```python
import torch

def _softmax(x, axis=-1):
    return torch.softmax(x, dim=axis)
def _gelu(x):
    return torch.nn.functional.gelu(x, approximate="tanh")
def _silu(x):
    return torch.nn.functional.silu(x)
def _sigmoid(x):
    return torch.sigmoid(x)
def _layernorm(x, axis=-1, eps=1e-5):
    m = x.mean(dim=axis, keepdim=True)
    v = x.var(dim=axis, keepdim=True, unbiased=False)
    return (x - m) / torch.sqrt(v + eps)
def _scatter_add(tgt, idx, src, axis=0):
    return tgt.clone().index_add_(axis, idx, src)
def _segment_sum(src, seg, n):
    out = torch.zeros((n,) + src.shape[1:], dtype=src.dtype)
    return out.index_add_(0, seg, src)
def _pad(x, pw):
    flat = tuple(v for pair in reversed(pw) for v in pair)
    return torch.nn.functional.pad(x, flat)

kernel_name = 'gated_mix__grouped_kv_mqa__glu_gated_reglu__prompt'

def setup_inputs():

    _w = (lambda a: (lambda t: t.to(torch.bfloat16) if t.is_floating_point() else t)(torch.as_tensor(a)))
    def _A_setup():
        B, S, D, H = 1, 2048, 1024, 32
        Dh = D // H
        return {
            "x": _w((lambda *s: torch.randn(*s, dtype=torch.bfloat16) * 0.05)(B, S, D)),
            "wq": _w((lambda *s: torch.randn(*s, dtype=torch.bfloat16) * 0.8)(D, H * Dh)),
            "wk": _w((lambda *s: torch.randn(*s, dtype=torch.bfloat16) * 0.8)(D, Dh)),
            "wv": _w((lambda *s: torch.randn(*s, dtype=torch.bfloat16) * 0.05)(D, Dh)),
            "wo": _w((lambda *s: torch.randn(*s, dtype=torch.bfloat16) * 0.05)(H * Dh, D)),
        }
    _A_in = _A_setup()

    def _B_setup():
        B, S, D, F = 1, 2048, 1024, 3584
        return {
            "x": _w((lambda *s: torch.randn(*s, dtype=torch.bfloat16) * 0.05)(B, S, D)),
            "W_gate": _w((lambda *s: torch.randn(*s, dtype=torch.bfloat16) * 1.6)(D, F) * (2.0 / D) ** 0.5),
            "W_up": _w((lambda *s: torch.randn(*s, dtype=torch.bfloat16) * 1.6)(D, F) * (2.0 / D) ** 0.5),
            "W_down": _w((lambda *s: torch.randn(*s, dtype=torch.bfloat16) * 1.6)(F, D) * (1.0 / F) ** 0.5),
        }
    _B_in = _B_setup()

    return {
        "A_x": _A_in["x"],
        "A_wq": _A_in["wq"],
        "A_wk": _A_in["wk"],
        "A_wv": _A_in["wv"],
        "A_wo": _A_in["wo"],
        "B_x": _B_in["x"],
        "B_W_gate": _B_in["W_gate"],
        "B_W_up": _B_in["W_up"],
        "B_W_down": _B_in["W_down"],
        "gate_w": _w((lambda *s: torch.randn(*s, dtype=torch.bfloat16) * 0.05)(1024) * 16.0),
    }

def reference(A_x, A_wq, A_wk, A_wv, A_wo, B_x, B_W_gate, B_W_up, B_W_down, gate_w):
    def _A_ref(x, wq, wk, wv, wo):
        B, S, D = x.shape
        H = 32
        Dh = D // H
        q = (lambda x, *d: x.permute(*d))((x @ wq).reshape(B, S, H, Dh), 0, 2, 1, 3)
        k = x @ wk
        v = x @ wv
        scores = torch.einsum("bhqd,bkd->bhqk", q, k) * (Dh ** -0.5)
        p = _softmax(scores, axis=-1)
        o = torch.einsum("bhqk,bkd->bhqd", p, v)
        return (lambda x, *d: x.permute(*d))(o, 0, 2, 1, 3).reshape(B, S, H * Dh) @ wo

    def _B_ref(x, W_gate, W_up, W_down):
        gate = torch.einsum("bsd,df->bsf", x, W_gate)
        up = torch.einsum("bsd,df->bsf", x, W_up)
        gate = gate * (lambda x, dt: x.to(dt))(gate > 0, gate.dtype)
        h = gate * up
        return torch.einsum("bsf,fd->bsd", h, W_down)

    x = A_x
    g = _sigmoid((x * gate_w).sum(-1, keepdims=True))
    a = _A_ref(x, A_wq, A_wk, A_wv, A_wo)
    b = _B_ref(x, B_W_gate, B_W_up, B_W_down)
    return g * a + (1 - g) * b
```

```asm
; @launch grid=(256,1,1) block=(256,1,1) lds=163840
.amdgcn_target "amdgcn-amd-amdhsa--gfx950"
.text
.globl gated_mix__grouped_kv_mqa__glu_gated_reglu__prompt_kernel
.p2align 8
.type gated_mix__grouped_kv_mqa__glu_gated_reglu__prompt_kernel,@function
gated_mix__grouped_kv_mqa__glu_gated_reglu__prompt_kernel:
    s_cmp_ge_u32 s2, 256
    s_cbranch_scc1 KM_END
    s_memrealtime s[72:73]
    s_load_dwordx8 s[56:63], s[0:1], 0
    s_load_dwordx8 s[64:71], s[0:1], 48
    s_load_dwordx2 s[74:75], s[0:1], 32
    s_load_dwordx4 s[96:99], s[0:1], 80
    s_load_dwordx2 s[86:87], s[0:1], 96
    s_getpc_b64 s[32:33]
KM_PC:
    s_and_b32 s33, s33, 0xffff
    s_mov_b32 s34, KM_END-KM_PC
    s_mov_b32 s35, 0x00020000
    v_lshrrev_b32 v1, 4, v0
    v_and_b32 v1, 12, v1
    v_and_or_b32 v1, v0, 3, v1
    v_lshlrev_b32 v1, 7, v1
    s_lshr_b32 s36, s2, 3
    s_lshl_b32 s36, s36, 11
    buffer_load_dword a255, v1, s[32:35], s36 offen
    v_and_b32 v20, 63, v0
    v_lshrrev_b32 v1, 6, v0
    s_and_b32 s80, s2, 7
    v_readfirstlane_b32 s36, v1
    s_lshr_b32 s81, s2, 3
    s_and_b32 s37, s81, 7
    s_lshr_b32 s83, s81, 3
    s_lshl_b32 s80, s80, 2
    s_add_u32 s38, s80, s83
    s_mul_i32 s85, s38, 224
    s_mov_b32 s42, 0
    s_mov_b32 s43, 0
    v_lshrrev_b32 v21, 3, v20
    s_lshl_b32 s81, s37, 8
    s_lshl_b32 s82, s36, 6
    s_add_u32 s81, s81, s82
    v_add_u32 v21, s81, v21
    v_lshlrev_b32 v21, 11, v21
    v_and_b32 v22, 7, v20
    v_lshrrev_b32 v23, 4, v20
    v_xor_b32 v22, v22, v23
    v_lshlrev_b32 v22, 4, v22
    v_xor_b32 v24, 64, v22
    v_add_u32 v2, v21, v22
    v_add_u32 v3, v21, v24
    v_add_u32 v3, 15360, v3
    v_add_u32 v4, v21, v22
    v_add_u32 v4, 30720, v4
    v_add_u32 v5, v21, v24
    v_add_u32 v5, 46080, v5
    s_mov_b32 s40, 0
    s_mov_b32 s41, 65536
    s_mov_b32 s39, 0
    s_lshl_b32 s81, s36, 4
    s_movk_i32 s84, 7168
    v_add_u32 v21, s81, v23
    v_mul_lo_u32 v21, v21, s84
    v_add_u32 v21, s85, v21
    v_and_b32 v25, 1, v20
    v_lshl_add_u32 v21, v25, 4, v21
    v_bfe_u32 v22, v20, 1, 3
    v_xor_b32 v22, v22, v23
    v_xor_b32 v24, 4, v22
    v_min_u32 v22, 6, v22
    v_min_u32 v24, 6, v24
    v_lshl_add_u32 v6, v22, 5, v21
    v_add_u32 v7, 27648, v6
    v_lshl_add_u32 v8, v24, 5, v21
    v_add_u32 v8, 55296, v8
    v_add_u32 v9, 27648, v8
    s_lshl_b32 s45, s36, 13
    s_lshl_b32 s46, s36, 12
    s_add_u32 s46, s46, 65536
    s_lshl_b32 s47, s36, 10
    s_add_u32 s51, s47, 147456
    s_add_u32 s47, s47, 135168
    s_lshr_b32 s81, s36, 1
    s_and_b32 s80, s36, 1
    v_lshlrev_b32 v21, 3, v23
    v_bfe_u32 v22, v20, 2, 2
    v_add_u32 v21, v21, v22
    s_lshl_b32 s82, s81, 5
    s_lshl_b32 s83, s80, 2
    s_add_u32 s82, s82, s83
    v_add_u32 v21, s82, v21
    v_lshlrev_b32 v21, 11, v21
    v_bfe_u32 v22, v20, 1, 1
    v_bfe_u32 v24, v20, 4, 1
    v_xor_b32 v22, v22, v24
    v_lshl_add_u32 v21, v22, 5, v21
    v_lshl_add_u32 v21, v25, 4, v21
    s_lshl_b32 s82, s38, 6
    v_add_u32 v0, s82, v21
    s_lshl_b32 s90, s81, 13
    s_lshl_b32 s83, s80, 10
    s_add_u32 s90, s90, s83
    s_waitcnt lgkmcnt(0)
    s_or_b32 s89, s72, 1
    s_mov_b32 s8, s56
    s_and_b32 s9, s57, 0xffff
    s_mov_b32 s10, 0x400000
    s_mov_b32 s11, 0x00020000
    s_mov_b32 s12, s64
    s_and_b32 s13, s65, 0xffff
    s_mov_b32 s14, 0x700000
    s_mov_b32 s15, 0x00020000
    s_mov_b32 s16, s66
    s_and_b32 s17, s67, 0xffff
    s_mov_b32 s18, 0x700000
    s_mov_b32 s19, 0x00020000
    s_mov_b32 s4, s58
    s_and_b32 s5, s59, 0xffff
    s_mov_b32 s6, 0x200000
    s_mov_b32 s7, 0x00020000
    s_add_u32 s56, s90, 131072
    s_add_u32 m0, s45, 0
    s_nop 0
    buffer_load_dwordx4 v2, s[8:11], s40 offen offset:0 lds
    buffer_load_dwordx4 v3, s[8:11], s40 offen offset:1024 lds
    buffer_load_dwordx4 v4, s[8:11], s40 offen offset:2048 lds
    buffer_load_dwordx4 v5, s[8:11], s40 offen offset:3072 lds
    s_add_u32 m0, s45, 4096
    s_nop 0
    buffer_load_dwordx4 v2, s[8:11], s41 offen offset:0 lds
    buffer_load_dwordx4 v3, s[8:11], s41 offen offset:1024 lds
    buffer_load_dwordx4 v4, s[8:11], s41 offen offset:2048 lds
    buffer_load_dwordx4 v5, s[8:11], s41 offen offset:3072 lds
    s_add_u32 s40, s40, 128
    s_add_u32 s41, s41, 128
    s_add_u32 m0, s46, 0
    s_nop 0
    buffer_load_dwordx4 v6, s[12:15], s42 offen offset:0 lds
    buffer_load_dwordx4 v7, s[12:15], s42 offen offset:1024 lds
    buffer_load_dwordx4 v8, s[12:15], s42 offen offset:2048 lds
    buffer_load_dwordx4 v9, s[12:15], s42 offen offset:3072 lds
    s_add_u32 m0, s46, 16384
    s_nop 0
    buffer_load_dwordx4 v6, s[16:19], s42 offen offset:0 lds
    buffer_load_dwordx4 v7, s[16:19], s42 offen offset:1024 lds
    buffer_load_dwordx4 v8, s[16:19], s42 offen offset:2048 lds
    buffer_load_dwordx4 v9, s[16:19], s42 offen offset:3072 lds
    s_add_u32 s42, s42, 458752
    s_add_u32 m0, s56, 0
    s_nop 0
    buffer_load_dwordx4 v0, s[4:7], s43 offen lds
    s_add_u32 s43, s43, 0x20000
    v_lshlrev_b32 v27, 4, v20
    v_and_b32 v21, 15, v20
    s_lshl_b32 s83, s81, 14
    v_lshlrev_b32 v22, 7, v21
    v_lshrrev_b32 v24, 1, v21
    v_xor_b32 v24, v24, v23
    v_lshl_add_u32 v22, v24, 4, v22
    v_add_u32 v10, s83, v22
    v_xor_b32 v11, 64, v10
    v_bfe_u32 v21, v20, 2, 2
    v_lshl_add_u32 v22, v23, 3, v21
    v_and_b32 v24, 3, v20
    v_lshlrev_b32 v24, 3, v24
    v_lshl_add_u32 v17, v22, 5, v24
    s_lshl_b32 s83, s81, 11
    s_add_u32 s83, s83, 135168
    v_add_u32 v17, s83, v17
    v_lshl_add_u32 v22, v22, 8, v24
    v_add_u32 v22, 65536, v22
    v_and_b32 v25, 1, v23
    v_lshl_or_b32 v1, v25, 2, v21
    s_lshl_b32 s82, s80, 2
    s_add_u32 s83, s82, 0
    v_xor_b32 v19, s83, v1
    v_lshl_add_u32 v12, v19, 5, v22
    s_add_u32 s83, s82, 1
    v_xor_b32 v19, s83, v1
    v_lshl_add_u32 v13, v19, 5, v22
    s_add_u32 s83, s82, 2
    v_xor_b32 v19, s83, v1
    v_lshl_add_u32 v14, v19, 5, v22
    s_add_u32 s83, s82, 3
    v_xor_b32 v19, s83, v1
    v_lshl_add_u32 v15, v19, 5, v22
    v_add_u32 v16, 16384, v15
    v_lshl_add_u32 v22, v23, 2, v21
    v_lshl_add_u32 v22, v22, 6, v24
    v_lshl_add_u32 v22, v25, 5, v22
    v_add_u32 v22, 131072, v22
    v_xor_b32 v1, 32, v22
    s_cmp_eq_u32 s80, 1
    s_cselect_b64 vcc, -1, 0
    s_movk_i32 s50, 2048
    s_cselect_b32 s50, s50, 0x8000
    v_cndmask_b32 v15, v15, v22, vcc
    v_cndmask_b32 v16, v16, v1, vcc
    s_add_u32 m0, s45, 32768
    s_nop 0
    buffer_load_dwordx4 v2, s[8:11], s40 offen offset:0 lds
    buffer_load_dwordx4 v3, s[8:11], s40 offen offset:1024 lds
    buffer_load_dwordx4 v4, s[8:11], s40 offen offset:2048 lds
    buffer_load_dwordx4 v5, s[8:11], s40 offen offset:3072 lds
    s_add_u32 m0, s45, 36864
    s_nop 0
    buffer_load_dwordx4 v2, s[8:11], s41 offen offset:0 lds
    buffer_load_dwordx4 v3, s[8:11], s41 offen offset:1024 lds
    buffer_load_dwordx4 v4, s[8:11], s41 offen offset:2048 lds
    buffer_load_dwordx4 v5, s[8:11], s41 offen offset:3072 lds
    s_add_u32 s40, s40, 128
    s_add_u32 s41, s41, 128
    s_add_u32 m0, s46, 32768
    s_nop 0
    buffer_load_dwordx4 v6, s[12:15], s42 offen offset:0 lds
    buffer_load_dwordx4 v7, s[12:15], s42 offen offset:1024 lds
    buffer_load_dwordx4 v8, s[12:15], s42 offen offset:2048 lds
    buffer_load_dwordx4 v9, s[12:15], s42 offen offset:3072 lds
    s_add_u32 m0, s46, 49152
    s_nop 0
    buffer_load_dwordx4 v6, s[16:19], s42 offen offset:0 lds
    s_branch KM_BODY
.p2align 12
KM_BODY:
    s_waitcnt vmcnt(13)
    s_barrier
    ds_read_b64_tr_b16 a[32:33], v12 offset:0
    ds_read_b64_tr_b16 a[34:35], v12 offset:1024
    ds_read_b128 a[0:3], v10 offset:0
    ds_read_b128 a[4:7], v10 offset:2048
    ds_read_b128 a[8:11], v10 offset:4096
    ds_read_b128 a[12:15], v10 offset:6144
    ds_read_b128 a[16:19], v10 offset:8192
    ds_read_b128 a[20:23], v10 offset:10240
    ds_read_b128 a[24:27], v10 offset:12288
    ds_read_b128 a[28:31], v10 offset:14336
    ds_read_b64_tr_b16 a[36:37], v13 offset:0
    ds_read_b64_tr_b16 a[38:39], v13 offset:1024
    ds_read_b64_tr_b16 a[40:41], v14 offset:0
    ds_read_b64_tr_b16 a[42:43], v14 offset:1024
    ds_read_b64_tr_b16 a[44:45], v15 offset:0
    ds_read_b64_tr_b16 a[46:47], v15 offset:1024
    ds_read_b64_tr_b16 a[48:49], v12 offset:16384
    ds_read_b64_tr_b16 a[50:51], v12 offset:17408
    ds_read_b64_tr_b16 a[52:53], v13 offset:16384
    ds_read_b64_tr_b16 a[54:55], v13 offset:17408
    ds_read_b64_tr_b16 a[56:57], v14 offset:16384
    ds_read_b64_tr_b16 a[58:59], v14 offset:17408
    ds_read_b64_tr_b16 a[60:61], v16 offset:0
    ds_read_b64_tr_b16 a[62:63], v16 offset:1024
    s_waitcnt lgkmcnt(0)
    v_mfma_f32_16x16x32_bf16 v[32:35], a[32:35], a[0:3], 0
    ds_read_b64_tr_b16 a[96:97], v12 offset:8192
    v_lshrrev_b32 v1, 3, v20
    v_mfma_f32_16x16x32_bf16 v[36:39], a[32:35], a[4:7], 0
    buffer_load_dwordx4 v7, s[16:19], s42 offen offset:1024 lds
    v_mfma_f32_16x16x32_bf16 v[40:43], a[32:35], a[8:11], 0
    ds_read_b64_tr_b16 a[98:99], v12 offset:9216
    v_lshlrev_b32 v1, 11, v1
    v_mfma_f32_16x16x32_bf16 v[44:47], a[32:35], a[12:15], 0
    v_bfe_u32 v25, v20, 1, 2
    v_xor_b32 v25, v25, v23
    v_mfma_f32_16x16x32_bf16 v[48:51], a[32:35], a[16:19], 0
    ds_read_b128 a[64:67], v11 offset:0
    v_lshl_add_u32 v1, v25, 5, v1
    v_mfma_f32_16x16x32_bf16 v[52:55], a[32:35], a[20:23], 0
    buffer_load_dwordx4 v8, s[16:19], s42 offen offset:2048 lds
    v_mfma_f32_16x16x32_bf16 v[56:59], a[32:35], a[24:27], 0
    ds_read_b128 a[68:71], v11 offset:2048
    v_and_b32 v25, 1, v20
    v_mfma_f32_16x16x32_bf16 v[60:63], a[32:35], a[28:31], 0
    v_lshl_add_u32 v29, v25, 4, v1
    v_lshl_add_u32 v1, v23, 2, v21
    v_mfma_f32_16x16x32_bf16 v[64:67], a[36:39], a[0:3], 0
    ds_read_b128 a[72:75], v11 offset:4096
    v_bfe_u32 v25, v1, 1, 2
    v_mfma_f32_16x16x32_bf16 v[68:71], a[36:39], a[4:7], 0
    buffer_load_dwordx4 v9, s[16:19], s42 offen offset:3072 lds
    v_mfma_f32_16x16x32_bf16 v[72:75], a[36:39], a[8:11], 0
    ds_read_b128 a[76:79], v11 offset:6144
    s_add_u32 s42, s42, 458752
    v_xor_b32 v25, s36, v25
    v_mfma_f32_16x16x32_bf16 v[76:79], a[36:39], a[12:15], 0
    v_lshlrev_b32 v1, 7, v1
    v_lshl_add_u32 v1, v25, 5, v1
    v_mfma_f32_16x16x32_bf16 v[80:83], a[36:39], a[16:19], 0
    ds_read_b128 a[80:83], v11 offset:8192
    s_add_u32 m0, s56, 2048
    v_add_u32 v1, v1, v24
    v_mfma_f32_16x16x32_bf16 v[84:87], a[36:39], a[20:23], 0
    buffer_load_dwordx4 v0, s[4:7], s43 offen lds
    v_mfma_f32_16x16x32_bf16 v[88:91], a[36:39], a[24:27], 0
    ds_read_b128 a[84:87], v11 offset:10240
    s_add_u32 s43, s43, 0x20000
    v_add_u32 v28, 147456, v1
    v_mfma_f32_16x16x32_bf16 v[92:95], a[36:39], a[28:31], 0
    s_lshr_b32 s82, s2, 4
    s_and_b32 s83, s2, 15
    v_mfma_f32_16x16x32_bf16 v[96:99], a[40:43], a[0:3], 0
    ds_read_b128 a[88:91], v11 offset:12288
    s_mul_i32 s3, s82, 458752
    v_mfma_f32_16x16x32_bf16 v[100:103], a[40:43], a[4:7], 0
    s_lshl_b32 s90, s83, 7
    s_add_u32 s3, s3, s90
    v_mfma_f32_16x16x32_bf16 v[104:107], a[40:43], a[8:11], 0
    ds_read_b128 a[92:95], v11 offset:14336
    s_lshl_b32 s95, s82, 17
    v_mfma_f32_16x16x32_bf16 v[108:111], a[40:43], a[12:15], 0
    s_add_u32 s95, s95, s90
    s_mul_i32 s90, s80, 229376
    v_mfma_f32_16x16x32_bf16 v[112:115], a[40:43], a[16:19], 0
    ds_read_b64_tr_b16 a[100:101], v13 offset:8192
    s_add_u32 s44, s3, s90
    v_mfma_f32_16x16x32_bf16 v[116:119], a[40:43], a[20:23], 0
    s_lshl_b32 s90, s81, 13
    s_add_u32 s44, s44, s90
    v_mfma_f32_16x16x32_bf16 v[120:123], a[40:43], a[24:27], 0
    ds_read_b64_tr_b16 a[102:103], v13 offset:9216
    s_add_u32 s44, s44, 196608
    v_mfma_f32_16x16x32_bf16 v[124:127], a[40:43], a[28:31], 0
    s_lshl_b32 s90, s36, 14
    s_add_u32 s3, s3, s90
    v_mfma_f32_16x16x32_bf16 v[128:131], a[44:47], a[0:3], 0
    ds_read_b64_tr_b16 a[104:105], v14 offset:8192
    s_lshl_b32 s90, s80, 15
    v_mfma_f32_16x16x32_bf16 v[132:135], a[44:47], a[4:7], 0
    s_add_u32 s95, s95, s90
    s_lshl_b32 s90, s81, 14
    v_mfma_f32_16x16x32_bf16 v[136:139], a[44:47], a[8:11], 0
    ds_read_b64_tr_b16 a[106:107], v14 offset:9216
    s_add_u32 s95, s95, s90
    v_mfma_f32_16x16x32_bf16 v[140:143], a[44:47], a[12:15], 0
    s_lshr_b32 s90, s83, 1
    s_mul_i32 s90, s90, 1179648
    v_mfma_f32_16x16x32_bf16 v[144:147], a[44:47], a[16:19], 0
    ds_read_b64_tr_b16 a[108:109], v15 offset:8192
    s_and_b32 s83, s83, 1
    v_mfma_f32_16x16x32_bf16 v[148:151], a[44:47], a[20:23], 0
    s_lshl_b32 s83, s83, 12
    s_add_u32 s90, s90, s83
    v_mfma_f32_16x16x32_bf16 v[152:155], a[44:47], a[24:27], 0
    ds_read_b64_tr_b16 a[110:111], v15 offset:9216
    s_lshl_b32 s83, s36, 10
    v_mfma_f32_16x16x32_bf16 v[156:159], a[44:47], a[28:31], 0
    s_add_u32 s90, s90, s83
    s_add_u32 s90, s90, 0x1700000
    v_mfma_f32_16x16x32_bf16 v[160:163], a[48:51], a[0:3], 0
    ds_read_b64_tr_b16 a[112:113], v12 offset:24576
    s_mul_i32 s94, s82, 57344
    v_mfma_f32_16x16x32_bf16 v[164:167], a[48:51], a[4:7], 0
    s_add_u32 s94, s94, s90
    s_lshl_b32 s100, s82, 14
    v_mfma_f32_16x16x32_bf16 v[168:171], a[48:51], a[8:11], 0
    ds_read_b64_tr_b16 a[114:115], v12 offset:25600
    s_add_u32 s100, s100, s90
    v_mfma_f32_16x16x32_bf16 v[172:175], a[48:51], a[12:15], 0
    s_add_u32 s100, s100, 917504
    s_lshl_b32 s82, s2, 3
    v_mfma_f32_16x16x32_bf16 v[176:179], a[48:51], a[16:19], 0
    ds_read_b64_tr_b16 a[116:117], v13 offset:24576
    s_lshl_b32 s83, s36, 1
    v_mfma_f32_16x16x32_bf16 v[180:183], a[48:51], a[20:23], 0
    s_add_u32 s82, s82, s83
    s_lshl_b32 s101, s82, 11
    v_mfma_f32_16x16x32_bf16 v[184:187], a[48:51], a[24:27], 0
    ds_read_b64_tr_b16 a[118:119], v13 offset:25600
    v_lshrrev_b32 v1, 5, v20
    v_mfma_f32_16x16x32_bf16 v[188:191], a[48:51], a[28:31], 0
    v_add_u32 v26, s82, v1
    v_lshlrev_b32 v26, 3, v26
    v_mfma_f32_16x16x32_bf16 v[192:195], a[52:55], a[0:3], 0
    ds_read_b64_tr_b16 a[120:121], v14 offset:24576
    v_add_u32 v26, 0x1240000, v26
    v_mfma_f32_16x16x32_bf16 v[196:199], a[52:55], a[4:7], 0
    s_lshl_b32 s82, s37, 2
    s_add_u32 s82, s82, s36
    v_mfma_f32_16x16x32_bf16 v[200:203], a[52:55], a[8:11], 0
    ds_read_b64_tr_b16 a[122:123], v14 offset:25600
    s_lshl_b32 s82, s82, 5
    v_mfma_f32_16x16x32_bf16 v[204:207], a[52:55], a[12:15], 0
    s_add_u32 s82, s82, s38
    s_lshl_b32 s82, s82, 7
    v_mfma_f32_16x16x32_bf16 v[208:211], a[52:55], a[16:19], 0
    ds_read_b64_tr_b16 a[124:125], v16 offset:8192
    s_add_u32 s57, s82, 0x1250000
    v_mfma_f32_16x16x32_bf16 v[212:215], a[52:55], a[20:23], 0
    s_and_b32 s82, s38, 2
    s_cmp_eq_u32 s82, 0
    s_cselect_b32 s20, s60, s62
    s_cselect_b32 s21, s61, s63
    v_mfma_f32_16x16x32_bf16 v[216:219], a[52:55], a[24:27], 0
    ds_read_b64_tr_b16 a[126:127], v16 offset:9216
    s_and_b32 s21, s21, 0xffff
    v_mfma_f32_16x16x32_bf16 v[220:223], a[52:55], a[28:31], 0
    s_mov_b32 s22, 65536
    s_mov_b32 s23, 0x00020000
    v_mfma_f32_16x16x32_bf16 v[224:227], a[56:59], a[0:3], 0
    s_mov_b32 s24, s86
    s_and_b32 s25, s87, 0xffff
    v_mfma_f32_16x16x32_bf16 v[228:231], a[56:59], a[4:7], 0
    s_mov_b32 s26, 0x2000000
    s_mov_b32 s27, 0x00020000
    v_mfma_f32_16x16x32_bf16 v[232:235], a[56:59], a[8:11], 0
    s_mov_b32 s28, s70
    s_and_b32 s29, s71, 0xffff
    v_mfma_f32_16x16x32_bf16 v[236:239], a[56:59], a[12:15], 0
    s_mov_b32 s30, 0x800
    s_mov_b32 s31, 0x00020000
    v_mfma_f32_16x16x32_bf16 v[240:243], a[56:59], a[16:19], 0
    s_mov_b32 s52, s68
    s_and_b32 s53, s69, 0xffff
    v_mfma_f32_16x16x32_bf16 v[244:247], a[56:59], a[20:23], 0
    s_mov_b32 s54, 0x700000
    s_mov_b32 s55, 0x00020000
    v_mfma_f32_16x16x32_bf16 v[248:251], a[56:59], a[24:27], 0
    s_mov_b32 s76, s74
    s_and_b32 s77, s75, 0xffff
    v_mfma_f32_16x16x32_bf16 v[252:255], a[56:59], a[28:31], 0
    s_mov_b32 s78, 0x200000
    s_mov_b32 s79, 0x00020000
    v_mfma_f32_16x16x32_bf16 a[128:131], a[60:63], a[0:3], 0
    s_mov_b32 s72, s98
    s_and_b32 s73, s99, 0xffff
    v_mfma_f32_16x16x32_bf16 a[132:135], a[60:63], a[4:7], 0
    v_xor_b32 v15, s50, v15
    s_mov_b32 s74, 0x100
    v_mfma_f32_16x16x32_bf16 a[136:139], a[60:63], a[8:11], 0
    s_mov_b32 s75, 0x00020000
    v_lshrrev_b32 v21, 1, v20
    v_mfma_f32_16x16x32_bf16 a[140:143], a[60:63], a[12:15], 0
    v_xor_b32 v16, s50, v16
    v_lshlrev_b32 v21, 6, v21
    v_mfma_f32_16x16x32_bf16 a[144:147], a[60:63], a[16:19], 0
    v_and_b32 v22, 1, v20
    v_lshl_add_u32 v21, v22, 4, v21
    v_mfma_f32_16x16x32_bf16 a[148:151], a[60:63], a[20:23], 0
    s_and_b32 s82, s38, 1
    s_lshl_b32 s82, s82, 5
    v_mfma_f32_16x16x32_bf16 a[152:155], a[60:63], a[24:27], 0
    s_lshl_b32 s83, s36, 11
    s_add_u32 s82, s82, s83
    v_mfma_f32_16x16x32_bf16 a[156:159], a[60:63], a[28:31], 0
    v_add_u32 v30, s82, v21
    s_lshl_b32 s82, s37, 8
    s_waitcnt vmcnt(0) lgkmcnt(0)
    s_barrier
    s_add_u32 m0, s45, 0
    v_mfma_f32_16x16x32_bf16 v[32:35], a[96:99], a[64:67], v[32:35]
    buffer_load_dwordx4 v2, s[8:11], s40 offen offset:0 lds
    v_mfma_f32_16x16x32_bf16 v[36:39], a[96:99], a[68:71], v[36:39]
    ds_read_b64_tr_b16 a[32:33], v12 offset:32768
    s_lshr_b32 s83, s38, 2
    v_mfma_f32_16x16x32_bf16 v[40:43], a[96:99], a[72:75], v[40:43]
    s_lshl_b32 s83, s83, 5
    s_add_u32 s82, s82, s83
    v_mfma_f32_16x16x32_bf16 v[44:47], a[96:99], a[76:79], v[44:47]
    ds_read_b64_tr_b16 a[34:35], v12 offset:33792
    s_lshl_b32 s83, s80, 4
    v_mfma_f32_16x16x32_bf16 v[48:51], a[96:99], a[80:83], v[48:51]
    buffer_load_dwordx4 v3, s[8:11], s40 offen offset:1024 lds
    v_mfma_f32_16x16x32_bf16 v[52:55], a[96:99], a[84:87], v[52:55]
    ds_read_b128 a[0:3], v10 offset:32768
    s_add_u32 s82, s82, s83
    v_mfma_f32_16x16x32_bf16 v[56:59], a[96:99], a[88:91], v[56:59]
    s_lshl_b32 s82, s82, 11
    s_lshl_b32 s83, s81, 7
    v_mfma_f32_16x16x32_bf16 v[60:63], a[96:99], a[92:95], v[60:63]
    ds_read_b128 a[4:7], v10 offset:34816
    s_add_u32 s82, s82, s83
    v_mfma_f32_16x16x32_bf16 v[64:67], a[100:103], a[64:67], v[64:67]
    v_and_b32 v21, 15, v20
    v_lshlrev_b32 v22, 11, v21
    v_mfma_f32_16x16x32_bf16 v[68:71], a[100:103], a[68:71], v[68:71]
    ds_read_b128 a[8:11], v10 offset:36864
    v_lshl_add_u32 v22, v23, 4, v22
    v_mfma_f32_16x16x32_bf16 v[72:75], a[100:103], a[72:75], v[72:75]
    buffer_load_dwordx4 v4, s[8:11], s40 offen offset:2048 lds
    v_mfma_f32_16x16x32_bf16 v[76:79], a[100:103], a[76:79], v[76:79]
    ds_read_b128 a[12:15], v10 offset:38912
    v_add_u32 v19, s82, v22
    v_mfma_f32_16x16x32_bf16 v[80:83], a[100:103], a[80:83], v[80:83]
    s_and_b32 s82, s38, 3
    s_lshl_b32 s82, s82, 6
    v_mfma_f32_16x16x32_bf16 v[84:87], a[100:103], a[84:87], v[84:87]
    ds_read_b128 a[16:19], v10 offset:40960
    s_lshl_b32 s83, s37, 8
    v_mfma_f32_16x16x32_bf16 v[88:91], a[100:103], a[88:91], v[88:91]
    buffer_load_dwordx4 v5, s[8:11], s40 offen offset:3072 lds
    v_mfma_f32_16x16x32_bf16 v[92:95], a[100:103], a[92:95], v[92:95]
    ds_read_b128 a[20:23], v10 offset:43008
    s_add_u32 s82, s82, s83
    v_mfma_f32_16x16x32_bf16 v[96:99], a[104:107], a[64:67], v[96:99]
    v_add_u32 v25, s82, v20
    v_lshlrev_b32 v25, 11, v25
    v_mfma_f32_16x16x32_bf16 v[100:103], a[104:107], a[68:71], v[100:103]
    ds_read_b128 a[24:27], v10 offset:45056
    s_mov_b32 s49, 0x7f000000
    v_mfma_f32_16x16x32_bf16 v[104:107], a[104:107], a[72:75], v[104:107]
    s_and_b32 s82, s38, 3
    s_lshl_b32 s82, s82, 4
    v_mfma_f32_16x16x32_bf16 v[108:111], a[104:107], a[76:79], v[108:111]
    s_add_u32 m0, s45, 4096
    ds_read_b128 a[28:31], v10 offset:47104
    v_lshrrev_b32 v24, 3, v20
    v_mfma_f32_16x16x32_bf16 v[112:115], a[104:107], a[80:83], v[112:115]
    buffer_load_dwordx4 v2, s[8:11], s41 offen offset:0 lds
    v_mfma_f32_16x16x32_bf16 v[116:119], a[104:107], a[84:87], v[116:119]
    ds_read_b64_tr_b16 a[36:37], v13 offset:32768
    v_add_u32 v24, s82, v24
    v_mfma_f32_16x16x32_bf16 v[120:123], a[104:107], a[88:91], v[120:123]
    v_mul_lo_u32 v24, v24, s84
    v_and_b32 v1, 7, v20
    v_mfma_f32_16x16x32_bf16 v[124:127], a[104:107], a[92:95], v[124:127]
    ds_read_b64_tr_b16 a[38:39], v13 offset:33792
    v_min_u32 v1, 6, v1
    v_mfma_f32_16x16x32_bf16 v[128:131], a[108:111], a[64:67], v[128:131]
    buffer_load_dwordx4 v3, s[8:11], s41 offen offset:1024 lds
    v_mfma_f32_16x16x32_bf16 v[132:135], a[108:111], a[68:71], v[132:135]
    ds_read_b64_tr_b16 a[40:41], v14 offset:32768
    v_lshl_add_u32 v24, v1, 7, v24
    v_mfma_f32_16x16x32_bf16 v[136:139], a[108:111], a[72:75], v[136:139]
    s_lshr_b32 s83, s38, 2
    s_mul_i32 s90, s83, 896
    v_mfma_f32_16x16x32_bf16 v[140:143], a[108:111], a[76:79], v[140:143]
    ds_read_b64_tr_b16 a[42:43], v14 offset:33792
    v_add_u32 v24, s90, v24
    v_mfma_f32_16x16x32_bf16 v[144:147], a[108:111], a[80:83], v[144:147]
    buffer_load_dwordx4 v4, s[8:11], s41 offen offset:2048 lds
    v_mfma_f32_16x16x32_bf16 v[148:151], a[108:111], a[84:87], v[148:151]
    ds_read_b64_tr_b16 a[44:45], v15 offset:0
    v_bfe_u32 v21, v20, 1, 4
    v_mfma_f32_16x16x32_bf16 v[152:155], a[108:111], a[88:91], v[152:155]
    v_add_u32 v21, s82, v21
    v_lshlrev_b32 v21, 11, v21
    v_mfma_f32_16x16x32_bf16 v[156:159], a[108:111], a[92:95], v[156:159]
    ds_read_b64_tr_b16 a[46:47], v15 offset:1024
    v_and_b32 v1, 1, v20
    v_mfma_f32_16x16x32_bf16 v[160:163], a[112:115], a[64:67], v[160:163]
    v_lshl_add_u32 v21, v1, 7, v21
    s_lshl_b32 s83, s83, 8
    v_mfma_f32_16x16x32_bf16 v[164:167], a[112:115], a[68:71], v[164:167]
    ds_read_b64_tr_b16 a[48:49], v12 offset:49152
    v_add_u32 v21, s83, v21
    v_mfma_f32_16x16x32_bf16 v[168:171], a[112:115], a[72:75], v[168:171]
    buffer_load_dwordx4 v5, s[8:11], s41 offen offset:3072 lds
    v_mfma_f32_16x16x32_bf16 v[172:175], a[112:115], a[76:79], v[172:175]
    ds_read_b64_tr_b16 a[50:51], v12 offset:50176
    s_lshl_b32 s58, 0x10101, s37
    v_mfma_f32_16x16x32_bf16 v[176:179], a[112:115], a[80:83], v[176:179]
    s_add_u32 s40, s40, 128
    s_add_u32 s41, s41, 128
    s_cmp_eq_u32 s36, 0
    s_cselect_b32 s58, 0x1f, s58
    s_add_u32 s82, s36, 1
    v_mfma_f32_16x16x32_bf16 v[180:183], a[112:115], a[84:87], v[180:183]
    s_add_u32 m0, s46, 0
    ds_read_b64_tr_b16 a[52:53], v13 offset:49152
    s_and_b32 s82, s82, 2
    s_cselect_b32 s59, 57344, s49
    v_mfma_f32_16x16x32_bf16 v[184:187], a[112:115], a[88:91], v[184:187]
    buffer_load_dwordx4 v6, s[12:15], s42 offen offset:0 lds
    v_mfma_f32_16x16x32_bf16 v[188:191], a[112:115], a[92:95], v[188:191]
    ds_read_b64_tr_b16 a[54:55], v13 offset:50176
    s_mov_b32 s49, 458752
    v_mfma_f32_16x16x32_bf16 v[192:195], a[116:119], a[64:67], v[192:195]
    s_cmp_eq_u32 s36, 0
    s_cselect_b64 vcc, -1, 0
    s_cselect_b32 s32, s8, s12
    s_cselect_b32 s33, s9, s13
    s_cselect_b32 s34, s10, s14
    s_cselect_b32 s49, 128, s49
    v_cndmask_b32 v18, v24, v25, vcc
    s_cmp_eq_u32 s36, 2
    s_cselect_b32 s32, s16, s32
    s_cselect_b32 s33, s17, s33
    v_mfma_f32_16x16x32_bf16 v[196:199], a[116:119], a[68:71], v[196:199]
    ds_read_b64_tr_b16 a[56:57], v14 offset:49152
    s_cmp_eq_u32 s36, 3
    s_cselect_b64 vcc, -1, 0
    s_cselect_b32 s32, s4, s32
    s_cselect_b32 s33, s5, s33
    s_cselect_b32 s34, s6, s34
    s_cselect_b32 s49, 0x20000, s49
    v_cndmask_b32 v18, v18, v21, vcc
    v_mfma_f32_16x16x32_bf16 v[200:203], a[116:119], a[72:75], v[200:203]
    buffer_load_dwordx4 v7, s[12:15], s42 offen offset:1024 lds
    v_mfma_f32_16x16x32_bf16 v[204:207], a[116:119], a[76:79], v[204:207]
    ds_read_b64_tr_b16 a[58:59], v14 offset:50176
    s_mov_b32 s35, 0x00020000
    v_mfma_f32_16x16x32_bf16 v[208:211], a[116:119], a[80:83], v[208:211]
    s_mul_i32 s48, s49, 3
    v_and_b32 v1, 31, v20
    v_mfma_f32_16x16x32_bf16 v[212:215], a[116:119], a[84:87], v[212:215]
    ds_read_b64_tr_b16 a[60:61], v16 offset:0
    v_lshlrev_b32 v1, 7, v1
    v_mfma_f32_16x16x32_bf16 v[216:219], a[116:119], a[88:91], v[216:219]
    s_lshr_b32 s82, s2, 3
    s_and_b32 s82, s82, 15
    v_mfma_f32_16x16x32_bf16 v[220:223], a[116:119], a[92:95], v[220:223]
    ds_read_b64_tr_b16 a[62:63], v16 offset:1024
    s_lshl_b32 s82, s82, 12
    v_mfma_f32_16x16x32_bf16 v[224:227], a[120:123], a[64:67], v[224:227]
    buffer_load_dwordx4 v8, s[12:15], s42 offen offset:2048 lds
    v_mfma_f32_16x16x32_bf16 v[228:231], a[120:123], a[68:71], v[228:231]
    v_mfma_f32_16x16x32_bf16 v[232:235], a[120:123], a[72:75], v[232:235]
    v_mfma_f32_16x16x32_bf16 v[236:239], a[120:123], a[76:79], v[236:239]
    v_mfma_f32_16x16x32_bf16 v[240:243], a[120:123], a[80:83], v[240:243]
    buffer_load_dwordx4 v9, s[12:15], s42 offen offset:3072 lds
    v_mfma_f32_16x16x32_bf16 v[244:247], a[120:123], a[84:87], v[244:247]
    v_mfma_f32_16x16x32_bf16 v[248:251], a[120:123], a[88:91], v[248:251]
    v_mfma_f32_16x16x32_bf16 v[252:255], a[120:123], a[92:95], v[252:255]
    v_mfma_f32_16x16x32_bf16 a[128:131], a[124:127], a[64:67], a[128:131]
    v_mfma_f32_16x16x32_bf16 a[132:135], a[124:127], a[68:71], a[132:135]
    s_add_u32 m0, s46, 16384
    v_mfma_f32_16x16x32_bf16 a[136:139], a[124:127], a[72:75], a[136:139]
    buffer_load_dwordx4 v6, s[16:19], s42 offen offset:0 lds
    v_mfma_f32_16x16x32_bf16 a[140:143], a[124:127], a[76:79], a[140:143]
    v_mfma_f32_16x16x32_bf16 a[144:147], a[124:127], a[80:83], a[144:147]
    v_mfma_f32_16x16x32_bf16 a[148:151], a[124:127], a[84:87], a[148:151]
    v_mfma_f32_16x16x32_bf16 a[152:155], a[124:127], a[88:91], a[152:155]
    v_mfma_f32_16x16x32_bf16 a[156:159], a[124:127], a[92:95], a[156:159]
    s_waitcnt lgkmcnt(0)
    v_mfma_f32_16x16x32_bf16 v[32:35], a[32:35], a[0:3], v[32:35]
    ds_read_b64_tr_b16 a[96:97], v12 offset:40960
    v_mfma_f32_16x16x32_bf16 v[36:39], a[32:35], a[4:7], v[36:39]
    buffer_load_dwordx4 v7, s[16:19], s42 offen offset:1024 lds
    v_mfma_f32_16x16x32_bf16 v[40:43], a[32:35], a[8:11], v[40:43]
    ds_read_b64_tr_b16 a[98:99], v12 offset:41984
    v_mfma_f32_16x16x32_bf16 v[44:47], a[32:35], a[12:15], v[44:47]
    v_mfma_f32_16x16x32_bf16 v[48:51], a[32:35], a[16:19], v[48:51]
    ds_read_b128 a[64:67], v11 offset:32768
    v_mfma_f32_16x16x32_bf16 v[52:55], a[32:35], a[20:23], v[52:55]
    buffer_load_dwordx4 v8, s[16:19], s42 offen offset:2048 lds
    v_mfma_f32_16x16x32_bf16 v[56:59], a[32:35], a[24:27], v[56:59]
    ds_read_b128 a[68:71], v11 offset:34816
    v_mfma_f32_16x16x32_bf16 v[60:63], a[32:35], a[28:31], v[60:63]
    v_mfma_f32_16x16x32_bf16 v[64:67], a[36:39], a[0:3], v[64:67]
    ds_read_b128 a[72:75], v11 offset:36864
    v_mfma_f32_16x16x32_bf16 v[68:71], a[36:39], a[4:7], v[68:71]
    buffer_load_dwordx4 v9, s[16:19], s42 offen offset:3072 lds
    v_mfma_f32_16x16x32_bf16 v[72:75], a[36:39], a[8:11], v[72:75]
    ds_read_b128 a[76:79], v11 offset:38912
    s_add_u32 s42, s42, 458752
    v_mfma_f32_16x16x32_bf16 v[76:79], a[36:39], a[12:15], v[76:79]
    v_mfma_f32_16x16x32_bf16 v[80:83], a[36:39], a[16:19], v[80:83]
    ds_read_b128 a[80:83], v11 offset:40960
    s_add_u32 m0, s56, 0
    v_mfma_f32_16x16x32_bf16 v[84:87], a[36:39], a[20:23], v[84:87]
    buffer_load_dwordx4 v0, s[4:7], s43 offen lds
    v_mfma_f32_16x16x32_bf16 v[88:91], a[36:39], a[24:27], v[88:91]
    ds_read_b128 a[84:87], v11 offset:43008
    s_add_u32 s43, s43, 0x20000
    v_mfma_f32_16x16x32_bf16 v[92:95], a[36:39], a[28:31], v[92:95]
    v_mfma_f32_16x16x32_bf16 v[96:99], a[40:43], a[0:3], v[96:99]
    ds_read_b128 a[88:91], v11 offset:45056
    s_add_u32 m0, s47, 0
    v_mfma_f32_16x16x32_bf16 v[100:103], a[40:43], a[4:7], v[100:103]
    buffer_load_dwordx4 v30, s[20:23], s39 offen lds
    v_mfma_f32_16x16x32_bf16 v[104:107], a[40:43], a[8:11], v[104:107]
    ds_read_b128 a[92:95], v11 offset:47104
    s_add_u32 s39, s39, 8192
    s_bitcmp1_b32 s58, 1
    s_cselect_b32 s60, s48, 0x7f000000
    v_mfma_f32_16x16x32_bf16 v[108:111], a[40:43], a[12:15], v[108:111]
    buffer_load_dword a255, v18, s[32:35], s60 offen
    v_mfma_f32_16x16x32_bf16 v[112:115], a[40:43], a[16:19], v[112:115]
    ds_read_b64_tr_b16 a[100:101], v13 offset:40960
    s_add_u32 s60, s60, s59
    s_add_u32 s48, s48, s49
    v_mfma_f32_16x16x32_bf16 v[116:119], a[40:43], a[20:23], v[116:119]
    buffer_load_dword a255, v18, s[32:35], s60 offen
    v_mfma_f32_16x16x32_bf16 v[120:123], a[40:43], a[24:27], v[120:123]
    ds_read_b64_tr_b16 a[102:103], v13 offset:41984
    v_mfma_f32_16x16x32_bf16 v[124:127], a[40:43], a[28:31], v[124:127]
    buffer_load_dwordx4 a[208:211], v19, s[8:11], 0 offen offset:0
    v_mfma_f32_16x16x32_bf16 v[128:131], a[44:47], a[0:3], v[128:131]
    ds_read_b64_tr_b16 a[104:105], v14 offset:40960
    v_mfma_f32_16x16x32_bf16 v[132:135], a[44:47], a[4:7], v[132:135]
    buffer_load_dwordx4 a[212:215], v19, s[8:11], 0 offen offset:64
    v_mfma_f32_16x16x32_bf16 v[136:139], a[44:47], a[8:11], v[136:139]
    ds_read_b64_tr_b16 a[106:107], v14 offset:41984
    v_mfma_f32_16x16x32_bf16 v[140:143], a[44:47], a[12:15], v[140:143]
    v_mfma_f32_16x16x32_bf16 v[144:147], a[44:47], a[16:19], v[144:147]
    ds_read_b64_tr_b16 a[108:109], v15 offset:8192
    v_mfma_f32_16x16x32_bf16 v[148:151], a[44:47], a[20:23], v[148:151]
    v_mfma_f32_16x16x32_bf16 v[152:155], a[44:47], a[24:27], v[152:155]
    ds_read_b64_tr_b16 a[110:111], v15 offset:9216
    v_mfma_f32_16x16x32_bf16 v[156:159], a[44:47], a[28:31], v[156:159]
    v_mfma_f32_16x16x32_bf16 v[160:163], a[48:51], a[0:3], v[160:163]
    ds_read_b64_tr_b16 a[112:113], v12 offset:57344
    v_mfma_f32_16x16x32_bf16 v[164:167], a[48:51], a[4:7], v[164:167]
    v_mfma_f32_16x16x32_bf16 v[168:171], a[48:51], a[8:11], v[168:171]
    ds_read_b64_tr_b16 a[114:115], v12 offset:58368
    v_mfma_f32_16x16x32_bf16 v[172:175], a[48:51], a[12:15], v[172:175]
    v_mfma_f32_16x16x32_bf16 v[176:179], a[48:51], a[16:19], v[176:179]
    ds_read_b64_tr_b16 a[116:117], v13 offset:57344
    v_mfma_f32_16x16x32_bf16 v[180:183], a[48:51], a[20:23], v[180:183]
    v_mfma_f32_16x16x32_bf16 v[184:187], a[48:51], a[24:27], v[184:187]
    ds_read_b64_tr_b16 a[118:119], v13 offset:58368
    v_mfma_f32_16x16x32_bf16 v[188:191], a[48:51], a[28:31], v[188:191]
    v_mfma_f32_16x16x32_bf16 v[192:195], a[52:55], a[0:3], v[192:195]
    ds_read_b64_tr_b16 a[120:121], v14 offset:57344
    v_mfma_f32_16x16x32_bf16 v[196:199], a[52:55], a[4:7], v[196:199]
    v_mfma_f32_16x16x32_bf16 v[200:203], a[52:55], a[8:11], v[200:203]
    ds_read_b64_tr_b16 a[122:123], v14 offset:58368
    v_mfma_f32_16x16x32_bf16 v[204:207], a[52:55], a[12:15], v[204:207]
    v_mfma_f32_16x16x32_bf16 v[208:211], a[52:55], a[16:19], v[208:211]
    ds_read_b64_tr_b16 a[124:125], v16 offset:8192
    v_mfma_f32_16x16x32_bf16 v[212:215], a[52:55], a[20:23], v[212:215]
    v_mfma_f32_16x16x32_bf16 v[216:219], a[52:55], a[24:27], v[216:219]
    ds_read_b64_tr_b16 a[126:127], v16 offset:9216
    v_mfma_f32_16x16x32_bf16 v[220:223], a[52:55], a[28:31], v[220:223]
    v_mfma_f32_16x16x32_bf16 v[224:227], a[56:59], a[0:3], v[224:227]
    v_mfma_f32_16x16x32_bf16 v[228:231], a[56:59], a[4:7], v[228:231]
    v_mfma_f32_16x16x32_bf16 v[232:235], a[56:59], a[8:11], v[232:235]
    v_mfma_f32_16x16x32_bf16 v[236:239], a[56:59], a[12:15], v[236:239]
    v_mfma_f32_16x16x32_bf16 v[240:243], a[56:59], a[16:19], v[240:243]
    v_mfma_f32_16x16x32_bf16 v[244:247], a[56:59], a[20:23], v[244:247]
    v_mfma_f32_16x16x32_bf16 v[248:251], a[56:59], a[24:27], v[248:251]
    v_mfma_f32_16x16x32_bf16 v[252:255], a[56:59], a[28:31], v[252:255]
    v_mfma_f32_16x16x32_bf16 a[128:131], a[60:63], a[0:3], a[128:131]
    v_mfma_f32_16x16x32_bf16 a[132:135], a[60:63], a[4:7], a[132:135]
    v_xor_b32 v15, s50, v15
    v_mfma_f32_16x16x32_bf16 a[136:139], a[60:63], a[8:11], a[136:139]
    v_mfma_f32_16x16x32_bf16 a[140:143], a[60:63], a[12:15], a[140:143]
    v_xor_b32 v16, s50, v16
    v_mfma_f32_16x16x32_bf16 a[144:147], a[60:63], a[16:19], a[144:147]
    v_mfma_f32_16x16x32_bf16 a[148:151], a[60:63], a[20:23], a[148:151]
    v_mfma_f32_16x16x32_bf16 a[152:155], a[60:63], a[24:27], a[152:155]
    v_mfma_f32_16x16x32_bf16 a[156:159], a[60:63], a[28:31], a[156:159]
    s_mov_b64 exec, 0
    s_cmp_eq_u32 s36, 0
    s_cbranch_scc1 KM_PAD1
    s_cmp_eq_u32 s36, 1
    s_cbranch_scc1 KM_PAD2
    s_cmp_eq_u32 s36, 2
    s_cbranch_scc1 KM_PAD3
    s_branch KM_PAD4
KM_RET1:
    s_mov_b64 exec, -1
    s_waitcnt vmcnt(4) lgkmcnt(0)
    s_barrier
    s_add_u32 m0, s45, 32768
    v_mfma_f32_16x16x32_bf16 v[32:35], a[96:99], a[64:67], v[32:35]
    buffer_load_dwordx4 v2, s[8:11], s40 offen offset:0 lds
    v_mfma_f32_16x16x32_bf16 v[36:39], a[96:99], a[68:71], v[36:39]
    ds_read_b64_tr_b16 a[32:33], v12 offset:0
    v_mfma_f32_16x16x32_bf16 v[40:43], a[96:99], a[72:75], v[40:43]
    v_mfma_f32_16x16x32_bf16 v[44:47], a[96:99], a[76:79], v[44:47]
    ds_read_b64_tr_b16 a[34:35], v12 offset:1024
    v_mfma_f32_16x16x32_bf16 v[48:51], a[96:99], a[80:83], v[48:51]
    buffer_load_dwordx4 v3, s[8:11], s40 offen offset:1024 lds
    v_mfma_f32_16x16x32_bf16 v[52:55], a[96:99], a[84:87], v[52:55]
    ds_read_b128 a[0:3], v10 offset:0
    v_mfma_f32_16x16x32_bf16 v[56:59], a[96:99], a[88:91], v[56:59]
    v_mfma_f32_16x16x32_bf16 v[60:63], a[96:99], a[92:95], v[60:63]
    ds_read_b128 a[4:7], v10 offset:2048
    v_mfma_f32_16x16x32_bf16 v[64:67], a[100:103], a[64:67], v[64:67]
    v_mfma_f32_16x16x32_bf16 v[68:71], a[100:103], a[68:71], v[68:71]
    ds_read_b128 a[8:11], v10 offset:4096
    v_mfma_f32_16x16x32_bf16 v[72:75], a[100:103], a[72:75], v[72:75]
    buffer_load_dwordx4 v4, s[8:11], s40 offen offset:2048 lds
    v_mfma_f32_16x16x32_bf16 v[76:79], a[100:103], a[76:79], v[76:79]
    ds_read_b128 a[12:15], v10 offset:6144
    v_mfma_f32_16x16x32_bf16 v[80:83], a[100:103], a[80:83], v[80:83]
    v_mfma_f32_16x16x32_bf16 v[84:87], a[100:103], a[84:87], v[84:87]
    ds_read_b128 a[16:19], v10 offset:8192
    v_mfma_f32_16x16x32_bf16 v[88:91], a[100:103], a[88:91], v[88:91]
    buffer_load_dwordx4 v5, s[8:11], s40 offen offset:3072 lds
    v_mfma_f32_16x16x32_bf16 v[92:95], a[100:103], a[92:95], v[92:95]
    ds_read_b128 a[20:23], v10 offset:10240
    v_mfma_f32_16x16x32_bf16 v[96:99], a[104:107], a[64:67], v[96:99]
    v_mfma_f32_16x16x32_bf16 v[100:103], a[104:107], a[68:71], v[100:103]
    ds_read_b128 a[24:27], v10 offset:12288
    v_mfma_f32_16x16x32_bf16 v[104:107], a[104:107], a[72:75], v[104:107]
    v_mfma_f32_16x16x32_bf16 v[108:111], a[104:107], a[76:79], v[108:111]
    s_add_u32 m0, s45, 36864
    ds_read_b128 a[28:31], v10 offset:14336
    v_mfma_f32_16x16x32_bf16 v[112:115], a[104:107], a[80:83], v[112:115]
    buffer_load_dwordx4 v2, s[8:11], s41 offen offset:0 lds
    v_mfma_f32_16x16x32_bf16 v[116:119], a[104:107], a[84:87], v[116:119]
    ds_read_b64_tr_b16 a[36:37], v13 offset:0
    v_mfma_f32_16x16x32_bf16 v[120:123], a[104:107], a[88:91], v[120:123]
    v_mfma_f32_16x16x32_bf16 v[124:127], a[104:107], a[92:95], v[124:127]
    ds_read_b64_tr_b16 a[38:39], v13 offset:1024
    v_mfma_f32_16x16x32_bf16 v[128:131], a[108:111], a[64:67], v[128:131]
    buffer_load_dwordx4 v3, s[8:11], s41 offen offset:1024 lds
    v_mfma_f32_16x16x32_bf16 v[132:135], a[108:111], a[68:71], v[132:135]
    ds_read_b64_tr_b16 a[40:41], v14 offset:0
    v_mfma_f32_16x16x32_bf16 v[136:139], a[108:111], a[72:75], v[136:139]
    v_mfma_f32_16x16x32_bf16 v[140:143], a[108:111], a[76:79], v[140:143]
    ds_read_b64_tr_b16 a[42:43], v14 offset:1024
    v_mfma_f32_16x16x32_bf16 v[144:147], a[108:111], a[80:83], v[144:147]
    buffer_load_dwordx4 v4, s[8:11], s41 offen offset:2048 lds
    v_mfma_f32_16x16x32_bf16 v[148:151], a[108:111], a[84:87], v[148:151]
    ds_read_b64_tr_b16 a[44:45], v15 offset:0
    v_mfma_f32_16x16x32_bf16 v[152:155], a[108:111], a[88:91], v[152:155]
    v_mfma_f32_16x16x32_bf16 v[156:159], a[108:111], a[92:95], v[156:159]
    ds_read_b64_tr_b16 a[46:47], v15 offset:1024
    v_mfma_f32_16x16x32_bf16 v[160:163], a[112:115], a[64:67], v[160:163]
    v_mfma_f32_16x16x32_bf16 v[164:167], a[112:115], a[68:71], v[164:167]
    ds_read_b64_tr_b16 a[48:49], v12 offset:16384
    v_mfma_f32_16x16x32_bf16 v[168:171], a[112:115], a[72:75], v[168:171]
    buffer_load_dwordx4 v5, s[8:11], s41 offen offset:3072 lds
    v_mfma_f32_16x16x32_bf16 v[172:175], a[112:115], a[76:79], v[172:175]
    ds_read_b64_tr_b16 a[50:51], v12 offset:17408
    v_mfma_f32_16x16x32_bf16 v[176:179], a[112:115], a[80:83], v[176:179]
    s_add_u32 s40, s40, 128
    s_add_u32 s41, s41, 128
KM_PAD1:
    s_cbranch_execz KM_PAD5
    s_nop 0
    v_mfma_f32_16x16x32_bf16 v[180:183], a[112:115], a[84:87], v[180:183]
    s_add_u32 m0, s46, 32768
    ds_read_b64_tr_b16 a[52:53], v13 offset:16384
    v_mfma_f32_16x16x32_bf16 v[184:187], a[112:115], a[88:91], v[184:187]
    buffer_load_dwordx4 v6, s[12:15], s42 offen offset:0 lds
    v_mfma_f32_16x16x32_bf16 v[188:191], a[112:115], a[92:95], v[188:191]
    ds_read_b64_tr_b16 a[54:55], v13 offset:17408
    v_mfma_f32_16x16x32_bf16 v[192:195], a[116:119], a[64:67], v[192:195]
    v_mfma_f32_16x16x32_bf16 v[196:199], a[116:119], a[68:71], v[196:199]
    ds_read_b64_tr_b16 a[56:57], v14 offset:16384
    v_mfma_f32_16x16x32_bf16 v[200:203], a[116:119], a[72:75], v[200:203]
    buffer_load_dwordx4 v7, s[12:15], s42 offen offset:1024 lds
    v_mfma_f32_16x16x32_bf16 v[204:207], a[116:119], a[76:79], v[204:207]
    ds_read_b64_tr_b16 a[58:59], v14 offset:17408
    v_mfma_f32_16x16x32_bf16 v[208:211], a[116:119], a[80:83], v[208:211]
    v_mfma_f32_16x16x32_bf16 v[212:215], a[116:119], a[84:87], v[212:215]
    ds_read_b64_tr_b16 a[60:61], v16 offset:0
    v_mfma_f32_16x16x32_bf16 v[216:219], a[116:119], a[88:91], v[216:219]
    v_mfma_f32_16x16x32_bf16 v[220:223], a[116:119], a[92:95], v[220:223]
    ds_read_b64_tr_b16 a[62:63], v16 offset:1024
    v_mfma_f32_16x16x32_bf16 v[224:227], a[120:123], a[64:67], v[224:227]
    buffer_load_dwordx4 v8, s[12:15], s42 offen offset:2048 lds
    v_mfma_f32_16x16x32_bf16 v[228:231], a[120:123], a[68:71], v[228:231]
    v_mfma_f32_16x16x32_bf16 v[232:235], a[120:123], a[72:75], v[232:235]
    v_mfma_f32_16x16x32_bf16 v[236:239], a[120:123], a[76:79], v[236:239]
    v_mfma_f32_16x16x32_bf16 v[240:243], a[120:123], a[80:83], v[240:243]
    buffer_load_dwordx4 v9, s[12:15], s42 offen offset:3072 lds
    v_mfma_f32_16x16x32_bf16 v[244:247], a[120:123], a[84:87], v[244:247]
    v_mfma_f32_16x16x32_bf16 v[248:251], a[120:123], a[88:91], v[248:251]
    v_mfma_f32_16x16x32_bf16 v[252:255], a[120:123], a[92:95], v[252:255]
    v_mfma_f32_16x16x32_bf16 a[128:131], a[124:127], a[64:67], a[128:131]
    v_mfma_f32_16x16x32_bf16 a[132:135], a[124:127], a[68:71], a[132:135]
    s_add_u32 m0, s46, 49152
    v_mfma_f32_16x16x32_bf16 a[136:139], a[124:127], a[72:75], a[136:139]
    buffer_load_dwordx4 v6, s[16:19], s42 offen offset:0 lds
    v_mfma_f32_16x16x32_bf16 a[140:143], a[124:127], a[76:79], a[140:143]
    v_mfma_f32_16x16x32_bf16 a[144:147], a[124:127], a[80:83], a[144:147]
    v_mfma_f32_16x16x32_bf16 a[148:151], a[124:127], a[84:87], a[148:151]
    v_mfma_f32_16x16x32_bf16 a[152:155], a[124:127], a[88:91], a[152:155]
    v_mfma_f32_16x16x32_bf16 a[156:159], a[124:127], a[92:95], a[156:159]
    s_waitcnt lgkmcnt(0)
    v_mfma_f32_16x16x32_bf16 v[32:35], a[32:35], a[0:3], v[32:35]
    ds_read_b64_tr_b16 a[96:97], v12 offset:8192
    v_mfma_f32_16x16x32_bf16 v[36:39], a[32:35], a[4:7], v[36:39]
    buffer_load_dwordx4 v7, s[16:19], s42 offen offset:1024 lds
    v_mfma_f32_16x16x32_bf16 v[40:43], a[32:35], a[8:11], v[40:43]
    ds_read_b64_tr_b16 a[98:99], v12 offset:9216
    v_mfma_f32_16x16x32_bf16 v[44:47], a[32:35], a[12:15], v[44:47]
    v_mfma_f32_16x16x32_bf16 v[48:51], a[32:35], a[16:19], v[48:51]
    ds_read_b128 a[64:67], v11 offset:0
    v_mfma_f32_16x16x32_bf16 v[52:55], a[32:35], a[20:23], v[52:55]
    buffer_load_dwordx4 v8, s[16:19], s42 offen offset:2048 lds
    v_mfma_f32_16x16x32_bf16 v[56:59], a[32:35], a[24:27], v[56:59]
    ds_read_b128 a[68:71], v11 offset:2048
    v_mfma_f32_16x16x32_bf16 v[60:63], a[32:35], a[28:31], v[60:63]
    v_mfma_f32_16x16x32_bf16 v[64:67], a[36:39], a[0:3], v[64:67]
    ds_read_b128 a[72:75], v11 offset:4096
    v_mfma_f32_16x16x32_bf16 v[68:71], a[36:39], a[4:7], v[68:71]
    buffer_load_dwordx4 v9, s[16:19], s42 offen offset:3072 lds
    v_mfma_f32_16x16x32_bf16 v[72:75], a[36:39], a[8:11], v[72:75]
    ds_read_b128 a[76:79], v11 offset:6144
    s_add_u32 s42, s42, 458752
    v_mfma_f32_16x16x32_bf16 v[76:79], a[36:39], a[12:15], v[76:79]
    v_mfma_f32_16x16x32_bf16 v[80:83], a[36:39], a[16:19], v[80:83]
    ds_read_b128 a[80:83], v11 offset:8192
    s_add_u32 m0, s56, 2048
    v_mfma_f32_16x16x32_bf16 v[84:87], a[36:39], a[20:23], v[84:87]
    buffer_load_dwordx4 v0, s[4:7], s43 offen lds
    v_mfma_f32_16x16x32_bf16 v[88:91], a[36:39], a[24:27], v[88:91]
    ds_read_b128 a[84:87], v11 offset:10240
    s_add_u32 s43, s43, 0x20000
    v_mfma_f32_16x16x32_bf16 v[92:95], a[36:39], a[28:31], v[92:95]
    v_mfma_f32_16x16x32_bf16 v[96:99], a[40:43], a[0:3], v[96:99]
    ds_read_b128 a[88:91], v11 offset:12288
    s_add_u32 m0, s47, 8192
    v_mfma_f32_16x16x32_bf16 v[100:103], a[40:43], a[4:7], v[100:103]
    buffer_load_dwordx4 v30, s[20:23], s39 offen lds
    v_mfma_f32_16x16x32_bf16 v[104:107], a[40:43], a[8:11], v[104:107]
    ds_read_b128 a[92:95], v11 offset:14336
    s_add_u32 s39, s39, 8192
    s_bitcmp1_b32 s58, 2
    s_cselect_b32 s60, s48, 0x7f000000
    v_mfma_f32_16x16x32_bf16 v[108:111], a[40:43], a[12:15], v[108:111]
    buffer_load_dword a255, v18, s[32:35], s60 offen
    v_mfma_f32_16x16x32_bf16 v[112:115], a[40:43], a[16:19], v[112:115]
    ds_read_b64_tr_b16 a[100:101], v13 offset:8192
    s_add_u32 s60, s60, s59
    s_add_u32 s48, s48, s49
    v_mfma_f32_16x16x32_bf16 v[116:119], a[40:43], a[20:23], v[116:119]
    buffer_load_dword a255, v18, s[32:35], s60 offen
    v_mfma_f32_16x16x32_bf16 v[120:123], a[40:43], a[24:27], v[120:123]
    ds_read_b64_tr_b16 a[102:103], v13 offset:9216
    v_mfma_f32_16x16x32_bf16 v[124:127], a[40:43], a[28:31], v[124:127]
    buffer_load_dwordx4 a[216:219], v19, s[8:11], 0 offen offset:256
    v_mfma_f32_16x16x32_bf16 v[128:131], a[44:47], a[0:3], v[128:131]
    ds_read_b64_tr_b16 a[104:105], v14 offset:8192
    v_mfma_f32_16x16x32_bf16 v[132:135], a[44:47], a[4:7], v[132:135]
    buffer_load_dwordx4 a[220:223], v19, s[8:11], 0 offen offset:320
    v_mfma_f32_16x16x32_bf16 v[136:139], a[44:47], a[8:11], v[136:139]
    ds_read_b64_tr_b16 a[106:107], v14 offset:9216
    v_mov_b32 v21, s89
    v_mfma_f32_16x16x32_bf16 v[140:143], a[44:47], a[12:15], v[140:143]
    s_or_b32 s83, s2, s36
    s_cselect_b32 s83, 0x7f000000, 0
    v_mfma_f32_16x16x32_bf16 v[144:147], a[44:47], a[16:19], v[144:147]
    ds_read_b64_tr_b16 a[108:109], v15 offset:8192
    v_mfma_f32_16x16x32_bf16 v[148:151], a[44:47], a[20:23], v[148:151]
    s_mov_b64 exec, 1
    buffer_store_dword v21, off, s[72:75], s83 sc1
    s_mov_b64 exec, -1
    v_mfma_f32_16x16x32_bf16 v[152:155], a[44:47], a[24:27], v[152:155]
    ds_read_b64_tr_b16 a[110:111], v15 offset:9216
    v_mfma_f32_16x16x32_bf16 v[156:159], a[44:47], a[28:31], v[156:159]
    buffer_load_dwordx4 a[172:175], v27, s[8:11], s101 offen offset:0
    v_mfma_f32_16x16x32_bf16 v[160:163], a[48:51], a[0:3], v[160:163]
    ds_read_b64_tr_b16 a[112:113], v12 offset:24576
    v_mfma_f32_16x16x32_bf16 v[164:167], a[48:51], a[4:7], v[164:167]
    buffer_load_dwordx4 a[176:179], v27, s[8:11], s101 offen offset:1024
    v_mfma_f32_16x16x32_bf16 v[168:171], a[48:51], a[8:11], v[168:171]
    ds_read_b64_tr_b16 a[114:115], v12 offset:25600
    v_mfma_f32_16x16x32_bf16 v[172:175], a[48:51], a[12:15], v[172:175]
    buffer_load_dwordx4 a[180:183], v27, s[8:11], s101 offen offset:2048
    v_mfma_f32_16x16x32_bf16 v[176:179], a[48:51], a[16:19], v[176:179]
    ds_read_b64_tr_b16 a[116:117], v13 offset:24576
    v_mfma_f32_16x16x32_bf16 v[180:183], a[48:51], a[20:23], v[180:183]
    buffer_load_dwordx4 a[184:187], v27, s[8:11], s101 offen offset:3072
    v_mfma_f32_16x16x32_bf16 v[184:187], a[48:51], a[24:27], v[184:187]
    ds_read_b64_tr_b16 a[118:119], v13 offset:25600
    v_mfma_f32_16x16x32_bf16 v[188:191], a[48:51], a[28:31], v[188:191]
    buffer_load_dwordx4 a[188:191], v27, s[28:31], 0 offen offset:0
    v_mfma_f32_16x16x32_bf16 v[192:195], a[52:55], a[0:3], v[192:195]
    ds_read_b64_tr_b16 a[120:121], v14 offset:24576
    v_mfma_f32_16x16x32_bf16 v[196:199], a[52:55], a[4:7], v[196:199]
    buffer_load_dwordx4 a[192:195], v27, s[28:31], 0 offen offset:1024
    v_mfma_f32_16x16x32_bf16 v[200:203], a[52:55], a[8:11], v[200:203]
    ds_read_b64_tr_b16 a[122:123], v14 offset:25600
    v_mfma_f32_16x16x32_bf16 v[204:207], a[52:55], a[12:15], v[204:207]
    v_mfma_f32_16x16x32_bf16 v[208:211], a[52:55], a[16:19], v[208:211]
    ds_read_b64_tr_b16 a[124:125], v16 offset:8192
    v_mfma_f32_16x16x32_bf16 v[212:215], a[52:55], a[20:23], v[212:215]
    v_mfma_f32_16x16x32_bf16 v[216:219], a[52:55], a[24:27], v[216:219]
    ds_read_b64_tr_b16 a[126:127], v16 offset:9216
    v_mfma_f32_16x16x32_bf16 v[220:223], a[52:55], a[28:31], v[220:223]
    v_mfma_f32_16x16x32_bf16 v[224:227], a[56:59], a[0:3], v[224:227]
    ds_read_b64_tr_b16 a[160:161], v17 offset:0
    v_mfma_f32_16x16x32_bf16 v[228:231], a[56:59], a[4:7], v[228:231]
    v_mfma_f32_16x16x32_bf16 v[232:235], a[56:59], a[8:11], v[232:235]
    ds_read_b64_tr_b16 a[162:163], v17 offset:128
    v_mfma_f32_16x16x32_bf16 v[236:239], a[56:59], a[12:15], v[236:239]
    v_mfma_f32_16x16x32_bf16 v[240:243], a[56:59], a[16:19], v[240:243]
    ds_read_b64_tr_b16 a[164:165], v17 offset:1024
    v_mfma_f32_16x16x32_bf16 v[244:247], a[56:59], a[20:23], v[244:247]
    v_mfma_f32_16x16x32_bf16 v[248:251], a[56:59], a[24:27], v[248:251]
    ds_read_b64_tr_b16 a[166:167], v17 offset:1152
    v_mfma_f32_16x16x32_bf16 v[252:255], a[56:59], a[28:31], v[252:255]
    v_mfma_f32_16x16x32_bf16 a[128:131], a[60:63], a[0:3], a[128:131]
    v_mfma_f32_16x16x32_bf16 a[132:135], a[60:63], a[4:7], a[132:135]
    v_xor_b32 v15, s50, v15
    v_mfma_f32_16x16x32_bf16 a[136:139], a[60:63], a[8:11], a[136:139]
    v_mfma_f32_16x16x32_bf16 a[140:143], a[60:63], a[12:15], a[140:143]
    v_xor_b32 v16, s50, v16
    v_mfma_f32_16x16x32_bf16 a[144:147], a[60:63], a[16:19], a[144:147]
    v_mfma_f32_16x16x32_bf16 a[148:151], a[60:63], a[20:23], a[148:151]
    v_mfma_f32_16x16x32_bf16 a[152:155], a[60:63], a[24:27], a[152:155]
    v_mfma_f32_16x16x32_bf16 a[156:159], a[60:63], a[28:31], a[156:159]
    s_waitcnt vmcnt(11) lgkmcnt(0)
    s_barrier
    s_add_u32 m0, s45, 0
    v_mfma_f32_16x16x32_bf16 v[32:35], a[96:99], a[64:67], v[32:35]
    buffer_load_dwordx4 v2, s[8:11], s40 offen offset:0 lds
    v_mfma_f32_16x16x32_bf16 v[36:39], a[96:99], a[68:71], v[36:39]
    ds_read_b64_tr_b16 a[32:33], v12 offset:32768
    v_mfma_f32_16x16x32_bf16 v[40:43], a[96:99], a[72:75], v[40:43]
    v_mfma_f32_16x16x32_bf16 v[44:47], a[96:99], a[76:79], v[44:47]
    ds_read_b64_tr_b16 a[34:35], v12 offset:33792
    v_mfma_f32_16x16x32_bf16 v[48:51], a[96:99], a[80:83], v[48:51]
    buffer_load_dwordx4 v3, s[8:11], s40 offen offset:1024 lds
    v_mfma_f32_16x16x32_bf16 v[52:55], a[96:99], a[84:87], v[52:55]
    ds_read_b128 a[0:3], v10 offset:32768
    v_mfma_f32_16x16x32_bf16 v[56:59], a[96:99], a[88:91], v[56:59]
    v_mfma_f32_16x16x32_bf16 v[60:63], a[96:99], a[92:95], v[60:63]
    ds_read_b128 a[4:7], v10 offset:34816
    v_mfma_f32_16x16x32_bf16 v[64:67], a[100:103], a[64:67], v[64:67]
    v_mfma_f32_16x16x32_bf16 v[68:71], a[100:103], a[68:71], v[68:71]
    ds_read_b128 a[8:11], v10 offset:36864
    v_mfma_f32_16x16x32_bf16 v[72:75], a[100:103], a[72:75], v[72:75]
    buffer_load_dwordx4 v4, s[8:11], s40 offen offset:2048 lds
    v_mfma_f32_16x16x32_bf16 v[76:79], a[100:103], a[76:79], v[76:79]
    ds_read_b128 a[12:15], v10 offset:38912
    v_mfma_f32_16x16x32_bf16 v[80:83], a[100:103], a[80:83], v[80:83]
    v_mfma_f32_16x16x32_bf16 v[84:87], a[100:103], a[84:87], v[84:87]
    ds_read_b128 a[16:19], v10 offset:40960
    v_mfma_f32_16x16x32_bf16 v[88:91], a[100:103], a[88:91], v[88:91]
    buffer_load_dwordx4 v5, s[8:11], s40 offen offset:3072 lds
    v_mfma_f32_16x16x32_bf16 v[92:95], a[100:103], a[92:95], v[92:95]
    ds_read_b128 a[20:23], v10 offset:43008
    v_mfma_f32_16x16x32_bf16 v[96:99], a[104:107], a[64:67], v[96:99]
    v_mfma_f32_16x16x32_bf16 v[100:103], a[104:107], a[68:71], v[100:103]
    ds_read_b128 a[24:27], v10 offset:45056
    v_mfma_f32_16x16x32_bf16 v[104:107], a[104:107], a[72:75], v[104:107]
    v_mfma_f32_16x16x32_bf16 v[108:111], a[104:107], a[76:79], v[108:111]
    s_add_u32 m0, s45, 4096
    ds_read_b128 a[28:31], v10 offset:47104
    v_mfma_f32_16x16x32_bf16 v[112:115], a[104:107], a[80:83], v[112:115]
    buffer_load_dwordx4 v2, s[8:11], s41 offen offset:0 lds
    v_mfma_f32_16x16x32_bf16 v[116:119], a[104:107], a[84:87], v[116:119]
    ds_read_b64_tr_b16 a[36:37], v13 offset:32768
    v_mfma_f32_16x16x32_bf16 v[120:123], a[104:107], a[88:91], v[120:123]
    v_mfma_f32_16x16x32_bf16 v[124:127], a[104:107], a[92:95], v[124:127]
    ds_read_b64_tr_b16 a[38:39], v13 offset:33792
    v_mfma_f32_16x16x32_bf16 v[128:131], a[108:111], a[64:67], v[128:131]
    buffer_load_dwordx4 v3, s[8:11], s41 offen offset:1024 lds
    v_mfma_f32_16x16x32_bf16 v[132:135], a[108:111], a[68:71], v[132:135]
    ds_read_b64_tr_b16 a[40:41], v14 offset:32768
    v_mfma_f32_16x16x32_bf16 v[136:139], a[108:111], a[72:75], v[136:139]
    v_mfma_f32_16x16x32_bf16 v[140:143], a[108:111], a[76:79], v[140:143]
    ds_read_b64_tr_b16 a[42:43], v14 offset:33792
    v_mfma_f32_16x16x32_bf16 v[144:147], a[108:111], a[80:83], v[144:147]
    buffer_load_dwordx4 v4, s[8:11], s41 offen offset:2048 lds
    v_mfma_f32_16x16x32_bf16 v[148:151], a[108:111], a[84:87], v[148:151]
    ds_read_b64_tr_b16 a[44:45], v15 offset:0
    v_mfma_f32_16x16x32_bf16 a[168:171], a[208:211], a[160:163], 0
    v_mfma_f32_16x16x32_bf16 v[152:155], a[108:111], a[88:91], v[152:155]
    ds_read_b64_tr_b16 a[46:47], v15 offset:1024
    v_mfma_f32_16x16x32_bf16 v[156:159], a[108:111], a[92:95], v[156:159]
    v_mfma_f32_16x16x32_bf16 v[160:163], a[112:115], a[64:67], v[160:163]
    ds_read_b64_tr_b16 a[48:49], v12 offset:49152
    v_mfma_f32_16x16x32_bf16 v[164:167], a[112:115], a[68:71], v[164:167]
    buffer_load_dwordx4 v5, s[8:11], s41 offen offset:3072 lds
    v_mfma_f32_16x16x32_bf16 v[168:171], a[112:115], a[72:75], v[168:171]
    ds_read_b64_tr_b16 a[50:51], v12 offset:50176
    v_mfma_f32_16x16x32_bf16 v[172:175], a[112:115], a[76:79], v[172:175]
    s_add_u32 s40, s40, 128
    s_add_u32 s41, s41, 128
    v_mfma_f32_16x16x32_bf16 v[176:179], a[112:115], a[80:83], v[176:179]
    s_add_u32 m0, s46, 0
    ds_read_b64_tr_b16 a[52:53], v13 offset:49152
    v_mfma_f32_16x16x32_bf16 v[180:183], a[112:115], a[84:87], v[180:183]
    buffer_load_dwordx4 v6, s[12:15], s42 offen offset:0 lds
    v_mfma_f32_16x16x32_bf16 v[184:187], a[112:115], a[88:91], v[184:187]
    ds_read_b64_tr_b16 a[54:55], v13 offset:50176
    v_mfma_f32_16x16x32_bf16 v[188:191], a[112:115], a[92:95], v[188:191]
    v_mfma_f32_16x16x32_bf16 v[192:195], a[116:119], a[64:67], v[192:195]
    ds_read_b64_tr_b16 a[56:57], v14 offset:49152
    v_mfma_f32_16x16x32_bf16 v[196:199], a[116:119], a[68:71], v[196:199]
    buffer_load_dwordx4 v7, s[12:15], s42 offen offset:1024 lds
    v_mfma_f32_16x16x32_bf16 v[200:203], a[116:119], a[72:75], v[200:203]
    ds_read_b64_tr_b16 a[58:59], v14 offset:50176
    v_mfma_f32_16x16x32_bf16 v[204:207], a[116:119], a[76:79], v[204:207]
    v_mfma_f32_16x16x32_bf16 v[208:211], a[116:119], a[80:83], v[208:211]
    ds_read_b64_tr_b16 a[60:61], v16 offset:0
    v_mfma_f32_16x16x32_bf16 v[212:215], a[116:119], a[84:87], v[212:215]
    v_mfma_f32_16x16x32_bf16 v[216:219], a[116:119], a[88:91], v[216:219]
    ds_read_b64_tr_b16 a[62:63], v16 offset:1024
    v_mfma_f32_16x16x32_bf16 v[220:223], a[116:119], a[92:95], v[220:223]
    buffer_load_dwordx4 v8, s[12:15], s42 offen offset:2048 lds
    v_mfma_f32_16x16x32_bf16 v[224:227], a[120:123], a[64:67], v[224:227]
    v_mfma_f32_16x16x32_bf16 a[168:171], a[212:215], a[164:167], a[168:171]
    v_mfma_f32_16x16x32_bf16 v[228:231], a[120:123], a[68:71], v[228:231]
    v_mfma_f32_16x16x32_bf16 v[232:235], a[120:123], a[72:75], v[232:235]
    buffer_load_dwordx4 v9, s[12:15], s42 offen offset:3072 lds
    v_mfma_f32_16x16x32_bf16 v[236:239], a[120:123], a[76:79], v[236:239]
    v_mfma_f32_16x16x32_bf16 v[240:243], a[120:123], a[80:83], v[240:243]
    v_mfma_f32_16x16x32_bf16 v[244:247], a[120:123], a[84:87], v[244:247]
    v_mfma_f32_16x16x32_bf16 v[248:251], a[120:123], a[88:91], v[248:251]
    v_mfma_f32_16x16x32_bf16 v[252:255], a[120:123], a[92:95], v[252:255]
    s_add_u32 m0, s46, 16384
    v_mfma_f32_16x16x32_bf16 a[128:131], a[124:127], a[64:67], a[128:131]
    buffer_load_dwordx4 v6, s[16:19], s42 offen offset:0 lds
    v_mfma_f32_16x16x32_bf16 a[132:135], a[124:127], a[68:71], a[132:135]
    v_mfma_f32_16x16x32_bf16 a[136:139], a[124:127], a[72:75], a[136:139]
    v_mfma_f32_16x16x32_bf16 a[140:143], a[124:127], a[76:79], a[140:143]
    v_mfma_f32_16x16x32_bf16 a[144:147], a[124:127], a[80:83], a[144:147]
    v_mfma_f32_16x16x32_bf16 a[148:151], a[124:127], a[84:87], a[148:151]
    v_mfma_f32_16x16x32_bf16 a[152:155], a[124:127], a[88:91], a[152:155]
    v_mfma_f32_16x16x32_bf16 a[156:159], a[124:127], a[92:95], a[156:159]
    s_waitcnt lgkmcnt(0)
    v_mfma_f32_16x16x32_bf16 v[32:35], a[32:35], a[0:3], v[32:35]
    ds_read_b64_tr_b16 a[96:97], v12 offset:40960
    v_mfma_f32_16x16x32_bf16 v[36:39], a[32:35], a[4:7], v[36:39]
    buffer_load_dwordx4 v7, s[16:19], s42 offen offset:1024 lds
    v_mfma_f32_16x16x32_bf16 v[40:43], a[32:35], a[8:11], v[40:43]
    ds_read_b64_tr_b16 a[98:99], v12 offset:41984
    v_mfma_f32_16x16x32_bf16 v[44:47], a[32:35], a[12:15], v[44:47]
    v_mfma_f32_16x16x32_bf16 v[48:51], a[32:35], a[16:19], v[48:51]
    ds_read_b128 a[64:67], v11 offset:32768
    v_mfma_f32_16x16x32_bf16 v[52:55], a[32:35], a[20:23], v[52:55]
    buffer_load_dwordx4 v8, s[16:19], s42 offen offset:2048 lds
    v_mfma_f32_16x16x32_bf16 v[56:59], a[32:35], a[24:27], v[56:59]
    ds_read_b128 a[68:71], v11 offset:34816
    v_mfma_f32_16x16x32_bf16 v[60:63], a[32:35], a[28:31], v[60:63]
    v_mfma_f32_16x16x32_bf16 v[64:67], a[36:39], a[0:3], v[64:67]
    ds_read_b128 a[72:75], v11 offset:36864
    v_mfma_f32_16x16x32_bf16 v[68:71], a[36:39], a[4:7], v[68:71]
    buffer_load_dwordx4 v9, s[16:19], s42 offen offset:3072 lds
    v_mfma_f32_16x16x32_bf16 v[72:75], a[36:39], a[8:11], v[72:75]
    ds_read_b128 a[76:79], v11 offset:38912
    s_add_u32 s42, s42, 458752
    v_mfma_f32_16x16x32_bf16 v[76:79], a[36:39], a[12:15], v[76:79]
    v_mfma_f32_16x16x32_bf16 v[80:83], a[36:39], a[16:19], v[80:83]
    ds_read_b128 a[80:83], v11 offset:40960
    s_add_u32 m0, s56, 0
    v_mfma_f32_16x16x32_bf16 v[84:87], a[36:39], a[20:23], v[84:87]
    buffer_load_dwordx4 v0, s[4:7], s43 offen lds
    v_mfma_f32_16x16x32_bf16 v[88:91], a[36:39], a[24:27], v[88:91]
    ds_read_b128 a[84:87], v11 offset:43008
    s_add_u32 s43, s43, 0x20000
    v_mfma_f32_16x16x32_bf16 v[92:95], a[36:39], a[28:31], v[92:95]
    v_mfma_f32_16x16x32_bf16 v[96:99], a[40:43], a[0:3], v[96:99]
    ds_read_b128 a[88:91], v11 offset:45056
    s_add_u32 m0, s47, 0
    v_mfma_f32_16x16x32_bf16 v[100:103], a[40:43], a[4:7], v[100:103]
    buffer_load_dwordx4 v30, s[20:23], s39 offen lds
    v_mfma_f32_16x16x32_bf16 v[104:107], a[40:43], a[8:11], v[104:107]
    ds_read_b128 a[92:95], v11 offset:47104
    s_add_u32 s39, s39, 8192
    s_bitcmp1_b32 s58, 3
    s_cselect_b32 s60, s48, 0x7f000000
    v_mfma_f32_16x16x32_bf16 v[108:111], a[40:43], a[12:15], v[108:111]
    buffer_load_dword a255, v18, s[32:35], s60 offen
    v_mfma_f32_16x16x32_bf16 v[112:115], a[40:43], a[16:19], v[112:115]
    ds_read_b64_tr_b16 a[100:101], v13 offset:40960
    s_add_u32 s60, s60, s59
    s_add_u32 s48, s48, s49
    v_mfma_f32_16x16x32_bf16 v[116:119], a[40:43], a[20:23], v[116:119]
    buffer_load_dword a255, v18, s[32:35], s60 offen
    v_mfma_f32_16x16x32_bf16 v[120:123], a[40:43], a[24:27], v[120:123]
    ds_read_b64_tr_b16 a[102:103], v13 offset:41984
    v_mfma_f32_16x16x32_bf16 v[124:127], a[40:43], a[28:31], v[124:127]
    buffer_load_dwordx4 a[208:211], v19, s[8:11], 0 offen offset:512
    v_mfma_f32_16x16x32_bf16 v[128:131], a[44:47], a[0:3], v[128:131]
    ds_read_b64_tr_b16 a[104:105], v14 offset:40960
    v_mfma_f32_16x16x32_bf16 v[132:135], a[44:47], a[4:7], v[132:135]
    buffer_load_dwordx4 a[212:215], v19, s[8:11], 0 offen offset:576
    v_mfma_f32_16x16x32_bf16 v[136:139], a[44:47], a[8:11], v[136:139]
    ds_read_b64_tr_b16 a[106:107], v14 offset:41984
    v_mfma_f32_16x16x32_bf16 v[140:143], a[44:47], a[12:15], v[140:143]
    v_mfma_f32_16x16x32_bf16 v[144:147], a[44:47], a[16:19], v[144:147]
    ds_read_b64_tr_b16 a[108:109], v15 offset:8192
    v_mfma_f32_16x16x32_bf16 v[148:151], a[44:47], a[20:23], v[148:151]
    v_mfma_f32_16x16x32_bf16 v[152:155], a[44:47], a[24:27], v[152:155]
    ds_read_b64_tr_b16 a[110:111], v15 offset:9216
    v_mfma_f32_16x16x32_bf16 v[156:159], a[44:47], a[28:31], v[156:159]
    v_mfma_f32_16x16x32_bf16 v[160:163], a[48:51], a[0:3], v[160:163]
    ds_read_b64_tr_b16 a[112:113], v12 offset:57344
    v_mfma_f32_16x16x32_bf16 v[164:167], a[48:51], a[4:7], v[164:167]
    v_mfma_f32_16x16x32_bf16 v[168:171], a[48:51], a[8:11], v[168:171]
    ds_read_b64_tr_b16 a[114:115], v12 offset:58368
    v_mfma_f32_16x16x32_bf16 v[172:175], a[48:51], a[12:15], v[172:175]
    v_mfma_f32_16x16x32_bf16 v[176:179], a[48:51], a[16:19], v[176:179]
    ds_read_b64_tr_b16 a[116:117], v13 offset:57344
    v_mfma_f32_16x16x32_bf16 v[180:183], a[48:51], a[20:23], v[180:183]
    v_mfma_f32_16x16x32_bf16 v[184:187], a[48:51], a[24:27], v[184:187]
    ds_read_b64_tr_b16 a[118:119], v13 offset:58368
    v_mfma_f32_16x16x32_bf16 v[188:191], a[48:51], a[28:31], v[188:191]
    v_mfma_f32_16x16x32_bf16 v[192:195], a[52:55], a[0:3], v[192:195]
    ds_read_b64_tr_b16 a[120:121], v14 offset:57344
    v_mfma_f32_16x16x32_bf16 v[196:199], a[52:55], a[4:7], v[196:199]
    v_mfma_f32_16x16x32_bf16 v[200:203], a[52:55], a[8:11], v[200:203]
    ds_read_b64_tr_b16 a[122:123], v14 offset:58368
    v_mfma_f32_16x16x32_bf16 v[204:207], a[52:55], a[12:15], v[204:207]
    v_mfma_f32_16x16x32_bf16 v[208:211], a[52:55], a[16:19], v[208:211]
    ds_read_b64_tr_b16 a[124:125], v16 offset:8192
    v_mfma_f32_16x16x32_bf16 v[212:215], a[52:55], a[20:23], v[212:215]
    v_mfma_f32_16x16x32_bf16 v[216:219], a[52:55], a[24:27], v[216:219]
    ds_read_b64_tr_b16 a[126:127], v16 offset:9216
    v_mfma_f32_16x16x32_bf16 v[220:223], a[52:55], a[28:31], v[220:223]
    v_mfma_f32_16x16x32_bf16 v[224:227], a[56:59], a[0:3], v[224:227]
    ds_read_b64_tr_b16 a[160:161], v17 offset:8192
    v_mfma_f32_16x16x32_bf16 v[228:231], a[56:59], a[4:7], v[228:231]
    v_mfma_f32_16x16x32_bf16 v[232:235], a[56:59], a[8:11], v[232:235]
    ds_read_b64_tr_b16 a[162:163], v17 offset:8320
    v_mfma_f32_16x16x32_bf16 v[236:239], a[56:59], a[12:15], v[236:239]
    v_mfma_f32_16x16x32_bf16 v[240:243], a[56:59], a[16:19], v[240:243]
    ds_read_b64_tr_b16 a[164:165], v17 offset:9216
    v_mfma_f32_16x16x32_bf16 v[244:247], a[56:59], a[20:23], v[244:247]
    v_mfma_f32_16x16x32_bf16 v[248:251], a[56:59], a[24:27], v[248:251]
    ds_read_b64_tr_b16 a[166:167], v17 offset:9344
    v_mfma_f32_16x16x32_bf16 v[252:255], a[56:59], a[28:31], v[252:255]
    v_mfma_f32_16x16x32_bf16 a[128:131], a[60:63], a[0:3], a[128:131]
    v_mfma_f32_16x16x32_bf16 a[132:135], a[60:63], a[4:7], a[132:135]
    v_xor_b32 v15, s50, v15
    v_mfma_f32_16x16x32_bf16 a[136:139], a[60:63], a[8:11], a[136:139]
    v_mfma_f32_16x16x32_bf16 a[140:143], a[60:63], a[12:15], a[140:143]
    v_xor_b32 v16, s50, v16
    v_mfma_f32_16x16x32_bf16 a[144:147], a[60:63], a[16:19], a[144:147]
    v_mfma_f32_16x16x32_bf16 a[148:151], a[60:63], a[20:23], a[148:151]
    v_mfma_f32_16x16x32_bf16 a[152:155], a[60:63], a[24:27], a[152:155]
    v_mfma_f32_16x16x32_bf16 a[156:159], a[60:63], a[28:31], a[156:159]
    s_waitcnt vmcnt(4) lgkmcnt(0)
    s_barrier
    s_add_u32 m0, s45, 32768
    v_mfma_f32_16x16x32_bf16 v[32:35], a[96:99], a[64:67], v[32:35]
    buffer_load_dwordx4 v2, s[8:11], s40 offen offset:0 lds
    v_mfma_f32_16x16x32_bf16 v[36:39], a[96:99], a[68:71], v[36:39]
    ds_read_b64_tr_b16 a[32:33], v12 offset:0
    v_mfma_f32_16x16x32_bf16 v[40:43], a[96:99], a[72:75], v[40:43]
    v_mov_b32 v25, 0
    v_mfma_f32_16x16x32_bf16 v[44:47], a[96:99], a[76:79], v[44:47]
    ds_read_b64_tr_b16 a[34:35], v12 offset:1024
    v_mfma_f32_16x16x32_bf16 v[48:51], a[96:99], a[80:83], v[48:51]
    buffer_load_dwordx4 v3, s[8:11], s40 offen offset:1024 lds
    v_mfma_f32_16x16x32_bf16 v[52:55], a[96:99], a[84:87], v[52:55]
    ds_read_b128 a[0:3], v10 offset:0
    v_mfma_f32_16x16x32_bf16 v[56:59], a[96:99], a[88:91], v[56:59]
    v_mov_b32 v24, 0
    v_mfma_f32_16x16x32_bf16 v[60:63], a[96:99], a[92:95], v[60:63]
    ds_read_b128 a[4:7], v10 offset:2048
    v_mfma_f32_16x16x32_bf16 v[64:67], a[100:103], a[64:67], v[64:67]
    v_accvgpr_read_b32 v22, a188
    v_mfma_f32_16x16x32_bf16 v[68:71], a[100:103], a[68:71], v[68:71]
    ds_read_b128 a[8:11], v10 offset:4096
    v_mfma_f32_16x16x32_bf16 v[72:75], a[100:103], a[72:75], v[72:75]
    buffer_load_dwordx4 v4, s[8:11], s40 offen offset:2048 lds
    v_mfma_f32_16x16x32_bf16 v[76:79], a[100:103], a[76:79], v[76:79]
    ds_read_b128 a[12:15], v10 offset:6144
    v_mfma_f32_16x16x32_bf16 v[80:83], a[100:103], a[80:83], v[80:83]
    v_lshlrev_b32 v1, 16, v22
    v_mfma_f32_16x16x32_bf16 v[84:87], a[100:103], a[84:87], v[84:87]
    ds_read_b128 a[16:19], v10 offset:8192
    v_mfma_f32_16x16x32_bf16 v[88:91], a[100:103], a[88:91], v[88:91]
    buffer_load_dwordx4 v5, s[8:11], s40 offen offset:3072 lds
    v_mfma_f32_16x16x32_bf16 v[92:95], a[100:103], a[92:95], v[92:95]
    ds_read_b128 a[20:23], v10 offset:10240
    v_mfma_f32_16x16x32_bf16 v[96:99], a[104:107], a[64:67], v[96:99]
    v_and_b32 v22, 0xffff0000, v22
    v_mfma_f32_16x16x32_bf16 v[100:103], a[104:107], a[68:71], v[100:103]
    ds_read_b128 a[24:27], v10 offset:12288
    v_mfma_f32_16x16x32_bf16 v[104:107], a[104:107], a[72:75], v[104:107]
    v_accvgpr_read_b32 v21, a172
    v_mfma_f32_16x16x32_bf16 v[108:111], a[104:107], a[76:79], v[108:111]
    s_add_u32 m0, s45, 36864
    ds_read_b128 a[28:31], v10 offset:14336
    v_mfma_f32_16x16x32_bf16 v[112:115], a[104:107], a[80:83], v[112:115]
    buffer_load_dwordx4 v2, s[8:11], s41 offen offset:0 lds
    v_mfma_f32_16x16x32_bf16 v[116:119], a[104:107], a[84:87], v[116:119]
    ds_read_b64_tr_b16 a[36:37], v13 offset:0
    v_mfma_f32_16x16x32_bf16 v[120:123], a[104:107], a[88:91], v[120:123]
    v_lshlrev_b32 v23, 16, v21
    v_mfma_f32_16x16x32_bf16 v[124:127], a[104:107], a[92:95], v[124:127]
    ds_read_b64_tr_b16 a[38:39], v13 offset:1024
    v_mfma_f32_16x16x32_bf16 v[128:131], a[108:111], a[64:67], v[128:131]
    buffer_load_dwordx4 v3, s[8:11], s41 offen offset:1024 lds
    v_mfma_f32_16x16x32_bf16 v[132:135], a[108:111], a[68:71], v[132:135]
    ds_read_b64_tr_b16 a[40:41], v14 offset:0
    v_mfma_f32_16x16x32_bf16 v[136:139], a[108:111], a[72:75], v[136:139]
    v_and_b32 v21, 0xffff0000, v21
    v_mfma_f32_16x16x32_bf16 v[140:143], a[108:111], a[76:79], v[140:143]
    ds_read_b64_tr_b16 a[42:43], v14 offset:1024
    v_mfma_f32_16x16x32_bf16 v[144:147], a[108:111], a[80:83], v[144:147]
    buffer_load_dwordx4 v4, s[8:11], s41 offen offset:2048 lds
    v_mfma_f32_16x16x32_bf16 v[148:151], a[108:111], a[84:87], v[148:151]
    ds_read_b64_tr_b16 a[44:45], v15 offset:0
    v_mfma_f32_16x16x32_bf16 a[168:171], a[216:219], a[160:163], a[168:171]
    v_mul_f32 v23, v23, v1
    v_mfma_f32_16x16x32_bf16 v[152:155], a[108:111], a[88:91], v[152:155]
    ds_read_b64_tr_b16 a[46:47], v15 offset:1024
    v_mfma_f32_16x16x32_bf16 v[156:159], a[108:111], a[92:95], v[156:159]
    v_mul_f32 v21, v21, v22
    v_mfma_f32_16x16x32_bf16 v[160:163], a[112:115], a[64:67], v[160:163]
    ds_read_b64_tr_b16 a[48:49], v12 offset:16384
    v_mfma_f32_16x16x32_bf16 v[164:167], a[112:115], a[68:71], v[164:167]
    buffer_load_dwordx4 v5, s[8:11], s41 offen offset:3072 lds
    v_mfma_f32_16x16x32_bf16 v[168:171], a[112:115], a[72:75], v[168:171]
    ds_read_b64_tr_b16 a[50:51], v12 offset:17408
    v_mfma_f32_16x16x32_bf16 v[172:175], a[112:115], a[76:79], v[172:175]
    s_add_u32 s40, s40, 128
    s_add_u32 s41, s41, 128
    v_mfma_f32_16x16x32_bf16 v[176:179], a[112:115], a[80:83], v[176:179]
    s_add_u32 m0, s46, 32768
    ds_read_b64_tr_b16 a[52:53], v13 offset:16384
    v_mfma_f32_16x16x32_bf16 v[180:183], a[112:115], a[84:87], v[180:183]
    buffer_load_dwordx4 v6, s[12:15], s42 offen offset:0 lds
    v_mfma_f32_16x16x32_bf16 v[184:187], a[112:115], a[88:91], v[184:187]
    ds_read_b64_tr_b16 a[54:55], v13 offset:17408
    v_mfma_f32_16x16x32_bf16 v[188:191], a[112:115], a[92:95], v[188:191]
    v_cvt_pk_bf16_f32 v21, v23, v21
    v_mfma_f32_16x16x32_bf16 v[192:195], a[116:119], a[64:67], v[192:195]
    ds_read_b64_tr_b16 a[56:57], v14 offset:16384
    v_mfma_f32_16x16x32_bf16 v[196:199], a[116:119], a[68:71], v[196:199]
    buffer_load_dwordx4 v7, s[12:15], s42 offen offset:1024 lds
    v_mfma_f32_16x16x32_bf16 v[200:203], a[116:119], a[72:75], v[200:203]
    ds_read_b64_tr_b16 a[58:59], v14 offset:17408
    v_mfma_f32_16x16x32_bf16 v[204:207], a[116:119], a[76:79], v[204:207]
    v_lshlrev_b32 v23, 16, v21
    v_mfma_f32_16x16x32_bf16 v[208:211], a[116:119], a[80:83], v[208:211]
    ds_read_b64_tr_b16 a[60:61], v16 offset:0
    v_mfma_f32_16x16x32_bf16 v[212:215], a[116:119], a[84:87], v[212:215]
    v_and_b32 v21, 0xffff0000, v21
    v_mfma_f32_16x16x32_bf16 v[216:219], a[116:119], a[88:91], v[216:219]
    ds_read_b64_tr_b16 a[62:63], v16 offset:1024
    v_mfma_f32_16x16x32_bf16 v[220:223], a[116:119], a[92:95], v[220:223]
    buffer_load_dwordx4 v8, s[12:15], s42 offen offset:2048 lds
    v_mfma_f32_16x16x32_bf16 v[224:227], a[120:123], a[64:67], v[224:227]
    v_add_f32 v25, v25, v23
    v_mfma_f32_16x16x32_bf16 a[168:171], a[220:223], a[164:167], a[168:171]
    v_add_f32 v25, v25, v21
    v_mfma_f32_16x16x32_bf16 v[228:231], a[120:123], a[68:71], v[228:231]
    v_accvgpr_read_b32 v21, a180
    v_mfma_f32_16x16x32_bf16 v[232:235], a[120:123], a[72:75], v[232:235]
    buffer_load_dwordx4 v9, s[12:15], s42 offen offset:3072 lds
    v_mfma_f32_16x16x32_bf16 v[236:239], a[120:123], a[76:79], v[236:239]
    v_lshlrev_b32 v23, 16, v21
    v_mfma_f32_16x16x32_bf16 v[240:243], a[120:123], a[80:83], v[240:243]
    v_and_b32 v21, 0xffff0000, v21
    v_mfma_f32_16x16x32_bf16 v[244:247], a[120:123], a[84:87], v[244:247]
    v_mul_f32 v23, v23, v1
    v_mfma_f32_16x16x32_bf16 v[248:251], a[120:123], a[88:91], v[248:251]
    v_mul_f32 v21, v21, v22
    v_mfma_f32_16x16x32_bf16 v[252:255], a[120:123], a[92:95], v[252:255]
    s_add_u32 m0, s46, 49152
    v_mfma_f32_16x16x32_bf16 a[128:131], a[124:127], a[64:67], a[128:131]
    buffer_load_dwordx4 v6, s[16:19], s42 offen offset:0 lds
    v_mfma_f32_16x16x32_bf16 a[132:135], a[124:127], a[68:71], a[132:135]
    v_cvt_pk_bf16_f32 v21, v23, v21
    v_mfma_f32_16x16x32_bf16 a[136:139], a[124:127], a[72:75], a[136:139]
    v_lshlrev_b32 v23, 16, v21
    v_mfma_f32_16x16x32_bf16 a[140:143], a[124:127], a[76:79], a[140:143]
    v_and_b32 v21, 0xffff0000, v21
    v_mfma_f32_16x16x32_bf16 a[144:147], a[124:127], a[80:83], a[144:147]
    v_add_f32 v24, v24, v23
    v_mfma_f32_16x16x32_bf16 a[148:151], a[124:127], a[84:87], a[148:151]
    v_add_f32 v24, v24, v21
    v_mfma_f32_16x16x32_bf16 a[152:155], a[124:127], a[88:91], a[152:155]
    v_accvgpr_read_b32 v22, a189
    v_mfma_f32_16x16x32_bf16 a[156:159], a[124:127], a[92:95], a[156:159]
    v_lshlrev_b32 v1, 16, v22
    s_waitcnt lgkmcnt(0)
    v_mfma_f32_16x16x32_bf16 v[32:35], a[32:35], a[0:3], v[32:35]
    ds_read_b64_tr_b16 a[96:97], v12 offset:8192
    v_mfma_f32_16x16x32_bf16 v[36:39], a[32:35], a[4:7], v[36:39]
    buffer_load_dwordx4 v7, s[16:19], s42 offen offset:1024 lds
    v_mfma_f32_16x16x32_bf16 v[40:43], a[32:35], a[8:11], v[40:43]
    ds_read_b64_tr_b16 a[98:99], v12 offset:9216
    v_mfma_f32_16x16x32_bf16 v[44:47], a[32:35], a[12:15], v[44:47]
KM_PAD2:
    s_cbranch_execz KM_PAD6
    s_nop 0
    v_and_b32 v22, 0xffff0000, v22
    v_mfma_f32_16x16x32_bf16 v[48:51], a[32:35], a[16:19], v[48:51]
    ds_read_b128 a[64:67], v11 offset:0
    v_mfma_f32_16x16x32_bf16 v[52:55], a[32:35], a[20:23], v[52:55]
    buffer_load_dwordx4 v8, s[16:19], s42 offen offset:2048 lds
    v_mfma_f32_16x16x32_bf16 v[56:59], a[32:35], a[24:27], v[56:59]
    ds_read_b128 a[68:71], v11 offset:2048
    v_mfma_f32_16x16x32_bf16 v[60:63], a[32:35], a[28:31], v[60:63]
    v_accvgpr_read_b32 v21, a173
    v_mfma_f32_16x16x32_bf16 v[64:67], a[36:39], a[0:3], v[64:67]
    ds_read_b128 a[72:75], v11 offset:4096
    v_mfma_f32_16x16x32_bf16 v[68:71], a[36:39], a[4:7], v[68:71]
    buffer_load_dwordx4 v9, s[16:19], s42 offen offset:3072 lds
    v_mfma_f32_16x16x32_bf16 v[72:75], a[36:39], a[8:11], v[72:75]
    ds_read_b128 a[76:79], v11 offset:6144
    s_add_u32 s42, s42, 458752
    v_mfma_f32_16x16x32_bf16 v[76:79], a[36:39], a[12:15], v[76:79]
    v_lshlrev_b32 v23, 16, v21
    v_mfma_f32_16x16x32_bf16 v[80:83], a[36:39], a[16:19], v[80:83]
    ds_read_b128 a[80:83], v11 offset:8192
    s_add_u32 m0, s56, 2048
    v_mfma_f32_16x16x32_bf16 v[84:87], a[36:39], a[20:23], v[84:87]
    buffer_load_dwordx4 v0, s[4:7], s43 offen lds
    v_mfma_f32_16x16x32_bf16 v[88:91], a[36:39], a[24:27], v[88:91]
    ds_read_b128 a[84:87], v11 offset:10240
    s_add_u32 s43, s43, 0x20000
    v_mfma_f32_16x16x32_bf16 v[92:95], a[36:39], a[28:31], v[92:95]
    v_and_b32 v21, 0xffff0000, v21
    v_mfma_f32_16x16x32_bf16 v[96:99], a[40:43], a[0:3], v[96:99]
    ds_read_b128 a[88:91], v11 offset:12288
    s_add_u32 m0, s47, 8192
    v_mfma_f32_16x16x32_bf16 v[100:103], a[40:43], a[4:7], v[100:103]
    buffer_load_dwordx4 v30, s[20:23], s39 offen lds
    v_mfma_f32_16x16x32_bf16 v[104:107], a[40:43], a[8:11], v[104:107]
    ds_read_b128 a[92:95], v11 offset:14336
    s_add_u32 s39, s39, 8192
    s_bitcmp1_b32 s58, 4
    s_cselect_b32 s60, s48, 0x7f000000
    v_mfma_f32_16x16x32_bf16 v[108:111], a[40:43], a[12:15], v[108:111]
    buffer_load_dword a255, v18, s[32:35], s60 offen
    v_mfma_f32_16x16x32_bf16 v[112:115], a[40:43], a[16:19], v[112:115]
    ds_read_b64_tr_b16 a[100:101], v13 offset:8192
    s_add_u32 s60, s60, s59
    s_add_u32 s48, s48, s49
    v_mfma_f32_16x16x32_bf16 v[116:119], a[40:43], a[20:23], v[116:119]
    buffer_load_dword a255, v18, s[32:35], s60 offen
    v_mfma_f32_16x16x32_bf16 v[120:123], a[40:43], a[24:27], v[120:123]
    ds_read_b64_tr_b16 a[102:103], v13 offset:9216
    v_mfma_f32_16x16x32_bf16 v[124:127], a[40:43], a[28:31], v[124:127]
    buffer_load_dwordx4 a[216:219], v19, s[8:11], 0 offen offset:768
    v_mfma_f32_16x16x32_bf16 v[128:131], a[44:47], a[0:3], v[128:131]
    ds_read_b64_tr_b16 a[104:105], v14 offset:8192
    v_mfma_f32_16x16x32_bf16 v[132:135], a[44:47], a[4:7], v[132:135]
    buffer_load_dwordx4 a[220:223], v19, s[8:11], 0 offen offset:832
    v_mfma_f32_16x16x32_bf16 v[136:139], a[44:47], a[8:11], v[136:139]
    ds_read_b64_tr_b16 a[106:107], v14 offset:9216
    v_mfma_f32_16x16x32_bf16 v[140:143], a[44:47], a[12:15], v[140:143]
    v_mul_f32 v23, v23, v1
    v_mfma_f32_16x16x32_bf16 v[144:147], a[44:47], a[16:19], v[144:147]
    ds_read_b64_tr_b16 a[108:109], v15 offset:8192
    v_mfma_f32_16x16x32_bf16 v[148:151], a[44:47], a[20:23], v[148:151]
    v_mul_f32 v21, v21, v22
    v_mfma_f32_16x16x32_bf16 v[152:155], a[44:47], a[24:27], v[152:155]
    ds_read_b64_tr_b16 a[110:111], v15 offset:9216
    v_mfma_f32_16x16x32_bf16 v[156:159], a[44:47], a[28:31], v[156:159]
    v_cvt_pk_bf16_f32 v21, v23, v21
    v_mfma_f32_16x16x32_bf16 v[160:163], a[48:51], a[0:3], v[160:163]
    ds_read_b64_tr_b16 a[112:113], v12 offset:24576
    v_mfma_f32_16x16x32_bf16 v[164:167], a[48:51], a[4:7], v[164:167]
    v_lshlrev_b32 v23, 16, v21
    v_mfma_f32_16x16x32_bf16 v[168:171], a[48:51], a[8:11], v[168:171]
    ds_read_b64_tr_b16 a[114:115], v12 offset:25600
    v_mfma_f32_16x16x32_bf16 v[172:175], a[48:51], a[12:15], v[172:175]
    v_and_b32 v21, 0xffff0000, v21
    v_mfma_f32_16x16x32_bf16 v[176:179], a[48:51], a[16:19], v[176:179]
    ds_read_b64_tr_b16 a[116:117], v13 offset:24576
    v_mfma_f32_16x16x32_bf16 v[180:183], a[48:51], a[20:23], v[180:183]
    v_add_f32 v25, v25, v23
    v_mfma_f32_16x16x32_bf16 v[184:187], a[48:51], a[24:27], v[184:187]
    ds_read_b64_tr_b16 a[118:119], v13 offset:25600
    v_mfma_f32_16x16x32_bf16 v[188:191], a[48:51], a[28:31], v[188:191]
    v_add_f32 v25, v25, v21
    v_mfma_f32_16x16x32_bf16 v[192:195], a[52:55], a[0:3], v[192:195]
    ds_read_b64_tr_b16 a[120:121], v14 offset:24576
    v_mfma_f32_16x16x32_bf16 v[196:199], a[52:55], a[4:7], v[196:199]
    v_accvgpr_read_b32 v21, a181
    v_mfma_f32_16x16x32_bf16 v[200:203], a[52:55], a[8:11], v[200:203]
    ds_read_b64_tr_b16 a[122:123], v14 offset:25600
    v_mfma_f32_16x16x32_bf16 v[204:207], a[52:55], a[12:15], v[204:207]
    v_lshlrev_b32 v23, 16, v21
    v_mfma_f32_16x16x32_bf16 v[208:211], a[52:55], a[16:19], v[208:211]
    ds_read_b64_tr_b16 a[124:125], v16 offset:8192
    v_mfma_f32_16x16x32_bf16 v[212:215], a[52:55], a[20:23], v[212:215]
    v_and_b32 v21, 0xffff0000, v21
    v_mfma_f32_16x16x32_bf16 v[216:219], a[52:55], a[24:27], v[216:219]
    ds_read_b64_tr_b16 a[126:127], v16 offset:9216
    v_mfma_f32_16x16x32_bf16 v[220:223], a[52:55], a[28:31], v[220:223]
    v_mul_f32 v23, v23, v1
    v_mfma_f32_16x16x32_bf16 v[224:227], a[56:59], a[0:3], v[224:227]
    ds_read_b64_tr_b16 a[160:161], v17 offset:0
    v_mfma_f32_16x16x32_bf16 v[228:231], a[56:59], a[4:7], v[228:231]
    v_mul_f32 v21, v21, v22
    v_mfma_f32_16x16x32_bf16 v[232:235], a[56:59], a[8:11], v[232:235]
    ds_read_b64_tr_b16 a[162:163], v17 offset:128
    v_mfma_f32_16x16x32_bf16 v[236:239], a[56:59], a[12:15], v[236:239]
    v_cvt_pk_bf16_f32 v21, v23, v21
    v_mfma_f32_16x16x32_bf16 v[240:243], a[56:59], a[16:19], v[240:243]
    ds_read_b64_tr_b16 a[164:165], v17 offset:1024
    v_mfma_f32_16x16x32_bf16 v[244:247], a[56:59], a[20:23], v[244:247]
    v_lshlrev_b32 v23, 16, v21
    v_mfma_f32_16x16x32_bf16 v[248:251], a[56:59], a[24:27], v[248:251]
    ds_read_b64_tr_b16 a[166:167], v17 offset:1152
    v_mfma_f32_16x16x32_bf16 v[252:255], a[56:59], a[28:31], v[252:255]
    v_and_b32 v21, 0xffff0000, v21
    v_mfma_f32_16x16x32_bf16 a[128:131], a[60:63], a[0:3], a[128:131]
    v_add_f32 v24, v24, v23
    v_mfma_f32_16x16x32_bf16 a[132:135], a[60:63], a[4:7], a[132:135]
    v_xor_b32 v15, s50, v15
    v_mfma_f32_16x16x32_bf16 a[136:139], a[60:63], a[8:11], a[136:139]
    v_add_f32 v24, v24, v21
    v_mfma_f32_16x16x32_bf16 a[140:143], a[60:63], a[12:15], a[140:143]
    v_xor_b32 v16, s50, v16
    v_mfma_f32_16x16x32_bf16 a[144:147], a[60:63], a[16:19], a[144:147]
    v_accvgpr_read_b32 v22, a190
    v_mfma_f32_16x16x32_bf16 a[148:151], a[60:63], a[20:23], a[148:151]
    v_lshlrev_b32 v1, 16, v22
    v_mfma_f32_16x16x32_bf16 a[152:155], a[60:63], a[24:27], a[152:155]
    v_and_b32 v22, 0xffff0000, v22
    v_mfma_f32_16x16x32_bf16 a[156:159], a[60:63], a[28:31], a[156:159]
    v_accvgpr_read_b32 v21, a174
    s_waitcnt vmcnt(4) lgkmcnt(0)
    s_barrier
    s_add_u32 m0, s45, 0
    v_mfma_f32_16x16x32_bf16 v[32:35], a[96:99], a[64:67], v[32:35]
    buffer_load_dwordx4 v2, s[8:11], s40 offen offset:0 lds
    v_mfma_f32_16x16x32_bf16 v[36:39], a[96:99], a[68:71], v[36:39]
    ds_read_b64_tr_b16 a[32:33], v12 offset:32768
    v_mfma_f32_16x16x32_bf16 v[40:43], a[96:99], a[72:75], v[40:43]
    v_lshlrev_b32 v23, 16, v21
    v_mfma_f32_16x16x32_bf16 v[44:47], a[96:99], a[76:79], v[44:47]
    ds_read_b64_tr_b16 a[34:35], v12 offset:33792
    v_mfma_f32_16x16x32_bf16 v[48:51], a[96:99], a[80:83], v[48:51]
    buffer_load_dwordx4 v3, s[8:11], s40 offen offset:1024 lds
    v_mfma_f32_16x16x32_bf16 v[52:55], a[96:99], a[84:87], v[52:55]
    ds_read_b128 a[0:3], v10 offset:32768
    v_mfma_f32_16x16x32_bf16 v[56:59], a[96:99], a[88:91], v[56:59]
    v_and_b32 v21, 0xffff0000, v21
    v_mfma_f32_16x16x32_bf16 v[60:63], a[96:99], a[92:95], v[60:63]
    ds_read_b128 a[4:7], v10 offset:34816
    v_mfma_f32_16x16x32_bf16 v[64:67], a[100:103], a[64:67], v[64:67]
    v_mul_f32 v23, v23, v1
    v_mfma_f32_16x16x32_bf16 v[68:71], a[100:103], a[68:71], v[68:71]
    ds_read_b128 a[8:11], v10 offset:36864
    v_mfma_f32_16x16x32_bf16 v[72:75], a[100:103], a[72:75], v[72:75]
    buffer_load_dwordx4 v4, s[8:11], s40 offen offset:2048 lds
    v_mfma_f32_16x16x32_bf16 v[76:79], a[100:103], a[76:79], v[76:79]
    ds_read_b128 a[12:15], v10 offset:38912
    v_mfma_f32_16x16x32_bf16 v[80:83], a[100:103], a[80:83], v[80:83]
    v_mul_f32 v21, v21, v22
    v_mfma_f32_16x16x32_bf16 v[84:87], a[100:103], a[84:87], v[84:87]
    ds_read_b128 a[16:19], v10 offset:40960
    v_mfma_f32_16x16x32_bf16 v[88:91], a[100:103], a[88:91], v[88:91]
    buffer_load_dwordx4 v5, s[8:11], s40 offen offset:3072 lds
    v_mfma_f32_16x16x32_bf16 v[92:95], a[100:103], a[92:95], v[92:95]
    ds_read_b128 a[20:23], v10 offset:43008
    v_mfma_f32_16x16x32_bf16 v[96:99], a[104:107], a[64:67], v[96:99]
    v_cvt_pk_bf16_f32 v21, v23, v21
    v_mfma_f32_16x16x32_bf16 v[100:103], a[104:107], a[68:71], v[100:103]
    ds_read_b128 a[24:27], v10 offset:45056
    v_mfma_f32_16x16x32_bf16 v[104:107], a[104:107], a[72:75], v[104:107]
    v_lshlrev_b32 v23, 16, v21
    v_mfma_f32_16x16x32_bf16 v[108:111], a[104:107], a[76:79], v[108:111]
    s_add_u32 m0, s45, 4096
    ds_read_b128 a[28:31], v10 offset:47104
    v_mfma_f32_16x16x32_bf16 v[112:115], a[104:107], a[80:83], v[112:115]
    buffer_load_dwordx4 v2, s[8:11], s41 offen offset:0 lds
    v_mfma_f32_16x16x32_bf16 v[116:119], a[104:107], a[84:87], v[116:119]
    ds_read_b64_tr_b16 a[36:37], v13 offset:32768
    v_mfma_f32_16x16x32_bf16 v[120:123], a[104:107], a[88:91], v[120:123]
    v_and_b32 v21, 0xffff0000, v21
    v_mfma_f32_16x16x32_bf16 v[124:127], a[104:107], a[92:95], v[124:127]
    ds_read_b64_tr_b16 a[38:39], v13 offset:33792
    v_mfma_f32_16x16x32_bf16 v[128:131], a[108:111], a[64:67], v[128:131]
    buffer_load_dwordx4 v3, s[8:11], s41 offen offset:1024 lds
    v_mfma_f32_16x16x32_bf16 v[132:135], a[108:111], a[68:71], v[132:135]
    ds_read_b64_tr_b16 a[40:41], v14 offset:32768
    v_mfma_f32_16x16x32_bf16 v[136:139], a[108:111], a[72:75], v[136:139]
    v_add_f32 v25, v25, v23
    v_mfma_f32_16x16x32_bf16 v[140:143], a[108:111], a[76:79], v[140:143]
    ds_read_b64_tr_b16 a[42:43], v14 offset:33792
    v_mfma_f32_16x16x32_bf16 v[144:147], a[108:111], a[80:83], v[144:147]
    buffer_load_dwordx4 v4, s[8:11], s41 offen offset:2048 lds
    v_mfma_f32_16x16x32_bf16 v[148:151], a[108:111], a[84:87], v[148:151]
    ds_read_b64_tr_b16 a[44:45], v15 offset:0
    v_mfma_f32_16x16x32_bf16 a[168:171], a[208:211], a[160:163], a[168:171]
    v_add_f32 v25, v25, v21
    v_mfma_f32_16x16x32_bf16 v[152:155], a[108:111], a[88:91], v[152:155]
    ds_read_b64_tr_b16 a[46:47], v15 offset:1024
    v_mfma_f32_16x16x32_bf16 v[156:159], a[108:111], a[92:95], v[156:159]
    v_accvgpr_read_b32 v21, a182
    v_mfma_f32_16x16x32_bf16 v[160:163], a[112:115], a[64:67], v[160:163]
    ds_read_b64_tr_b16 a[48:49], v12 offset:49152
    v_mfma_f32_16x16x32_bf16 v[164:167], a[112:115], a[68:71], v[164:167]
    buffer_load_dwordx4 v5, s[8:11], s41 offen offset:3072 lds
    v_mfma_f32_16x16x32_bf16 v[168:171], a[112:115], a[72:75], v[168:171]
    ds_read_b64_tr_b16 a[50:51], v12 offset:50176
    v_mfma_f32_16x16x32_bf16 v[172:175], a[112:115], a[76:79], v[172:175]
    s_add_u32 s40, s40, 128
    s_add_u32 s41, s41, 128
    v_mfma_f32_16x16x32_bf16 v[176:179], a[112:115], a[80:83], v[176:179]
    s_add_u32 m0, s46, 0
    ds_read_b64_tr_b16 a[52:53], v13 offset:49152
    v_mfma_f32_16x16x32_bf16 v[180:183], a[112:115], a[84:87], v[180:183]
    buffer_load_dwordx4 v6, s[12:15], s42 offen offset:0 lds
    v_mfma_f32_16x16x32_bf16 v[184:187], a[112:115], a[88:91], v[184:187]
    ds_read_b64_tr_b16 a[54:55], v13 offset:50176
    v_mfma_f32_16x16x32_bf16 v[188:191], a[112:115], a[92:95], v[188:191]
    v_lshlrev_b32 v23, 16, v21
    v_mfma_f32_16x16x32_bf16 v[192:195], a[116:119], a[64:67], v[192:195]
    ds_read_b64_tr_b16 a[56:57], v14 offset:49152
    v_mfma_f32_16x16x32_bf16 v[196:199], a[116:119], a[68:71], v[196:199]
    buffer_load_dwordx4 v7, s[12:15], s42 offen offset:1024 lds
    v_mfma_f32_16x16x32_bf16 v[200:203], a[116:119], a[72:75], v[200:203]
    ds_read_b64_tr_b16 a[58:59], v14 offset:50176
    v_mfma_f32_16x16x32_bf16 v[204:207], a[116:119], a[76:79], v[204:207]
    v_and_b32 v21, 0xffff0000, v21
    v_mfma_f32_16x16x32_bf16 v[208:211], a[116:119], a[80:83], v[208:211]
    ds_read_b64_tr_b16 a[60:61], v16 offset:0
    v_mfma_f32_16x16x32_bf16 v[212:215], a[116:119], a[84:87], v[212:215]
    v_mul_f32 v23, v23, v1
    v_mfma_f32_16x16x32_bf16 v[216:219], a[116:119], a[88:91], v[216:219]
    ds_read_b64_tr_b16 a[62:63], v16 offset:1024
    v_mfma_f32_16x16x32_bf16 v[220:223], a[116:119], a[92:95], v[220:223]
    buffer_load_dwordx4 v8, s[12:15], s42 offen offset:2048 lds
    v_mfma_f32_16x16x32_bf16 v[224:227], a[120:123], a[64:67], v[224:227]
    v_mul_f32 v21, v21, v22
    v_mfma_f32_16x16x32_bf16 a[168:171], a[212:215], a[164:167], a[168:171]
    v_cvt_pk_bf16_f32 v21, v23, v21
    v_mfma_f32_16x16x32_bf16 v[228:231], a[120:123], a[68:71], v[228:231]
    v_lshlrev_b32 v23, 16, v21
    v_mfma_f32_16x16x32_bf16 v[232:235], a[120:123], a[72:75], v[232:235]
    buffer_load_dwordx4 v9, s[12:15], s42 offen offset:3072 lds
    v_mfma_f32_16x16x32_bf16 v[236:239], a[120:123], a[76:79], v[236:239]
    v_and_b32 v21, 0xffff0000, v21
    v_mfma_f32_16x16x32_bf16 v[240:243], a[120:123], a[80:83], v[240:243]
    v_add_f32 v24, v24, v23
    v_mfma_f32_16x16x32_bf16 v[244:247], a[120:123], a[84:87], v[244:247]
    v_add_f32 v24, v24, v21
    v_mfma_f32_16x16x32_bf16 v[248:251], a[120:123], a[88:91], v[248:251]
    v_accvgpr_read_b32 v22, a191
    v_mfma_f32_16x16x32_bf16 v[252:255], a[120:123], a[92:95], v[252:255]
    s_add_u32 m0, s46, 16384
    v_mfma_f32_16x16x32_bf16 a[128:131], a[124:127], a[64:67], a[128:131]
    buffer_load_dwordx4 v6, s[16:19], s42 offen offset:0 lds
    v_mfma_f32_16x16x32_bf16 a[132:135], a[124:127], a[68:71], a[132:135]
    v_lshlrev_b32 v1, 16, v22
    v_mfma_f32_16x16x32_bf16 a[136:139], a[124:127], a[72:75], a[136:139]
    v_and_b32 v22, 0xffff0000, v22
    v_mfma_f32_16x16x32_bf16 a[140:143], a[124:127], a[76:79], a[140:143]
    v_accvgpr_read_b32 v21, a175
    v_mfma_f32_16x16x32_bf16 a[144:147], a[124:127], a[80:83], a[144:147]
    v_lshlrev_b32 v23, 16, v21
    v_mfma_f32_16x16x32_bf16 a[148:151], a[124:127], a[84:87], a[148:151]
    v_and_b32 v21, 0xffff0000, v21
    v_mfma_f32_16x16x32_bf16 a[152:155], a[124:127], a[88:91], a[152:155]
    v_mul_f32 v23, v23, v1
    v_mfma_f32_16x16x32_bf16 a[156:159], a[124:127], a[92:95], a[156:159]
    v_mul_f32 v21, v21, v22
    s_waitcnt lgkmcnt(0)
    v_mfma_f32_16x16x32_bf16 v[32:35], a[32:35], a[0:3], v[32:35]
    ds_read_b64_tr_b16 a[96:97], v12 offset:40960
    v_mfma_f32_16x16x32_bf16 v[36:39], a[32:35], a[4:7], v[36:39]
    buffer_load_dwordx4 v7, s[16:19], s42 offen offset:1024 lds
    v_mfma_f32_16x16x32_bf16 v[40:43], a[32:35], a[8:11], v[40:43]
    ds_read_b64_tr_b16 a[98:99], v12 offset:41984
    v_mfma_f32_16x16x32_bf16 v[44:47], a[32:35], a[12:15], v[44:47]
    v_cvt_pk_bf16_f32 v21, v23, v21
    v_mfma_f32_16x16x32_bf16 v[48:51], a[32:35], a[16:19], v[48:51]
    ds_read_b128 a[64:67], v11 offset:32768
    v_mfma_f32_16x16x32_bf16 v[52:55], a[32:35], a[20:23], v[52:55]
    buffer_load_dwordx4 v8, s[16:19], s42 offen offset:2048 lds
    v_mfma_f32_16x16x32_bf16 v[56:59], a[32:35], a[24:27], v[56:59]
    ds_read_b128 a[68:71], v11 offset:34816
    v_mfma_f32_16x16x32_bf16 v[60:63], a[32:35], a[28:31], v[60:63]
    v_lshlrev_b32 v23, 16, v21
    v_mfma_f32_16x16x32_bf16 v[64:67], a[36:39], a[0:3], v[64:67]
    ds_read_b128 a[72:75], v11 offset:36864
    v_mfma_f32_16x16x32_bf16 v[68:71], a[36:39], a[4:7], v[68:71]
    buffer_load_dwordx4 v9, s[16:19], s42 offen offset:3072 lds
    v_mfma_f32_16x16x32_bf16 v[72:75], a[36:39], a[8:11], v[72:75]
    ds_read_b128 a[76:79], v11 offset:38912
    s_add_u32 s42, s42, 458752
    v_mfma_f32_16x16x32_bf16 v[76:79], a[36:39], a[12:15], v[76:79]
    v_and_b32 v21, 0xffff0000, v21
    v_mfma_f32_16x16x32_bf16 v[80:83], a[36:39], a[16:19], v[80:83]
    ds_read_b128 a[80:83], v11 offset:40960
    s_add_u32 m0, s56, 0
    v_mfma_f32_16x16x32_bf16 v[84:87], a[36:39], a[20:23], v[84:87]
    buffer_load_dwordx4 v0, s[4:7], s43 offen lds
    v_mfma_f32_16x16x32_bf16 v[88:91], a[36:39], a[24:27], v[88:91]
    ds_read_b128 a[84:87], v11 offset:43008
    s_add_u32 s43, s43, 0x20000
    v_mfma_f32_16x16x32_bf16 v[92:95], a[36:39], a[28:31], v[92:95]
    v_add_f32 v25, v25, v23
    v_mfma_f32_16x16x32_bf16 v[96:99], a[40:43], a[0:3], v[96:99]
    ds_read_b128 a[88:91], v11 offset:45056
    s_add_u32 m0, s47, 0
    v_mfma_f32_16x16x32_bf16 v[100:103], a[40:43], a[4:7], v[100:103]
    buffer_load_dwordx4 v30, s[20:23], s39 offen lds
    v_mfma_f32_16x16x32_bf16 v[104:107], a[40:43], a[8:11], v[104:107]
    ds_read_b128 a[92:95], v11 offset:47104
    s_add_u32 s39, s39, 8192
    s_bitcmp1_b32 s58, 5
    s_cselect_b32 s60, s48, 0x7f000000
    v_mfma_f32_16x16x32_bf16 v[108:111], a[40:43], a[12:15], v[108:111]
    buffer_load_dword a255, v18, s[32:35], s60 offen
    v_mfma_f32_16x16x32_bf16 v[112:115], a[40:43], a[16:19], v[112:115]
    ds_read_b64_tr_b16 a[100:101], v13 offset:40960
    s_add_u32 s60, s60, s59
    s_add_u32 s48, s48, s49
    v_mfma_f32_16x16x32_bf16 v[116:119], a[40:43], a[20:23], v[116:119]
    buffer_load_dword a255, v18, s[32:35], s60 offen
    v_mfma_f32_16x16x32_bf16 v[120:123], a[40:43], a[24:27], v[120:123]
    ds_read_b64_tr_b16 a[102:103], v13 offset:41984
    v_mfma_f32_16x16x32_bf16 v[124:127], a[40:43], a[28:31], v[124:127]
    buffer_load_dwordx4 a[208:211], v19, s[8:11], 0 offen offset:1024
    v_mfma_f32_16x16x32_bf16 v[128:131], a[44:47], a[0:3], v[128:131]
    ds_read_b64_tr_b16 a[104:105], v14 offset:40960
    v_mfma_f32_16x16x32_bf16 v[132:135], a[44:47], a[4:7], v[132:135]
    buffer_load_dwordx4 a[212:215], v19, s[8:11], 0 offen offset:1088
    v_mfma_f32_16x16x32_bf16 v[136:139], a[44:47], a[8:11], v[136:139]
    ds_read_b64_tr_b16 a[106:107], v14 offset:41984
    s_add_u32 m0, s51, 0
    v_mfma_f32_16x16x32_bf16 v[140:143], a[44:47], a[12:15], v[140:143]
    buffer_load_dwordx4 v29, s[52:55], s3 offen nt lds
    v_mfma_f32_16x16x32_bf16 v[144:147], a[44:47], a[16:19], v[144:147]
    ds_read_b64_tr_b16 a[108:109], v15 offset:8192
    s_add_u32 s3, s3, 65536
    v_mfma_f32_16x16x32_bf16 v[148:151], a[44:47], a[20:23], v[148:151]
    v_add_f32 v25, v25, v21
    v_mfma_f32_16x16x32_bf16 v[152:155], a[44:47], a[24:27], v[152:155]
    ds_read_b64_tr_b16 a[110:111], v15 offset:9216
    v_mfma_f32_16x16x32_bf16 v[156:159], a[44:47], a[28:31], v[156:159]
    v_accvgpr_read_b32 v21, a183
    v_mfma_f32_16x16x32_bf16 v[160:163], a[48:51], a[0:3], v[160:163]
    ds_read_b64_tr_b16 a[112:113], v12 offset:57344
    v_mfma_f32_16x16x32_bf16 v[164:167], a[48:51], a[4:7], v[164:167]
    v_lshlrev_b32 v23, 16, v21
    v_mfma_f32_16x16x32_bf16 v[168:171], a[48:51], a[8:11], v[168:171]
    ds_read_b64_tr_b16 a[114:115], v12 offset:58368
    v_mfma_f32_16x16x32_bf16 v[172:175], a[48:51], a[12:15], v[172:175]
    v_and_b32 v21, 0xffff0000, v21
    v_mfma_f32_16x16x32_bf16 v[176:179], a[48:51], a[16:19], v[176:179]
    ds_read_b64_tr_b16 a[116:117], v13 offset:57344
    v_mfma_f32_16x16x32_bf16 v[180:183], a[48:51], a[20:23], v[180:183]
    v_mul_f32 v23, v23, v1
    v_mfma_f32_16x16x32_bf16 v[184:187], a[48:51], a[24:27], v[184:187]
    ds_read_b64_tr_b16 a[118:119], v13 offset:58368
    v_mfma_f32_16x16x32_bf16 v[188:191], a[48:51], a[28:31], v[188:191]
    v_mul_f32 v21, v21, v22
    v_mfma_f32_16x16x32_bf16 v[192:195], a[52:55], a[0:3], v[192:195]
    ds_read_b64_tr_b16 a[120:121], v14 offset:57344
    v_mfma_f32_16x16x32_bf16 v[196:199], a[52:55], a[4:7], v[196:199]
    v_cvt_pk_bf16_f32 v21, v23, v21
    v_mfma_f32_16x16x32_bf16 v[200:203], a[52:55], a[8:11], v[200:203]
    ds_read_b64_tr_b16 a[122:123], v14 offset:58368
    v_mfma_f32_16x16x32_bf16 v[204:207], a[52:55], a[12:15], v[204:207]
    v_lshlrev_b32 v23, 16, v21
    v_mfma_f32_16x16x32_bf16 v[208:211], a[52:55], a[16:19], v[208:211]
    ds_read_b64_tr_b16 a[124:125], v16 offset:8192
    v_mfma_f32_16x16x32_bf16 v[212:215], a[52:55], a[20:23], v[212:215]
    v_and_b32 v21, 0xffff0000, v21
    v_mfma_f32_16x16x32_bf16 v[216:219], a[52:55], a[24:27], v[216:219]
    ds_read_b64_tr_b16 a[126:127], v16 offset:9216
    v_mfma_f32_16x16x32_bf16 v[220:223], a[52:55], a[28:31], v[220:223]
    v_add_f32 v24, v24, v23
    v_mfma_f32_16x16x32_bf16 v[224:227], a[56:59], a[0:3], v[224:227]
    ds_read_b64_tr_b16 a[160:161], v17 offset:8192
    v_mfma_f32_16x16x32_bf16 v[228:231], a[56:59], a[4:7], v[228:231]
    v_add_f32 v24, v24, v21
    v_mfma_f32_16x16x32_bf16 v[232:235], a[56:59], a[8:11], v[232:235]
    ds_read_b64_tr_b16 a[162:163], v17 offset:8320
    v_mfma_f32_16x16x32_bf16 v[236:239], a[56:59], a[12:15], v[236:239]
    v_accvgpr_read_b32 v22, a192
    v_mfma_f32_16x16x32_bf16 v[240:243], a[56:59], a[16:19], v[240:243]
    ds_read_b64_tr_b16 a[164:165], v17 offset:9216
    v_mfma_f32_16x16x32_bf16 v[244:247], a[56:59], a[20:23], v[244:247]
    v_lshlrev_b32 v1, 16, v22
    v_mfma_f32_16x16x32_bf16 v[248:251], a[56:59], a[24:27], v[248:251]
    ds_read_b64_tr_b16 a[166:167], v17 offset:9344
    v_mfma_f32_16x16x32_bf16 v[252:255], a[56:59], a[28:31], v[252:255]
    v_and_b32 v22, 0xffff0000, v22
    v_mfma_f32_16x16x32_bf16 a[128:131], a[60:63], a[0:3], a[128:131]
    v_accvgpr_read_b32 v21, a176
    v_mfma_f32_16x16x32_bf16 a[132:135], a[60:63], a[4:7], a[132:135]
    v_xor_b32 v15, s50, v15
    v_mfma_f32_16x16x32_bf16 a[136:139], a[60:63], a[8:11], a[136:139]
    v_lshlrev_b32 v23, 16, v21
    v_mfma_f32_16x16x32_bf16 a[140:143], a[60:63], a[12:15], a[140:143]
    v_xor_b32 v16, s50, v16
    v_mfma_f32_16x16x32_bf16 a[144:147], a[60:63], a[16:19], a[144:147]
    v_and_b32 v21, 0xffff0000, v21
    v_mfma_f32_16x16x32_bf16 a[148:151], a[60:63], a[20:23], a[148:151]
    v_mul_f32 v23, v23, v1
    v_mfma_f32_16x16x32_bf16 a[152:155], a[60:63], a[24:27], a[152:155]
    v_mul_f32 v21, v21, v22
    v_mfma_f32_16x16x32_bf16 a[156:159], a[60:63], a[28:31], a[156:159]
    v_cvt_pk_bf16_f32 v21, v23, v21
    s_waitcnt vmcnt(5) lgkmcnt(0)
    s_barrier
    s_add_u32 m0, s45, 32768
    v_mfma_f32_16x16x32_bf16 v[32:35], a[96:99], a[64:67], v[32:35]
    buffer_load_dwordx4 v2, s[8:11], s40 offen offset:0 lds
    v_mfma_f32_16x16x32_bf16 v[36:39], a[96:99], a[68:71], v[36:39]
    ds_read_b64_tr_b16 a[32:33], v12 offset:0
    v_mfma_f32_16x16x32_bf16 v[40:43], a[96:99], a[72:75], v[40:43]
    v_lshlrev_b32 v23, 16, v21
    v_mfma_f32_16x16x32_bf16 v[44:47], a[96:99], a[76:79], v[44:47]
    ds_read_b64_tr_b16 a[34:35], v12 offset:1024
    v_mfma_f32_16x16x32_bf16 v[48:51], a[96:99], a[80:83], v[48:51]
    buffer_load_dwordx4 v3, s[8:11], s40 offen offset:1024 lds
    v_mfma_f32_16x16x32_bf16 v[52:55], a[96:99], a[84:87], v[52:55]
    ds_read_b128 a[0:3], v10 offset:0
    v_mfma_f32_16x16x32_bf16 v[56:59], a[96:99], a[88:91], v[56:59]
    v_and_b32 v21, 0xffff0000, v21
    v_mfma_f32_16x16x32_bf16 v[60:63], a[96:99], a[92:95], v[60:63]
    ds_read_b128 a[4:7], v10 offset:2048
    v_mfma_f32_16x16x32_bf16 v[64:67], a[100:103], a[64:67], v[64:67]
    v_add_f32 v25, v25, v23
    v_mfma_f32_16x16x32_bf16 v[68:71], a[100:103], a[68:71], v[68:71]
    ds_read_b128 a[8:11], v10 offset:4096
    v_mfma_f32_16x16x32_bf16 v[72:75], a[100:103], a[72:75], v[72:75]
    buffer_load_dwordx4 v4, s[8:11], s40 offen offset:2048 lds
    v_mfma_f32_16x16x32_bf16 v[76:79], a[100:103], a[76:79], v[76:79]
    ds_read_b128 a[12:15], v10 offset:6144
    v_mfma_f32_16x16x32_bf16 v[80:83], a[100:103], a[80:83], v[80:83]
    v_add_f32 v25, v25, v21
    v_mfma_f32_16x16x32_bf16 v[84:87], a[100:103], a[84:87], v[84:87]
    ds_read_b128 a[16:19], v10 offset:8192
    v_mfma_f32_16x16x32_bf16 v[88:91], a[100:103], a[88:91], v[88:91]
    buffer_load_dwordx4 v5, s[8:11], s40 offen offset:3072 lds
    v_mfma_f32_16x16x32_bf16 v[92:95], a[100:103], a[92:95], v[92:95]
    ds_read_b128 a[20:23], v10 offset:10240
    v_mfma_f32_16x16x32_bf16 v[96:99], a[104:107], a[64:67], v[96:99]
    v_accvgpr_read_b32 v21, a184
    v_mfma_f32_16x16x32_bf16 v[100:103], a[104:107], a[68:71], v[100:103]
    ds_read_b128 a[24:27], v10 offset:12288
    v_mfma_f32_16x16x32_bf16 v[104:107], a[104:107], a[72:75], v[104:107]
    v_lshlrev_b32 v23, 16, v21
    v_mfma_f32_16x16x32_bf16 v[108:111], a[104:107], a[76:79], v[108:111]
    s_add_u32 m0, s45, 36864
    ds_read_b128 a[28:31], v10 offset:14336
    v_mfma_f32_16x16x32_bf16 v[112:115], a[104:107], a[80:83], v[112:115]
    buffer_load_dwordx4 v2, s[8:11], s41 offen offset:0 lds
    v_mfma_f32_16x16x32_bf16 v[116:119], a[104:107], a[84:87], v[116:119]
    ds_read_b64_tr_b16 a[36:37], v13 offset:0
    v_mfma_f32_16x16x32_bf16 v[120:123], a[104:107], a[88:91], v[120:123]
    v_and_b32 v21, 0xffff0000, v21
    v_mfma_f32_16x16x32_bf16 v[124:127], a[104:107], a[92:95], v[124:127]
    ds_read_b64_tr_b16 a[38:39], v13 offset:1024
    v_mfma_f32_16x16x32_bf16 v[128:131], a[108:111], a[64:67], v[128:131]
    buffer_load_dwordx4 v3, s[8:11], s41 offen offset:1024 lds
    v_mfma_f32_16x16x32_bf16 v[132:135], a[108:111], a[68:71], v[132:135]
    ds_read_b64_tr_b16 a[40:41], v14 offset:0
    v_mfma_f32_16x16x32_bf16 v[136:139], a[108:111], a[72:75], v[136:139]
    v_mul_f32 v23, v23, v1
    v_mfma_f32_16x16x32_bf16 v[140:143], a[108:111], a[76:79], v[140:143]
    ds_read_b64_tr_b16 a[42:43], v14 offset:1024
    v_mfma_f32_16x16x32_bf16 v[144:147], a[108:111], a[80:83], v[144:147]
    buffer_load_dwordx4 v4, s[8:11], s41 offen offset:2048 lds
    v_mfma_f32_16x16x32_bf16 v[148:151], a[108:111], a[84:87], v[148:151]
    ds_read_b64_tr_b16 a[44:45], v15 offset:0
    v_mfma_f32_16x16x32_bf16 a[168:171], a[216:219], a[160:163], a[168:171]
    v_mul_f32 v21, v21, v22
    v_mfma_f32_16x16x32_bf16 v[152:155], a[108:111], a[88:91], v[152:155]
    ds_read_b64_tr_b16 a[46:47], v15 offset:1024
    v_mfma_f32_16x16x32_bf16 v[156:159], a[108:111], a[92:95], v[156:159]
    v_cvt_pk_bf16_f32 v21, v23, v21
    v_mfma_f32_16x16x32_bf16 v[160:163], a[112:115], a[64:67], v[160:163]
    ds_read_b64_tr_b16 a[48:49], v12 offset:16384
    v_mfma_f32_16x16x32_bf16 v[164:167], a[112:115], a[68:71], v[164:167]
    buffer_load_dwordx4 v5, s[8:11], s41 offen offset:3072 lds
    v_mfma_f32_16x16x32_bf16 v[168:171], a[112:115], a[72:75], v[168:171]
    ds_read_b64_tr_b16 a[50:51], v12 offset:17408
    v_mfma_f32_16x16x32_bf16 v[172:175], a[112:115], a[76:79], v[172:175]
    s_add_u32 s40, s40, 128
    s_add_u32 s41, s41, 128
    v_mfma_f32_16x16x32_bf16 v[176:179], a[112:115], a[80:83], v[176:179]
    s_add_u32 m0, s46, 32768
    ds_read_b64_tr_b16 a[52:53], v13 offset:16384
    v_mfma_f32_16x16x32_bf16 v[180:183], a[112:115], a[84:87], v[180:183]
    buffer_load_dwordx4 v6, s[12:15], s42 offen offset:0 lds
    v_mfma_f32_16x16x32_bf16 v[184:187], a[112:115], a[88:91], v[184:187]
    ds_read_b64_tr_b16 a[54:55], v13 offset:17408
    v_mfma_f32_16x16x32_bf16 v[188:191], a[112:115], a[92:95], v[188:191]
    v_lshlrev_b32 v23, 16, v21
    v_mfma_f32_16x16x32_bf16 v[192:195], a[116:119], a[64:67], v[192:195]
    ds_read_b64_tr_b16 a[56:57], v14 offset:16384
    v_mfma_f32_16x16x32_bf16 v[196:199], a[116:119], a[68:71], v[196:199]
    buffer_load_dwordx4 v7, s[12:15], s42 offen offset:1024 lds
    v_mfma_f32_16x16x32_bf16 v[200:203], a[116:119], a[72:75], v[200:203]
    ds_read_b64_tr_b16 a[58:59], v14 offset:17408
    v_mfma_f32_16x16x32_bf16 v[204:207], a[116:119], a[76:79], v[204:207]
    v_and_b32 v21, 0xffff0000, v21
    v_mfma_f32_16x16x32_bf16 v[208:211], a[116:119], a[80:83], v[208:211]
    ds_read_b64_tr_b16 a[60:61], v16 offset:0
    v_mfma_f32_16x16x32_bf16 v[212:215], a[116:119], a[84:87], v[212:215]
    v_add_f32 v24, v24, v23
    v_mfma_f32_16x16x32_bf16 v[216:219], a[116:119], a[88:91], v[216:219]
    ds_read_b64_tr_b16 a[62:63], v16 offset:1024
    v_mfma_f32_16x16x32_bf16 v[220:223], a[116:119], a[92:95], v[220:223]
    buffer_load_dwordx4 v8, s[12:15], s42 offen offset:2048 lds
    v_mfma_f32_16x16x32_bf16 v[224:227], a[120:123], a[64:67], v[224:227]
    v_add_f32 v24, v24, v21
    v_mfma_f32_16x16x32_bf16 a[168:171], a[220:223], a[164:167], a[168:171]
    v_accvgpr_read_b32 v22, a193
    v_mfma_f32_16x16x32_bf16 v[228:231], a[120:123], a[68:71], v[228:231]
    v_lshlrev_b32 v1, 16, v22
    v_mfma_f32_16x16x32_bf16 v[232:235], a[120:123], a[72:75], v[232:235]
    buffer_load_dwordx4 v9, s[12:15], s42 offen offset:3072 lds
    v_mfma_f32_16x16x32_bf16 v[236:239], a[120:123], a[76:79], v[236:239]
    v_and_b32 v22, 0xffff0000, v22
    v_mfma_f32_16x16x32_bf16 v[240:243], a[120:123], a[80:83], v[240:243]
    v_accvgpr_read_b32 v21, a177
    v_mfma_f32_16x16x32_bf16 v[244:247], a[120:123], a[84:87], v[244:247]
    v_lshlrev_b32 v23, 16, v21
    v_mfma_f32_16x16x32_bf16 v[248:251], a[120:123], a[88:91], v[248:251]
    v_and_b32 v21, 0xffff0000, v21
    v_mfma_f32_16x16x32_bf16 v[252:255], a[120:123], a[92:95], v[252:255]
    s_add_u32 m0, s46, 49152
    v_mfma_f32_16x16x32_bf16 a[128:131], a[124:127], a[64:67], a[128:131]
    buffer_load_dwordx4 v6, s[16:19], s42 offen offset:0 lds
    v_mfma_f32_16x16x32_bf16 a[132:135], a[124:127], a[68:71], a[132:135]
    v_mul_f32 v23, v23, v1
    v_mfma_f32_16x16x32_bf16 a[136:139], a[124:127], a[72:75], a[136:139]
    v_mul_f32 v21, v21, v22
    v_mfma_f32_16x16x32_bf16 a[140:143], a[124:127], a[76:79], a[140:143]
    v_cvt_pk_bf16_f32 v21, v23, v21
    v_mfma_f32_16x16x32_bf16 a[144:147], a[124:127], a[80:83], a[144:147]
    v_lshlrev_b32 v23, 16, v21
    v_mfma_f32_16x16x32_bf16 a[148:151], a[124:127], a[84:87], a[148:151]
    v_and_b32 v21, 0xffff0000, v21
    v_mfma_f32_16x16x32_bf16 a[152:155], a[124:127], a[88:91], a[152:155]
    v_add_f32 v25, v25, v23
    v_mfma_f32_16x16x32_bf16 a[156:159], a[124:127], a[92:95], a[156:159]
    v_add_f32 v25, v25, v21
    s_waitcnt lgkmcnt(0)
KM_PAD3:
    s_cbranch_execz KM_PAD7
    s_nop 0
    v_mfma_f32_16x16x32_bf16 v[32:35], a[32:35], a[0:3], v[32:35]
    ds_read_b64_tr_b16 a[96:97], v12 offset:8192
    v_mfma_f32_16x16x32_bf16 v[36:39], a[32:35], a[4:7], v[36:39]
    buffer_load_dwordx4 v7, s[16:19], s42 offen offset:1024 lds
    v_mfma_f32_16x16x32_bf16 v[40:43], a[32:35], a[8:11], v[40:43]
    ds_read_b64_tr_b16 a[98:99], v12 offset:9216
    v_mfma_f32_16x16x32_bf16 v[44:47], a[32:35], a[12:15], v[44:47]
    v_accvgpr_read_b32 v21, a185
    v_mfma_f32_16x16x32_bf16 v[48:51], a[32:35], a[16:19], v[48:51]
    ds_read_b128 a[64:67], v11 offset:0
    v_mfma_f32_16x16x32_bf16 v[52:55], a[32:35], a[20:23], v[52:55]
    buffer_load_dwordx4 v8, s[16:19], s42 offen offset:2048 lds
    v_mfma_f32_16x16x32_bf16 v[56:59], a[32:35], a[24:27], v[56:59]
    ds_read_b128 a[68:71], v11 offset:2048
    v_mfma_f32_16x16x32_bf16 v[60:63], a[32:35], a[28:31], v[60:63]
    v_lshlrev_b32 v23, 16, v21
    v_mfma_f32_16x16x32_bf16 v[64:67], a[36:39], a[0:3], v[64:67]
    ds_read_b128 a[72:75], v11 offset:4096
    v_mfma_f32_16x16x32_bf16 v[68:71], a[36:39], a[4:7], v[68:71]
    buffer_load_dwordx4 v9, s[16:19], s42 offen offset:3072 lds
    v_mfma_f32_16x16x32_bf16 v[72:75], a[36:39], a[8:11], v[72:75]
    ds_read_b128 a[76:79], v11 offset:6144
    s_add_u32 s42, s42, 458752
    v_mfma_f32_16x16x32_bf16 v[76:79], a[36:39], a[12:15], v[76:79]
    v_and_b32 v21, 0xffff0000, v21
    v_mfma_f32_16x16x32_bf16 v[80:83], a[36:39], a[16:19], v[80:83]
    ds_read_b128 a[80:83], v11 offset:8192
    s_add_u32 m0, s56, 2048
    v_mfma_f32_16x16x32_bf16 v[84:87], a[36:39], a[20:23], v[84:87]
    buffer_load_dwordx4 v0, s[4:7], s43 offen lds
    v_mfma_f32_16x16x32_bf16 v[88:91], a[36:39], a[24:27], v[88:91]
    ds_read_b128 a[84:87], v11 offset:10240
    s_add_u32 s43, s43, 0x20000
    v_mfma_f32_16x16x32_bf16 v[92:95], a[36:39], a[28:31], v[92:95]
    v_mul_f32 v23, v23, v1
    v_mfma_f32_16x16x32_bf16 v[96:99], a[40:43], a[0:3], v[96:99]
    ds_read_b128 a[88:91], v11 offset:12288
    s_add_u32 m0, s47, 8192
    v_mfma_f32_16x16x32_bf16 v[100:103], a[40:43], a[4:7], v[100:103]
    buffer_load_dwordx4 v30, s[20:23], s39 offen lds
    v_mfma_f32_16x16x32_bf16 v[104:107], a[40:43], a[8:11], v[104:107]
    ds_read_b128 a[92:95], v11 offset:14336
    s_add_u32 s39, s39, 8192
    s_bitcmp1_b32 s58, 6
    s_cselect_b32 s60, s48, 0x7f000000
    v_mfma_f32_16x16x32_bf16 v[108:111], a[40:43], a[12:15], v[108:111]
    buffer_load_dword a255, v18, s[32:35], s60 offen
    v_mfma_f32_16x16x32_bf16 v[112:115], a[40:43], a[16:19], v[112:115]
    ds_read_b64_tr_b16 a[100:101], v13 offset:8192
    s_add_u32 s60, s60, s59
    s_add_u32 s48, s48, s49
    v_mfma_f32_16x16x32_bf16 v[116:119], a[40:43], a[20:23], v[116:119]
    buffer_load_dword a255, v18, s[32:35], s60 offen
    v_mfma_f32_16x16x32_bf16 v[120:123], a[40:43], a[24:27], v[120:123]
    ds_read_b64_tr_b16 a[102:103], v13 offset:9216
    v_mfma_f32_16x16x32_bf16 v[124:127], a[40:43], a[28:31], v[124:127]
    buffer_load_dwordx4 a[216:219], v19, s[8:11], 0 offen offset:1280
    v_mfma_f32_16x16x32_bf16 v[128:131], a[44:47], a[0:3], v[128:131]
    ds_read_b64_tr_b16 a[104:105], v14 offset:8192
    v_mfma_f32_16x16x32_bf16 v[132:135], a[44:47], a[4:7], v[132:135]
    buffer_load_dwordx4 a[220:223], v19, s[8:11], 0 offen offset:1344
    v_mfma_f32_16x16x32_bf16 v[136:139], a[44:47], a[8:11], v[136:139]
    ds_read_b64_tr_b16 a[106:107], v14 offset:9216
    s_add_u32 m0, s51, 4096
    v_mfma_f32_16x16x32_bf16 v[140:143], a[44:47], a[12:15], v[140:143]
    buffer_load_dwordx4 v29, s[52:55], s3 offen nt lds
    v_mfma_f32_16x16x32_bf16 v[144:147], a[44:47], a[16:19], v[144:147]
    ds_read_b64_tr_b16 a[108:109], v15 offset:8192
    s_add_u32 s3, s3, 65536
    v_mfma_f32_16x16x32_bf16 v[148:151], a[44:47], a[20:23], v[148:151]
    v_mul_f32 v21, v21, v22
    v_mfma_f32_16x16x32_bf16 v[152:155], a[44:47], a[24:27], v[152:155]
    ds_read_b64_tr_b16 a[110:111], v15 offset:9216
    v_mfma_f32_16x16x32_bf16 v[156:159], a[44:47], a[28:31], v[156:159]
    v_cvt_pk_bf16_f32 v21, v23, v21
    v_mfma_f32_16x16x32_bf16 v[160:163], a[48:51], a[0:3], v[160:163]
    ds_read_b64_tr_b16 a[112:113], v12 offset:24576
    v_mfma_f32_16x16x32_bf16 v[164:167], a[48:51], a[4:7], v[164:167]
    v_lshlrev_b32 v23, 16, v21
    v_mfma_f32_16x16x32_bf16 v[168:171], a[48:51], a[8:11], v[168:171]
    ds_read_b64_tr_b16 a[114:115], v12 offset:25600
    v_mfma_f32_16x16x32_bf16 v[172:175], a[48:51], a[12:15], v[172:175]
    v_and_b32 v21, 0xffff0000, v21
    v_mfma_f32_16x16x32_bf16 v[176:179], a[48:51], a[16:19], v[176:179]
    ds_read_b64_tr_b16 a[116:117], v13 offset:24576
    v_mfma_f32_16x16x32_bf16 v[180:183], a[48:51], a[20:23], v[180:183]
    v_add_f32 v24, v24, v23
    v_mfma_f32_16x16x32_bf16 v[184:187], a[48:51], a[24:27], v[184:187]
    ds_read_b64_tr_b16 a[118:119], v13 offset:25600
    v_mfma_f32_16x16x32_bf16 v[188:191], a[48:51], a[28:31], v[188:191]
    v_add_f32 v24, v24, v21
    v_mfma_f32_16x16x32_bf16 v[192:195], a[52:55], a[0:3], v[192:195]
    ds_read_b64_tr_b16 a[120:121], v14 offset:24576
    v_mfma_f32_16x16x32_bf16 v[196:199], a[52:55], a[4:7], v[196:199]
    v_accvgpr_read_b32 v22, a194
    v_mfma_f32_16x16x32_bf16 v[200:203], a[52:55], a[8:11], v[200:203]
    ds_read_b64_tr_b16 a[122:123], v14 offset:25600
    v_mfma_f32_16x16x32_bf16 v[204:207], a[52:55], a[12:15], v[204:207]
    v_lshlrev_b32 v1, 16, v22
    v_mfma_f32_16x16x32_bf16 v[208:211], a[52:55], a[16:19], v[208:211]
    ds_read_b64_tr_b16 a[124:125], v16 offset:8192
    v_mfma_f32_16x16x32_bf16 v[212:215], a[52:55], a[20:23], v[212:215]
    v_and_b32 v22, 0xffff0000, v22
    v_mfma_f32_16x16x32_bf16 v[216:219], a[52:55], a[24:27], v[216:219]
    ds_read_b64_tr_b16 a[126:127], v16 offset:9216
    v_mfma_f32_16x16x32_bf16 v[220:223], a[52:55], a[28:31], v[220:223]
    v_accvgpr_read_b32 v21, a178
    v_mfma_f32_16x16x32_bf16 v[224:227], a[56:59], a[0:3], v[224:227]
    ds_read_b64_tr_b16 a[160:161], v17 offset:0
    v_mfma_f32_16x16x32_bf16 v[228:231], a[56:59], a[4:7], v[228:231]
    v_lshlrev_b32 v23, 16, v21
    v_mfma_f32_16x16x32_bf16 v[232:235], a[56:59], a[8:11], v[232:235]
    ds_read_b64_tr_b16 a[162:163], v17 offset:128
    v_mfma_f32_16x16x32_bf16 v[236:239], a[56:59], a[12:15], v[236:239]
    v_and_b32 v21, 0xffff0000, v21
    v_mfma_f32_16x16x32_bf16 v[240:243], a[56:59], a[16:19], v[240:243]
    ds_read_b64_tr_b16 a[164:165], v17 offset:1024
    v_mfma_f32_16x16x32_bf16 v[244:247], a[56:59], a[20:23], v[244:247]
    v_mul_f32 v23, v23, v1
    v_mfma_f32_16x16x32_bf16 v[248:251], a[56:59], a[24:27], v[248:251]
    ds_read_b64_tr_b16 a[166:167], v17 offset:1152
    v_mfma_f32_16x16x32_bf16 v[252:255], a[56:59], a[28:31], v[252:255]
    v_mul_f32 v21, v21, v22
    v_mfma_f32_16x16x32_bf16 a[128:131], a[60:63], a[0:3], a[128:131]
    v_cvt_pk_bf16_f32 v21, v23, v21
    v_mfma_f32_16x16x32_bf16 a[132:135], a[60:63], a[4:7], a[132:135]
    v_xor_b32 v15, s50, v15
    v_mfma_f32_16x16x32_bf16 a[136:139], a[60:63], a[8:11], a[136:139]
    v_lshlrev_b32 v23, 16, v21
    v_mfma_f32_16x16x32_bf16 a[140:143], a[60:63], a[12:15], a[140:143]
    v_xor_b32 v16, s50, v16
    v_mfma_f32_16x16x32_bf16 a[144:147], a[60:63], a[16:19], a[144:147]
    v_and_b32 v21, 0xffff0000, v21
    v_mfma_f32_16x16x32_bf16 a[148:151], a[60:63], a[20:23], a[148:151]
    v_add_f32 v25, v25, v23
    v_mfma_f32_16x16x32_bf16 a[152:155], a[60:63], a[24:27], a[152:155]
    v_add_f32 v25, v25, v21
    v_mfma_f32_16x16x32_bf16 a[156:159], a[60:63], a[28:31], a[156:159]
    v_accvgpr_read_b32 v21, a186
    s_waitcnt vmcnt(5) lgkmcnt(0)
    s_barrier
    s_add_u32 m0, s45, 0
    v_mfma_f32_16x16x32_bf16 v[32:35], a[96:99], a[64:67], v[32:35]
    buffer_load_dwordx4 v2, s[8:11], s40 offen offset:0 lds
    v_mfma_f32_16x16x32_bf16 v[36:39], a[96:99], a[68:71], v[36:39]
    ds_read_b64_tr_b16 a[32:33], v12 offset:32768
    v_mfma_f32_16x16x32_bf16 v[40:43], a[96:99], a[72:75], v[40:43]
    v_lshlrev_b32 v23, 16, v21
    v_mfma_f32_16x16x32_bf16 v[44:47], a[96:99], a[76:79], v[44:47]
    ds_read_b64_tr_b16 a[34:35], v12 offset:33792
    v_mfma_f32_16x16x32_bf16 v[48:51], a[96:99], a[80:83], v[48:51]
    buffer_load_dwordx4 v3, s[8:11], s40 offen offset:1024 lds
    v_mfma_f32_16x16x32_bf16 v[52:55], a[96:99], a[84:87], v[52:55]
    ds_read_b128 a[0:3], v10 offset:32768
    v_mfma_f32_16x16x32_bf16 v[56:59], a[96:99], a[88:91], v[56:59]
    v_and_b32 v21, 0xffff0000, v21
    v_mfma_f32_16x16x32_bf16 v[60:63], a[96:99], a[92:95], v[60:63]
    ds_read_b128 a[4:7], v10 offset:34816
    v_mfma_f32_16x16x32_bf16 v[64:67], a[100:103], a[64:67], v[64:67]
    v_mul_f32 v23, v23, v1
    v_mfma_f32_16x16x32_bf16 v[68:71], a[100:103], a[68:71], v[68:71]
    ds_read_b128 a[8:11], v10 offset:36864
    v_mfma_f32_16x16x32_bf16 v[72:75], a[100:103], a[72:75], v[72:75]
    buffer_load_dwordx4 v4, s[8:11], s40 offen offset:2048 lds
    v_mfma_f32_16x16x32_bf16 v[76:79], a[100:103], a[76:79], v[76:79]
    ds_read_b128 a[12:15], v10 offset:38912
    v_mfma_f32_16x16x32_bf16 v[80:83], a[100:103], a[80:83], v[80:83]
    v_mul_f32 v21, v21, v22
    v_mfma_f32_16x16x32_bf16 v[84:87], a[100:103], a[84:87], v[84:87]
    ds_read_b128 a[16:19], v10 offset:40960
    v_mfma_f32_16x16x32_bf16 v[88:91], a[100:103], a[88:91], v[88:91]
    buffer_load_dwordx4 v5, s[8:11], s40 offen offset:3072 lds
    v_mfma_f32_16x16x32_bf16 v[92:95], a[100:103], a[92:95], v[92:95]
    ds_read_b128 a[20:23], v10 offset:43008
    v_mfma_f32_16x16x32_bf16 v[96:99], a[104:107], a[64:67], v[96:99]
    v_cvt_pk_bf16_f32 v21, v23, v21
    v_mfma_f32_16x16x32_bf16 v[100:103], a[104:107], a[68:71], v[100:103]
    ds_read_b128 a[24:27], v10 offset:45056
    v_mfma_f32_16x16x32_bf16 v[104:107], a[104:107], a[72:75], v[104:107]
    v_lshlrev_b32 v23, 16, v21
    v_mfma_f32_16x16x32_bf16 v[108:111], a[104:107], a[76:79], v[108:111]
    s_add_u32 m0, s45, 4096
    ds_read_b128 a[28:31], v10 offset:47104
    v_mfma_f32_16x16x32_bf16 v[112:115], a[104:107], a[80:83], v[112:115]
    buffer_load_dwordx4 v2, s[8:11], s41 offen offset:0 lds
    v_mfma_f32_16x16x32_bf16 v[116:119], a[104:107], a[84:87], v[116:119]
    ds_read_b64_tr_b16 a[36:37], v13 offset:32768
    v_mfma_f32_16x16x32_bf16 v[120:123], a[104:107], a[88:91], v[120:123]
    v_and_b32 v21, 0xffff0000, v21
    v_mfma_f32_16x16x32_bf16 v[124:127], a[104:107], a[92:95], v[124:127]
    ds_read_b64_tr_b16 a[38:39], v13 offset:33792
    v_mfma_f32_16x16x32_bf16 v[128:131], a[108:111], a[64:67], v[128:131]
    buffer_load_dwordx4 v3, s[8:11], s41 offen offset:1024 lds
    v_mfma_f32_16x16x32_bf16 v[132:135], a[108:111], a[68:71], v[132:135]
    ds_read_b64_tr_b16 a[40:41], v14 offset:32768
    v_mfma_f32_16x16x32_bf16 v[136:139], a[108:111], a[72:75], v[136:139]
    v_add_f32 v24, v24, v23
    v_mfma_f32_16x16x32_bf16 v[140:143], a[108:111], a[76:79], v[140:143]
    ds_read_b64_tr_b16 a[42:43], v14 offset:33792
    v_mfma_f32_16x16x32_bf16 v[144:147], a[108:111], a[80:83], v[144:147]
    buffer_load_dwordx4 v4, s[8:11], s41 offen offset:2048 lds
    v_mfma_f32_16x16x32_bf16 v[148:151], a[108:111], a[84:87], v[148:151]
    ds_read_b64_tr_b16 a[44:45], v15 offset:0
    v_mfma_f32_16x16x32_bf16 a[168:171], a[208:211], a[160:163], a[168:171]
    v_add_f32 v24, v24, v21
    v_mfma_f32_16x16x32_bf16 v[152:155], a[108:111], a[88:91], v[152:155]
    ds_read_b64_tr_b16 a[46:47], v15 offset:1024
    v_mfma_f32_16x16x32_bf16 v[156:159], a[108:111], a[92:95], v[156:159]
    v_accvgpr_read_b32 v22, a195
    v_mfma_f32_16x16x32_bf16 v[160:163], a[112:115], a[64:67], v[160:163]
    ds_read_b64_tr_b16 a[48:49], v12 offset:49152
    v_mfma_f32_16x16x32_bf16 v[164:167], a[112:115], a[68:71], v[164:167]
    buffer_load_dwordx4 v5, s[8:11], s41 offen offset:3072 lds
    v_mfma_f32_16x16x32_bf16 v[168:171], a[112:115], a[72:75], v[168:171]
    ds_read_b64_tr_b16 a[50:51], v12 offset:50176
    v_mfma_f32_16x16x32_bf16 v[172:175], a[112:115], a[76:79], v[172:175]
    s_add_u32 s40, s40, 128
    s_add_u32 s41, s41, 128
    v_mfma_f32_16x16x32_bf16 v[176:179], a[112:115], a[80:83], v[176:179]
    s_add_u32 m0, s46, 0
    ds_read_b64_tr_b16 a[52:53], v13 offset:49152
    v_mfma_f32_16x16x32_bf16 v[180:183], a[112:115], a[84:87], v[180:183]
    buffer_load_dwordx4 v6, s[12:15], s42 offen offset:0 lds
    v_mfma_f32_16x16x32_bf16 v[184:187], a[112:115], a[88:91], v[184:187]
    ds_read_b64_tr_b16 a[54:55], v13 offset:50176
    v_mfma_f32_16x16x32_bf16 v[188:191], a[112:115], a[92:95], v[188:191]
    v_lshlrev_b32 v1, 16, v22
    v_mfma_f32_16x16x32_bf16 v[192:195], a[116:119], a[64:67], v[192:195]
    ds_read_b64_tr_b16 a[56:57], v14 offset:49152
    v_mfma_f32_16x16x32_bf16 v[196:199], a[116:119], a[68:71], v[196:199]
    buffer_load_dwordx4 v7, s[12:15], s42 offen offset:1024 lds
    v_mfma_f32_16x16x32_bf16 v[200:203], a[116:119], a[72:75], v[200:203]
    ds_read_b64_tr_b16 a[58:59], v14 offset:50176
    v_mfma_f32_16x16x32_bf16 v[204:207], a[116:119], a[76:79], v[204:207]
    v_and_b32 v22, 0xffff0000, v22
    v_mfma_f32_16x16x32_bf16 v[208:211], a[116:119], a[80:83], v[208:211]
    ds_read_b64_tr_b16 a[60:61], v16 offset:0
    v_mfma_f32_16x16x32_bf16 v[212:215], a[116:119], a[84:87], v[212:215]
    v_accvgpr_read_b32 v21, a179
    v_mfma_f32_16x16x32_bf16 v[216:219], a[116:119], a[88:91], v[216:219]
    ds_read_b64_tr_b16 a[62:63], v16 offset:1024
    v_mfma_f32_16x16x32_bf16 v[220:223], a[116:119], a[92:95], v[220:223]
    buffer_load_dwordx4 v8, s[12:15], s42 offen offset:2048 lds
    v_mfma_f32_16x16x32_bf16 v[224:227], a[120:123], a[64:67], v[224:227]
    ds_read_b64_tr_b16 a[204:205], v28 offset:0
    v_mfma_f32_16x16x32_bf16 a[168:171], a[212:215], a[164:167], a[168:171]
    v_lshlrev_b32 v23, 16, v21
    v_mfma_f32_16x16x32_bf16 v[228:231], a[120:123], a[68:71], v[228:231]
    ds_read_b64_tr_b16 a[206:207], v28 offset:2048
    v_mfma_f32_16x16x32_bf16 v[232:235], a[120:123], a[72:75], v[232:235]
    buffer_load_dwordx4 v9, s[12:15], s42 offen offset:3072 lds
    v_mfma_f32_16x16x32_bf16 v[236:239], a[120:123], a[76:79], v[236:239]
    v_and_b32 v21, 0xffff0000, v21
    v_mfma_f32_16x16x32_bf16 v[240:243], a[120:123], a[80:83], v[240:243]
    v_mul_f32 v23, v23, v1
    v_mfma_f32_16x16x32_bf16 v[244:247], a[120:123], a[84:87], v[244:247]
    v_mul_f32 v21, v21, v22
    v_mfma_f32_16x16x32_bf16 v[248:251], a[120:123], a[88:91], v[248:251]
    v_cvt_pk_bf16_f32 v21, v23, v21
    v_mfma_f32_16x16x32_bf16 v[252:255], a[120:123], a[92:95], v[252:255]
    s_add_u32 m0, s46, 16384
    v_mfma_f32_16x16x32_bf16 a[128:131], a[124:127], a[64:67], a[128:131]
    buffer_load_dwordx4 v6, s[16:19], s42 offen offset:0 lds
    v_mfma_f32_16x16x32_bf16 a[132:135], a[124:127], a[68:71], a[132:135]
    v_lshlrev_b32 v23, 16, v21
    v_mfma_f32_16x16x32_bf16 a[136:139], a[124:127], a[72:75], a[136:139]
    v_and_b32 v21, 0xffff0000, v21
    v_mfma_f32_16x16x32_bf16 a[140:143], a[124:127], a[76:79], a[140:143]
    v_add_f32 v25, v25, v23
    v_mfma_f32_16x16x32_bf16 a[144:147], a[124:127], a[80:83], a[144:147]
    v_add_f32 v25, v25, v21
    v_mfma_f32_16x16x32_bf16 a[148:151], a[124:127], a[84:87], a[148:151]
    v_accvgpr_read_b32 v21, a187
    v_mfma_f32_16x16x32_bf16 a[152:155], a[124:127], a[88:91], a[152:155]
    v_lshlrev_b32 v23, 16, v21
    v_mfma_f32_16x16x32_bf16 a[156:159], a[124:127], a[92:95], a[156:159]
    v_and_b32 v21, 0xffff0000, v21
    s_waitcnt lgkmcnt(0)
    v_mfma_f32_16x16x32_bf16 v[32:35], a[32:35], a[0:3], v[32:35]
    ds_read_b64_tr_b16 a[96:97], v12 offset:40960
    v_mfma_f32_16x16x32_bf16 v[36:39], a[32:35], a[4:7], v[36:39]
    buffer_load_dwordx4 v7, s[16:19], s42 offen offset:1024 lds
    v_mfma_f32_16x16x32_bf16 v[40:43], a[32:35], a[8:11], v[40:43]
    ds_read_b64_tr_b16 a[98:99], v12 offset:41984
    v_mfma_f32_16x16x32_bf16 v[44:47], a[32:35], a[12:15], v[44:47]
    v_mul_f32 v23, v23, v1
    v_mfma_f32_16x16x32_bf16 v[48:51], a[32:35], a[16:19], v[48:51]
    ds_read_b128 a[64:67], v11 offset:32768
    v_mfma_f32_16x16x32_bf16 v[52:55], a[32:35], a[20:23], v[52:55]
    buffer_load_dwordx4 v8, s[16:19], s42 offen offset:2048 lds
    v_mfma_f32_16x16x32_bf16 v[56:59], a[32:35], a[24:27], v[56:59]
    ds_read_b128 a[68:71], v11 offset:34816
    v_mfma_f32_16x16x32_bf16 v[60:63], a[32:35], a[28:31], v[60:63]
    v_mul_f32 v21, v21, v22
    v_mfma_f32_16x16x32_bf16 v[64:67], a[36:39], a[0:3], v[64:67]
    ds_read_b128 a[72:75], v11 offset:36864
    v_mfma_f32_16x16x32_bf16 v[68:71], a[36:39], a[4:7], v[68:71]
    buffer_load_dwordx4 v9, s[16:19], s42 offen offset:3072 lds
    v_mfma_f32_16x16x32_bf16 v[72:75], a[36:39], a[8:11], v[72:75]
    ds_read_b128 a[76:79], v11 offset:38912
    s_add_u32 s42, s42, 458752
    v_mfma_f32_16x16x32_bf16 v[76:79], a[36:39], a[12:15], v[76:79]
    v_cvt_pk_bf16_f32 v21, v23, v21
    v_mfma_f32_16x16x32_bf16 v[80:83], a[36:39], a[16:19], v[80:83]
    ds_read_b128 a[80:83], v11 offset:40960
    s_add_u32 m0, s56, 0
    v_mfma_f32_16x16x32_bf16 v[84:87], a[36:39], a[20:23], v[84:87]
    buffer_load_dwordx4 v0, s[4:7], s43 offen lds
    v_mfma_f32_16x16x32_bf16 v[88:91], a[36:39], a[24:27], v[88:91]
    ds_read_b128 a[84:87], v11 offset:43008
    s_add_u32 s43, s43, 0x20000
    v_mfma_f32_16x16x32_bf16 v[92:95], a[36:39], a[28:31], v[92:95]
    v_lshlrev_b32 v23, 16, v21
    v_mfma_f32_16x16x32_bf16 v[96:99], a[40:43], a[0:3], v[96:99]
    ds_read_b128 a[88:91], v11 offset:45056
    s_add_u32 m0, s47, 0
    v_mfma_f32_16x16x32_bf16 v[100:103], a[40:43], a[4:7], v[100:103]
    buffer_load_dwordx4 v30, s[20:23], s39 offen lds
    v_mfma_f32_16x16x32_bf16 v[104:107], a[40:43], a[8:11], v[104:107]
    ds_read_b128 a[92:95], v11 offset:47104
    s_add_u32 s39, s39, 8192
    s_bitcmp1_b32 s58, 7
    s_cselect_b32 s60, s48, 0x7f000000
    v_mfma_f32_16x16x32_bf16 v[108:111], a[40:43], a[12:15], v[108:111]
    buffer_load_dword a255, v18, s[32:35], s60 offen
    v_mfma_f32_16x16x32_bf16 v[112:115], a[40:43], a[16:19], v[112:115]
    ds_read_b64_tr_b16 a[100:101], v13 offset:40960
    s_add_u32 s60, s60, s59
    s_add_u32 s48, s48, s49
    v_mfma_f32_16x16x32_bf16 v[116:119], a[40:43], a[20:23], v[116:119]
    buffer_load_dword a255, v18, s[32:35], s60 offen
    v_mfma_f32_16x16x32_bf16 v[120:123], a[40:43], a[24:27], v[120:123]
    ds_read_b64_tr_b16 a[102:103], v13 offset:41984
    v_mfma_f32_16x16x32_bf16 v[124:127], a[40:43], a[28:31], v[124:127]
    buffer_load_dwordx4 a[208:211], v19, s[8:11], 0 offen offset:1536
    v_mfma_f32_16x16x32_bf16 v[128:131], a[44:47], a[0:3], v[128:131]
    ds_read_b64_tr_b16 a[104:105], v14 offset:40960
    v_mfma_f32_16x16x32_bf16 v[132:135], a[44:47], a[4:7], v[132:135]
    buffer_load_dwordx4 a[212:215], v19, s[8:11], 0 offen offset:1600
    v_mfma_f32_16x16x32_bf16 v[136:139], a[44:47], a[8:11], v[136:139]
    ds_read_b64_tr_b16 a[106:107], v14 offset:41984
    s_add_u32 m0, s51, 8192
    v_mfma_f32_16x16x32_bf16 v[140:143], a[44:47], a[12:15], v[140:143]
    buffer_load_dwordx4 v29, s[52:55], s3 offen nt lds
    v_mfma_f32_16x16x32_bf16 v[144:147], a[44:47], a[16:19], v[144:147]
    ds_read_b64_tr_b16 a[108:109], v15 offset:8192
    s_add_u32 s3, s3, 98304
    v_mfma_f32_16x16x32_bf16 v[148:151], a[44:47], a[20:23], v[148:151]
    buffer_store_dwordx4 a[204:207], v27, s[24:27], s94 offen sc1
    v_mfma_f32_16x16x32_bf16 v[152:155], a[44:47], a[24:27], v[152:155]
    ds_read_b64_tr_b16 a[110:111], v15 offset:9216
    s_add_u32 s94, s94, 8192
    v_mfma_f32_16x16x32_bf16 v[156:159], a[44:47], a[28:31], v[156:159]
    v_and_b32 v21, 0xffff0000, v21
    v_mfma_f32_16x16x32_bf16 v[160:163], a[48:51], a[0:3], v[160:163]
    ds_read_b64_tr_b16 a[112:113], v12 offset:57344
    v_mfma_f32_16x16x32_bf16 v[164:167], a[48:51], a[4:7], v[164:167]
    v_add_f32 v24, v24, v23
    v_mfma_f32_16x16x32_bf16 v[168:171], a[48:51], a[8:11], v[168:171]
    ds_read_b64_tr_b16 a[114:115], v12 offset:58368
    v_mfma_f32_16x16x32_bf16 v[172:175], a[48:51], a[12:15], v[172:175]
    v_add_f32 v24, v24, v21
    v_mfma_f32_16x16x32_bf16 v[176:179], a[48:51], a[16:19], v[176:179]
    ds_read_b64_tr_b16 a[116:117], v13 offset:57344
    v_mfma_f32_16x16x32_bf16 v[180:183], a[48:51], a[20:23], v[180:183]
    v_mfma_f32_16x16x32_bf16 v[184:187], a[48:51], a[24:27], v[184:187]
    ds_read_b64_tr_b16 a[118:119], v13 offset:58368
    v_mfma_f32_16x16x32_bf16 v[188:191], a[48:51], a[28:31], v[188:191]
    v_mfma_f32_16x16x32_bf16 v[192:195], a[52:55], a[0:3], v[192:195]
    ds_read_b64_tr_b16 a[120:121], v14 offset:57344
    v_mfma_f32_16x16x32_bf16 v[196:199], a[52:55], a[4:7], v[196:199]
    v_mfma_f32_16x16x32_bf16 v[200:203], a[52:55], a[8:11], v[200:203]
    ds_read_b64_tr_b16 a[122:123], v14 offset:58368
    v_mfma_f32_16x16x32_bf16 v[204:207], a[52:55], a[12:15], v[204:207]
    v_mfma_f32_16x16x32_bf16 v[208:211], a[52:55], a[16:19], v[208:211]
    ds_read_b64_tr_b16 a[124:125], v16 offset:8192
    v_mfma_f32_16x16x32_bf16 v[212:215], a[52:55], a[20:23], v[212:215]
    v_mfma_f32_16x16x32_bf16 v[216:219], a[52:55], a[24:27], v[216:219]
    ds_read_b64_tr_b16 a[126:127], v16 offset:9216
    v_mfma_f32_16x16x32_bf16 v[220:223], a[52:55], a[28:31], v[220:223]
    v_mfma_f32_16x16x32_bf16 v[224:227], a[56:59], a[0:3], v[224:227]
    ds_read_b64_tr_b16 a[160:161], v17 offset:8192
    v_mfma_f32_16x16x32_bf16 v[228:231], a[56:59], a[4:7], v[228:231]
    v_mfma_f32_16x16x32_bf16 v[232:235], a[56:59], a[8:11], v[232:235]
    ds_read_b64_tr_b16 a[162:163], v17 offset:8320
    v_mfma_f32_16x16x32_bf16 v[236:239], a[56:59], a[12:15], v[236:239]
    v_mfma_f32_16x16x32_bf16 v[240:243], a[56:59], a[16:19], v[240:243]
    ds_read_b64_tr_b16 a[164:165], v17 offset:9216
    v_mfma_f32_16x16x32_bf16 v[244:247], a[56:59], a[20:23], v[244:247]
    v_mfma_f32_16x16x32_bf16 v[248:251], a[56:59], a[24:27], v[248:251]
    ds_read_b64_tr_b16 a[166:167], v17 offset:9344
    v_mfma_f32_16x16x32_bf16 v[252:255], a[56:59], a[28:31], v[252:255]
    v_mfma_f32_16x16x32_bf16 a[128:131], a[60:63], a[0:3], a[128:131]
    v_mfma_f32_16x16x32_bf16 a[132:135], a[60:63], a[4:7], a[132:135]
    v_xor_b32 v15, s50, v15
    v_mfma_f32_16x16x32_bf16 a[136:139], a[60:63], a[8:11], a[136:139]
    v_mfma_f32_16x16x32_bf16 a[140:143], a[60:63], a[12:15], a[140:143]
    v_xor_b32 v16, s50, v16
    v_mfma_f32_16x16x32_bf16 a[144:147], a[60:63], a[16:19], a[144:147]
    v_mfma_f32_16x16x32_bf16 a[148:151], a[60:63], a[20:23], a[148:151]
    v_mfma_f32_16x16x32_bf16 a[152:155], a[60:63], a[24:27], a[152:155]
    v_mfma_f32_16x16x32_bf16 a[156:159], a[60:63], a[28:31], a[156:159]
    s_waitcnt vmcnt(6) lgkmcnt(0)
    s_barrier
    s_add_u32 m0, s45, 32768
    v_mfma_f32_16x16x32_bf16 v[32:35], a[96:99], a[64:67], v[32:35]
    buffer_load_dwordx4 v2, s[8:11], s40 offen offset:0 lds
    v_mfma_f32_16x16x32_bf16 v[36:39], a[96:99], a[68:71], v[36:39]
    ds_read_b64_tr_b16 a[32:33], v12 offset:0
    v_mfma_f32_16x16x32_bf16 v[40:43], a[96:99], a[72:75], v[40:43]
    v_mfma_f32_16x16x32_bf16 v[44:47], a[96:99], a[76:79], v[44:47]
    ds_read_b64_tr_b16 a[34:35], v12 offset:1024
    v_mfma_f32_16x16x32_bf16 v[48:51], a[96:99], a[80:83], v[48:51]
    buffer_load_dwordx4 v3, s[8:11], s40 offen offset:1024 lds
    v_mfma_f32_16x16x32_bf16 v[52:55], a[96:99], a[84:87], v[52:55]
    ds_read_b128 a[0:3], v10 offset:0
    v_mfma_f32_16x16x32_bf16 v[56:59], a[96:99], a[88:91], v[56:59]
    v_mfma_f32_16x16x32_bf16 v[60:63], a[96:99], a[92:95], v[60:63]
    ds_read_b128 a[4:7], v10 offset:2048
    v_mfma_f32_16x16x32_bf16 v[64:67], a[100:103], a[64:67], v[64:67]
    v_mfma_f32_16x16x32_bf16 v[68:71], a[100:103], a[68:71], v[68:71]
    ds_read_b128 a[8:11], v10 offset:4096
    v_mfma_f32_16x16x32_bf16 v[72:75], a[100:103], a[72:75], v[72:75]
    buffer_load_dwordx4 v4, s[8:11], s40 offen offset:2048 lds
    v_mfma_f32_16x16x32_bf16 v[76:79], a[100:103], a[76:79], v[76:79]
    ds_read_b128 a[12:15], v10 offset:6144
    v_mfma_f32_16x16x32_bf16 v[80:83], a[100:103], a[80:83], v[80:83]
    v_mfma_f32_16x16x32_bf16 v[84:87], a[100:103], a[84:87], v[84:87]
    ds_read_b128 a[16:19], v10 offset:8192
    v_mfma_f32_16x16x32_bf16 v[88:91], a[100:103], a[88:91], v[88:91]
    buffer_load_dwordx4 v5, s[8:11], s40 offen offset:3072 lds
    v_mfma_f32_16x16x32_bf16 v[92:95], a[100:103], a[92:95], v[92:95]
    ds_read_b128 a[20:23], v10 offset:10240
    v_mfma_f32_16x16x32_bf16 v[96:99], a[104:107], a[64:67], v[96:99]
    v_mfma_f32_16x16x32_bf16 v[100:103], a[104:107], a[68:71], v[100:103]
    ds_read_b128 a[24:27], v10 offset:12288
    v_mfma_f32_16x16x32_bf16 v[104:107], a[104:107], a[72:75], v[104:107]
    v_mfma_f32_16x16x32_bf16 v[108:111], a[104:107], a[76:79], v[108:111]
    s_add_u32 m0, s45, 36864
    ds_read_b128 a[28:31], v10 offset:14336
    v_mfma_f32_16x16x32_bf16 v[112:115], a[104:107], a[80:83], v[112:115]
    buffer_load_dwordx4 v2, s[8:11], s41 offen offset:0 lds
    v_mfma_f32_16x16x32_bf16 v[116:119], a[104:107], a[84:87], v[116:119]
    ds_read_b64_tr_b16 a[36:37], v13 offset:0
    v_mfma_f32_16x16x32_bf16 v[120:123], a[104:107], a[88:91], v[120:123]
    v_mfma_f32_16x16x32_bf16 v[124:127], a[104:107], a[92:95], v[124:127]
    ds_read_b64_tr_b16 a[38:39], v13 offset:1024
    v_mfma_f32_16x16x32_bf16 v[128:131], a[108:111], a[64:67], v[128:131]
    buffer_load_dwordx4 v3, s[8:11], s41 offen offset:1024 lds
    v_mfma_f32_16x16x32_bf16 v[132:135], a[108:111], a[68:71], v[132:135]
    ds_read_b64_tr_b16 a[40:41], v14 offset:0
    v_mfma_f32_16x16x32_bf16 v[136:139], a[108:111], a[72:75], v[136:139]
    v_mfma_f32_16x16x32_bf16 v[140:143], a[108:111], a[76:79], v[140:143]
    ds_read_b64_tr_b16 a[42:43], v14 offset:1024
    v_mfma_f32_16x16x32_bf16 v[144:147], a[108:111], a[80:83], v[144:147]
    buffer_load_dwordx4 v4, s[8:11], s41 offen offset:2048 lds
    v_mfma_f32_16x16x32_bf16 v[148:151], a[108:111], a[84:87], v[148:151]
    ds_read_b64_tr_b16 a[44:45], v15 offset:0
    v_mfma_f32_16x16x32_bf16 a[168:171], a[216:219], a[160:163], a[168:171]
    v_mfma_f32_16x16x32_bf16 v[152:155], a[108:111], a[88:91], v[152:155]
    ds_read_b64_tr_b16 a[46:47], v15 offset:1024
    v_mfma_f32_16x16x32_bf16 v[156:159], a[108:111], a[92:95], v[156:159]
    v_mfma_f32_16x16x32_bf16 v[160:163], a[112:115], a[64:67], v[160:163]
    ds_read_b64_tr_b16 a[48:49], v12 offset:16384
    v_mfma_f32_16x16x32_bf16 v[164:167], a[112:115], a[68:71], v[164:167]
    buffer_load_dwordx4 v5, s[8:11], s41 offen offset:3072 lds
    v_mfma_f32_16x16x32_bf16 v[168:171], a[112:115], a[72:75], v[168:171]
    ds_read_b64_tr_b16 a[50:51], v12 offset:17408
    v_mfma_f32_16x16x32_bf16 v[172:175], a[112:115], a[76:79], v[172:175]
    s_add_u32 s40, s40, 128
    s_add_u32 s41, s41, 128
    v_mfma_f32_16x16x32_bf16 v[176:179], a[112:115], a[80:83], v[176:179]
    s_add_u32 m0, s46, 32768
    ds_read_b64_tr_b16 a[52:53], v13 offset:16384
    v_mfma_f32_16x16x32_bf16 v[180:183], a[112:115], a[84:87], v[180:183]
    buffer_load_dwordx4 v6, s[12:15], s42 offen offset:0 lds
    v_mfma_f32_16x16x32_bf16 v[184:187], a[112:115], a[88:91], v[184:187]
    ds_read_b64_tr_b16 a[54:55], v13 offset:17408
    v_mfma_f32_16x16x32_bf16 v[188:191], a[112:115], a[92:95], v[188:191]
    v_mfma_f32_16x16x32_bf16 v[192:195], a[116:119], a[64:67], v[192:195]
    ds_read_b64_tr_b16 a[56:57], v14 offset:16384
    v_mfma_f32_16x16x32_bf16 v[196:199], a[116:119], a[68:71], v[196:199]
    buffer_load_dwordx4 v7, s[12:15], s42 offen offset:1024 lds
    v_mfma_f32_16x16x32_bf16 v[200:203], a[116:119], a[72:75], v[200:203]
    ds_read_b64_tr_b16 a[58:59], v14 offset:17408
    v_mfma_f32_16x16x32_bf16 v[204:207], a[116:119], a[76:79], v[204:207]
    v_mfma_f32_16x16x32_bf16 v[208:211], a[116:119], a[80:83], v[208:211]
    ds_read_b64_tr_b16 a[60:61], v16 offset:0
    v_mfma_f32_16x16x32_bf16 v[212:215], a[116:119], a[84:87], v[212:215]
    v_mfma_f32_16x16x32_bf16 v[216:219], a[116:119], a[88:91], v[216:219]
    ds_read_b64_tr_b16 a[62:63], v16 offset:1024
    v_mfma_f32_16x16x32_bf16 v[220:223], a[116:119], a[92:95], v[220:223]
    buffer_load_dwordx4 v8, s[12:15], s42 offen offset:2048 lds
    v_mfma_f32_16x16x32_bf16 v[224:227], a[120:123], a[64:67], v[224:227]
    ds_read_b64_tr_b16 a[204:205], v28 offset:4096
    v_mfma_f32_16x16x32_bf16 a[168:171], a[220:223], a[164:167], a[168:171]
    v_mfma_f32_16x16x32_bf16 v[228:231], a[120:123], a[68:71], v[228:231]
    ds_read_b64_tr_b16 a[206:207], v28 offset:6144
    v_mfma_f32_16x16x32_bf16 v[232:235], a[120:123], a[72:75], v[232:235]
    buffer_load_dwordx4 v9, s[12:15], s42 offen offset:3072 lds
    v_mfma_f32_16x16x32_bf16 v[236:239], a[120:123], a[76:79], v[236:239]
    v_mfma_f32_16x16x32_bf16 v[240:243], a[120:123], a[80:83], v[240:243]
    v_mfma_f32_16x16x32_bf16 v[244:247], a[120:123], a[84:87], v[244:247]
    v_mfma_f32_16x16x32_bf16 v[248:251], a[120:123], a[88:91], v[248:251]
    v_mfma_f32_16x16x32_bf16 v[252:255], a[120:123], a[92:95], v[252:255]
    s_add_u32 m0, s46, 49152
    v_mfma_f32_16x16x32_bf16 a[128:131], a[124:127], a[64:67], a[128:131]
    buffer_load_dwordx4 v6, s[16:19], s42 offen offset:0 lds
    v_mfma_f32_16x16x32_bf16 a[132:135], a[124:127], a[68:71], a[132:135]
    v_mfma_f32_16x16x32_bf16 a[136:139], a[124:127], a[72:75], a[136:139]
    v_mfma_f32_16x16x32_bf16 a[140:143], a[124:127], a[76:79], a[140:143]
    v_mfma_f32_16x16x32_bf16 a[144:147], a[124:127], a[80:83], a[144:147]
    v_mfma_f32_16x16x32_bf16 a[148:151], a[124:127], a[84:87], a[148:151]
    v_mfma_f32_16x16x32_bf16 a[152:155], a[124:127], a[88:91], a[152:155]
    v_mfma_f32_16x16x32_bf16 a[156:159], a[124:127], a[92:95], a[156:159]
    s_waitcnt lgkmcnt(0)
    v_mfma_f32_16x16x32_bf16 v[32:35], a[32:35], a[0:3], v[32:35]
    ds_read_b64_tr_b16 a[96:97], v12 offset:8192
    v_mfma_f32_16x16x32_bf16 v[36:39], a[32:35], a[4:7], v[36:39]
    buffer_load_dwordx4 v7, s[16:19], s42 offen offset:1024 lds
    v_mfma_f32_16x16x32_bf16 v[40:43], a[32:35], a[8:11], v[40:43]
    ds_read_b64_tr_b16 a[98:99], v12 offset:9216
    v_mfma_f32_16x16x32_bf16 v[44:47], a[32:35], a[12:15], v[44:47]
    v_mfma_f32_16x16x32_bf16 v[48:51], a[32:35], a[16:19], v[48:51]
    ds_read_b128 a[64:67], v11 offset:0
    v_mfma_f32_16x16x32_bf16 v[52:55], a[32:35], a[20:23], v[52:55]
    buffer_load_dwordx4 v8, s[16:19], s42 offen offset:2048 lds
    v_mfma_f32_16x16x32_bf16 v[56:59], a[32:35], a[24:27], v[56:59]
    ds_read_b128 a[68:71], v11 offset:2048
    v_mfma_f32_16x16x32_bf16 v[60:63], a[32:35], a[28:31], v[60:63]
    v_mfma_f32_16x16x32_bf16 v[64:67], a[36:39], a[0:3], v[64:67]
    ds_read_b128 a[72:75], v11 offset:4096
    v_mfma_f32_16x16x32_bf16 v[68:71], a[36:39], a[4:7], v[68:71]
    buffer_load_dwordx4 v9, s[16:19], s42 offen offset:3072 lds
    v_mfma_f32_16x16x32_bf16 v[72:75], a[36:39], a[8:11], v[72:75]
    ds_read_b128 a[76:79], v11 offset:6144
    s_add_u32 s42, s42, 458752
    v_mfma_f32_16x16x32_bf16 v[76:79], a[36:39], a[12:15], v[76:79]
KM_PAD4:
    s_cbranch_execz KM_PAD8
    s_nop 0
    v_mfma_f32_16x16x32_bf16 v[80:83], a[36:39], a[16:19], v[80:83]
    ds_read_b128 a[80:83], v11 offset:8192
    s_add_u32 m0, s56, 2048
    v_mfma_f32_16x16x32_bf16 v[84:87], a[36:39], a[20:23], v[84:87]
    buffer_load_dwordx4 v0, s[4:7], s43 offen lds
    v_mfma_f32_16x16x32_bf16 v[88:91], a[36:39], a[24:27], v[88:91]
    ds_read_b128 a[84:87], v11 offset:10240
    s_add_u32 s43, s43, 0x20000
    v_mfma_f32_16x16x32_bf16 v[92:95], a[36:39], a[28:31], v[92:95]
    v_mfma_f32_16x16x32_bf16 v[96:99], a[40:43], a[0:3], v[96:99]
    ds_read_b128 a[88:91], v11 offset:12288
    s_add_u32 m0, s47, 8192
    v_mfma_f32_16x16x32_bf16 v[100:103], a[40:43], a[4:7], v[100:103]
    buffer_load_dwordx4 v30, s[20:23], s39 offen lds
    v_mfma_f32_16x16x32_bf16 v[104:107], a[40:43], a[8:11], v[104:107]
    ds_read_b128 a[92:95], v11 offset:14336
    s_add_u32 s39, s39, 8192
    s_bitcmp1_b32 s58, 8
    s_cselect_b32 s60, s48, 0x7f000000
    v_mfma_f32_16x16x32_bf16 v[108:111], a[40:43], a[12:15], v[108:111]
    buffer_load_dword a255, v18, s[32:35], s60 offen
    v_mfma_f32_16x16x32_bf16 v[112:115], a[40:43], a[16:19], v[112:115]
    ds_read_b64_tr_b16 a[100:101], v13 offset:8192
    s_add_u32 s60, s60, s59
    s_add_u32 s48, s48, s49
    v_mfma_f32_16x16x32_bf16 v[116:119], a[40:43], a[20:23], v[116:119]
    buffer_load_dword a255, v18, s[32:35], s60 offen
    v_mfma_f32_16x16x32_bf16 v[120:123], a[40:43], a[24:27], v[120:123]
    ds_read_b64_tr_b16 a[102:103], v13 offset:9216
    v_mfma_f32_16x16x32_bf16 v[124:127], a[40:43], a[28:31], v[124:127]
    buffer_load_dwordx4 a[216:219], v19, s[8:11], 0 offen offset:1792
    v_mfma_f32_16x16x32_bf16 v[128:131], a[44:47], a[0:3], v[128:131]
    ds_read_b64_tr_b16 a[104:105], v14 offset:8192
    v_mfma_f32_16x16x32_bf16 v[132:135], a[44:47], a[4:7], v[132:135]
    buffer_load_dwordx4 a[220:223], v19, s[8:11], 0 offen offset:1856
    v_mfma_f32_16x16x32_bf16 v[136:139], a[44:47], a[8:11], v[136:139]
    ds_read_b64_tr_b16 a[106:107], v14 offset:9216
    s_add_u32 m0, s51, 0
    v_mfma_f32_16x16x32_bf16 v[140:143], a[44:47], a[12:15], v[140:143]
    buffer_load_dwordx4 v29, s[52:55], s3 offen nt lds
    v_mfma_f32_16x16x32_bf16 v[144:147], a[44:47], a[16:19], v[144:147]
    ds_read_b64_tr_b16 a[108:109], v15 offset:8192
    s_add_u32 s3, s3, 65536
    v_mfma_f32_16x16x32_bf16 v[148:151], a[44:47], a[20:23], v[148:151]
    buffer_store_dwordx4 a[204:207], v27, s[24:27], s94 offen sc1
    v_mfma_f32_16x16x32_bf16 v[152:155], a[44:47], a[24:27], v[152:155]
    ds_read_b64_tr_b16 a[110:111], v15 offset:9216
    s_add_u32 s94, s94, 8192
    v_mfma_f32_16x16x32_bf16 v[156:159], a[44:47], a[28:31], v[156:159]
    v_mfma_f32_16x16x32_bf16 v[160:163], a[48:51], a[0:3], v[160:163]
    ds_read_b64_tr_b16 a[112:113], v12 offset:24576
    v_mfma_f32_16x16x32_bf16 v[164:167], a[48:51], a[4:7], v[164:167]
    v_mfma_f32_16x16x32_bf16 v[168:171], a[48:51], a[8:11], v[168:171]
    ds_read_b64_tr_b16 a[114:115], v12 offset:25600
    v_mfma_f32_16x16x32_bf16 v[172:175], a[48:51], a[12:15], v[172:175]
    v_mfma_f32_16x16x32_bf16 v[176:179], a[48:51], a[16:19], v[176:179]
    ds_read_b64_tr_b16 a[116:117], v13 offset:24576
    v_mfma_f32_16x16x32_bf16 v[180:183], a[48:51], a[20:23], v[180:183]
    v_mfma_f32_16x16x32_bf16 v[184:187], a[48:51], a[24:27], v[184:187]
    ds_read_b64_tr_b16 a[118:119], v13 offset:25600
    v_mfma_f32_16x16x32_bf16 v[188:191], a[48:51], a[28:31], v[188:191]
    v_mfma_f32_16x16x32_bf16 v[192:195], a[52:55], a[0:3], v[192:195]
    ds_read_b64_tr_b16 a[120:121], v14 offset:24576
    v_mfma_f32_16x16x32_bf16 v[196:199], a[52:55], a[4:7], v[196:199]
    v_mfma_f32_16x16x32_bf16 v[200:203], a[52:55], a[8:11], v[200:203]
    ds_read_b64_tr_b16 a[122:123], v14 offset:25600
    v_mfma_f32_16x16x32_bf16 v[204:207], a[52:55], a[12:15], v[204:207]
    v_mfma_f32_16x16x32_bf16 v[208:211], a[52:55], a[16:19], v[208:211]
    ds_read_b64_tr_b16 a[124:125], v16 offset:8192
    v_mfma_f32_16x16x32_bf16 v[212:215], a[52:55], a[20:23], v[212:215]
    v_mfma_f32_16x16x32_bf16 v[216:219], a[52:55], a[24:27], v[216:219]
    ds_read_b64_tr_b16 a[126:127], v16 offset:9216
    v_mfma_f32_16x16x32_bf16 v[220:223], a[52:55], a[28:31], v[220:223]
    v_mfma_f32_16x16x32_bf16 v[224:227], a[56:59], a[0:3], v[224:227]
    ds_read_b64_tr_b16 a[160:161], v17 offset:0
    v_mfma_f32_16x16x32_bf16 v[228:231], a[56:59], a[4:7], v[228:231]
    v_mfma_f32_16x16x32_bf16 v[232:235], a[56:59], a[8:11], v[232:235]
    ds_read_b64_tr_b16 a[162:163], v17 offset:128
    v_mfma_f32_16x16x32_bf16 v[236:239], a[56:59], a[12:15], v[236:239]
    v_mfma_f32_16x16x32_bf16 v[240:243], a[56:59], a[16:19], v[240:243]
    ds_read_b64_tr_b16 a[164:165], v17 offset:1024
    v_mfma_f32_16x16x32_bf16 v[244:247], a[56:59], a[20:23], v[244:247]
    v_mfma_f32_16x16x32_bf16 v[248:251], a[56:59], a[24:27], v[248:251]
    ds_read_b64_tr_b16 a[166:167], v17 offset:1152
    v_mfma_f32_16x16x32_bf16 v[252:255], a[56:59], a[28:31], v[252:255]
    v_mfma_f32_16x16x32_bf16 a[128:131], a[60:63], a[0:3], a[128:131]
    v_mfma_f32_16x16x32_bf16 a[132:135], a[60:63], a[4:7], a[132:135]
    v_xor_b32 v15, s50, v15
    v_mfma_f32_16x16x32_bf16 a[136:139], a[60:63], a[8:11], a[136:139]
    v_mfma_f32_16x16x32_bf16 a[140:143], a[60:63], a[12:15], a[140:143]
    v_xor_b32 v16, s50, v16
    v_mfma_f32_16x16x32_bf16 a[144:147], a[60:63], a[16:19], a[144:147]
    v_mfma_f32_16x16x32_bf16 a[148:151], a[60:63], a[20:23], a[148:151]
    v_mfma_f32_16x16x32_bf16 a[152:155], a[60:63], a[24:27], a[152:155]
    v_mfma_f32_16x16x32_bf16 a[156:159], a[60:63], a[28:31], a[156:159]
    s_waitcnt vmcnt(6) lgkmcnt(0)
    s_barrier
    s_add_u32 m0, s45, 0
    v_mfma_f32_16x16x32_bf16 v[32:35], a[96:99], a[64:67], v[32:35]
    buffer_load_dwordx4 v2, s[8:11], s40 offen offset:0 lds
    v_mfma_f32_16x16x32_bf16 v[36:39], a[96:99], a[68:71], v[36:39]
    ds_read_b64_tr_b16 a[32:33], v12 offset:32768
    v_mfma_f32_16x16x32_bf16 v[40:43], a[96:99], a[72:75], v[40:43]
    v_mfma_f32_16x16x32_bf16 v[44:47], a[96:99], a[76:79], v[44:47]
    ds_read_b64_tr_b16 a[34:35], v12 offset:33792
    v_mfma_f32_16x16x32_bf16 v[48:51], a[96:99], a[80:83], v[48:51]
    buffer_load_dwordx4 v3, s[8:11], s40 offen offset:1024 lds
    v_mfma_f32_16x16x32_bf16 v[52:55], a[96:99], a[84:87], v[52:55]
    ds_read_b128 a[0:3], v10 offset:32768
    v_mfma_f32_16x16x32_bf16 v[56:59], a[96:99], a[88:91], v[56:59]
    v_mfma_f32_16x16x32_bf16 v[60:63], a[96:99], a[92:95], v[60:63]
    ds_read_b128 a[4:7], v10 offset:34816
    v_mfma_f32_16x16x32_bf16 v[64:67], a[100:103], a[64:67], v[64:67]
    v_mfma_f32_16x16x32_bf16 v[68:71], a[100:103], a[68:71], v[68:71]
    ds_read_b128 a[8:11], v10 offset:36864
    v_mfma_f32_16x16x32_bf16 v[72:75], a[100:103], a[72:75], v[72:75]
    buffer_load_dwordx4 v4, s[8:11], s40 offen offset:2048 lds
    v_mfma_f32_16x16x32_bf16 v[76:79], a[100:103], a[76:79], v[76:79]
    ds_read_b128 a[12:15], v10 offset:38912
    v_mfma_f32_16x16x32_bf16 v[80:83], a[100:103], a[80:83], v[80:83]
    v_mfma_f32_16x16x32_bf16 v[84:87], a[100:103], a[84:87], v[84:87]
    ds_read_b128 a[16:19], v10 offset:40960
    v_mfma_f32_16x16x32_bf16 v[88:91], a[100:103], a[88:91], v[88:91]
    buffer_load_dwordx4 v5, s[8:11], s40 offen offset:3072 lds
    v_mfma_f32_16x16x32_bf16 v[92:95], a[100:103], a[92:95], v[92:95]
    ds_read_b128 a[20:23], v10 offset:43008
    v_mfma_f32_16x16x32_bf16 v[96:99], a[104:107], a[64:67], v[96:99]
    v_mfma_f32_16x16x32_bf16 v[100:103], a[104:107], a[68:71], v[100:103]
    ds_read_b128 a[24:27], v10 offset:45056
    v_mfma_f32_16x16x32_bf16 v[104:107], a[104:107], a[72:75], v[104:107]
    v_mfma_f32_16x16x32_bf16 v[108:111], a[104:107], a[76:79], v[108:111]
    s_add_u32 m0, s45, 4096
    ds_read_b128 a[28:31], v10 offset:47104
    v_mfma_f32_16x16x32_bf16 v[112:115], a[104:107], a[80:83], v[112:115]
    buffer_load_dwordx4 v2, s[8:11], s41 offen offset:0 lds
    v_mfma_f32_16x16x32_bf16 v[116:119], a[104:107], a[84:87], v[116:119]
    ds_read_b64_tr_b16 a[36:37], v13 offset:32768
    v_mfma_f32_16x16x32_bf16 v[120:123], a[104:107], a[88:91], v[120:123]
    v_mfma_f32_16x16x32_bf16 v[124:127], a[104:107], a[92:95], v[124:127]
    ds_read_b64_tr_b16 a[38:39], v13 offset:33792
    v_mfma_f32_16x16x32_bf16 v[128:131], a[108:111], a[64:67], v[128:131]
    buffer_load_dwordx4 v3, s[8:11], s41 offen offset:1024 lds
    v_mfma_f32_16x16x32_bf16 v[132:135], a[108:111], a[68:71], v[132:135]
    ds_read_b64_tr_b16 a[40:41], v14 offset:32768
    v_mfma_f32_16x16x32_bf16 v[136:139], a[108:111], a[72:75], v[136:139]
    v_mfma_f32_16x16x32_bf16 v[140:143], a[108:111], a[76:79], v[140:143]
    ds_read_b64_tr_b16 a[42:43], v14 offset:33792
    v_mfma_f32_16x16x32_bf16 v[144:147], a[108:111], a[80:83], v[144:147]
    buffer_load_dwordx4 v4, s[8:11], s41 offen offset:2048 lds
    v_mfma_f32_16x16x32_bf16 v[148:151], a[108:111], a[84:87], v[148:151]
    ds_read_b64_tr_b16 a[44:45], v15 offset:0
    v_mfma_f32_16x16x32_bf16 a[168:171], a[208:211], a[160:163], a[168:171]
    v_mfma_f32_16x16x32_bf16 v[152:155], a[108:111], a[88:91], v[152:155]
    ds_read_b64_tr_b16 a[46:47], v15 offset:1024
    v_mfma_f32_16x16x32_bf16 v[156:159], a[108:111], a[92:95], v[156:159]
    v_mfma_f32_16x16x32_bf16 v[160:163], a[112:115], a[64:67], v[160:163]
    ds_read_b64_tr_b16 a[48:49], v12 offset:49152
    v_mfma_f32_16x16x32_bf16 v[164:167], a[112:115], a[68:71], v[164:167]
    buffer_load_dwordx4 v5, s[8:11], s41 offen offset:3072 lds
    v_mfma_f32_16x16x32_bf16 v[168:171], a[112:115], a[72:75], v[168:171]
    ds_read_b64_tr_b16 a[50:51], v12 offset:50176
    v_mfma_f32_16x16x32_bf16 v[172:175], a[112:115], a[76:79], v[172:175]
    s_add_u32 s40, s40, 128
    s_add_u32 s41, s41, 128
    v_mfma_f32_16x16x32_bf16 v[176:179], a[112:115], a[80:83], v[176:179]
    s_add_u32 m0, s46, 0
    ds_read_b64_tr_b16 a[52:53], v13 offset:49152
    v_mfma_f32_16x16x32_bf16 v[180:183], a[112:115], a[84:87], v[180:183]
    buffer_load_dwordx4 v6, s[12:15], s42 offen offset:0 lds
    v_mfma_f32_16x16x32_bf16 v[184:187], a[112:115], a[88:91], v[184:187]
    ds_read_b64_tr_b16 a[54:55], v13 offset:50176
    v_mfma_f32_16x16x32_bf16 v[188:191], a[112:115], a[92:95], v[188:191]
    v_mfma_f32_16x16x32_bf16 v[192:195], a[116:119], a[64:67], v[192:195]
    ds_read_b64_tr_b16 a[56:57], v14 offset:49152
    v_mfma_f32_16x16x32_bf16 v[196:199], a[116:119], a[68:71], v[196:199]
    buffer_load_dwordx4 v7, s[12:15], s42 offen offset:1024 lds
    v_mfma_f32_16x16x32_bf16 v[200:203], a[116:119], a[72:75], v[200:203]
    ds_read_b64_tr_b16 a[58:59], v14 offset:50176
    v_mfma_f32_16x16x32_bf16 v[204:207], a[116:119], a[76:79], v[204:207]
    v_mfma_f32_16x16x32_bf16 v[208:211], a[116:119], a[80:83], v[208:211]
    ds_read_b64_tr_b16 a[60:61], v16 offset:0
    v_mfma_f32_16x16x32_bf16 v[212:215], a[116:119], a[84:87], v[212:215]
    v_mfma_f32_16x16x32_bf16 v[216:219], a[116:119], a[88:91], v[216:219]
    ds_read_b64_tr_b16 a[62:63], v16 offset:1024
    v_mfma_f32_16x16x32_bf16 v[220:223], a[116:119], a[92:95], v[220:223]
    buffer_load_dwordx4 v8, s[12:15], s42 offen offset:2048 lds
    v_mfma_f32_16x16x32_bf16 v[224:227], a[120:123], a[64:67], v[224:227]
    ds_read_b64_tr_b16 a[204:205], v28 offset:8192
    v_mfma_f32_16x16x32_bf16 a[168:171], a[212:215], a[164:167], a[168:171]
    v_mfma_f32_16x16x32_bf16 v[228:231], a[120:123], a[68:71], v[228:231]
    ds_read_b64_tr_b16 a[206:207], v28 offset:10240
    v_mfma_f32_16x16x32_bf16 v[232:235], a[120:123], a[72:75], v[232:235]
    buffer_load_dwordx4 v9, s[12:15], s42 offen offset:3072 lds
    v_mfma_f32_16x16x32_bf16 v[236:239], a[120:123], a[76:79], v[236:239]
    v_mfma_f32_16x16x32_bf16 v[240:243], a[120:123], a[80:83], v[240:243]
    v_mfma_f32_16x16x32_bf16 v[244:247], a[120:123], a[84:87], v[244:247]
    v_mfma_f32_16x16x32_bf16 v[248:251], a[120:123], a[88:91], v[248:251]
    v_mfma_f32_16x16x32_bf16 v[252:255], a[120:123], a[92:95], v[252:255]
    s_add_u32 m0, s46, 16384
    v_mfma_f32_16x16x32_bf16 a[128:131], a[124:127], a[64:67], a[128:131]
    buffer_load_dwordx4 v6, s[16:19], s42 offen offset:0 lds
    v_mfma_f32_16x16x32_bf16 a[132:135], a[124:127], a[68:71], a[132:135]
    v_mfma_f32_16x16x32_bf16 a[136:139], a[124:127], a[72:75], a[136:139]
    v_mfma_f32_16x16x32_bf16 a[140:143], a[124:127], a[76:79], a[140:143]
    v_mfma_f32_16x16x32_bf16 a[144:147], a[124:127], a[80:83], a[144:147]
    v_mfma_f32_16x16x32_bf16 a[148:151], a[124:127], a[84:87], a[148:151]
    v_mfma_f32_16x16x32_bf16 a[152:155], a[124:127], a[88:91], a[152:155]
    v_mfma_f32_16x16x32_bf16 a[156:159], a[124:127], a[92:95], a[156:159]
    s_waitcnt lgkmcnt(0)
    v_mfma_f32_16x16x32_bf16 v[32:35], a[32:35], a[0:3], v[32:35]
    ds_read_b64_tr_b16 a[96:97], v12 offset:40960
    v_mfma_f32_16x16x32_bf16 v[36:39], a[32:35], a[4:7], v[36:39]
    buffer_load_dwordx4 v7, s[16:19], s42 offen offset:1024 lds
    v_mfma_f32_16x16x32_bf16 v[40:43], a[32:35], a[8:11], v[40:43]
    ds_read_b64_tr_b16 a[98:99], v12 offset:41984
    v_mfma_f32_16x16x32_bf16 v[44:47], a[32:35], a[12:15], v[44:47]
    v_mfma_f32_16x16x32_bf16 v[48:51], a[32:35], a[16:19], v[48:51]
    ds_read_b128 a[64:67], v11 offset:32768
    v_mfma_f32_16x16x32_bf16 v[52:55], a[32:35], a[20:23], v[52:55]
    buffer_load_dwordx4 v8, s[16:19], s42 offen offset:2048 lds
    v_mfma_f32_16x16x32_bf16 v[56:59], a[32:35], a[24:27], v[56:59]
    ds_read_b128 a[68:71], v11 offset:34816
    v_mfma_f32_16x16x32_bf16 v[60:63], a[32:35], a[28:31], v[60:63]
    v_mfma_f32_16x16x32_bf16 v[64:67], a[36:39], a[0:3], v[64:67]
    ds_read_b128 a[72:75], v11 offset:36864
    v_mfma_f32_16x16x32_bf16 v[68:71], a[36:39], a[4:7], v[68:71]
    buffer_load_dwordx4 v9, s[16:19], s42 offen offset:3072 lds
    v_mfma_f32_16x16x32_bf16 v[72:75], a[36:39], a[8:11], v[72:75]
    ds_read_b128 a[76:79], v11 offset:38912
    s_add_u32 s42, s42, 458752
    v_mfma_f32_16x16x32_bf16 v[76:79], a[36:39], a[12:15], v[76:79]
    v_mfma_f32_16x16x32_bf16 v[80:83], a[36:39], a[16:19], v[80:83]
    ds_read_b128 a[80:83], v11 offset:40960
    s_add_u32 m0, s56, 0
    v_mfma_f32_16x16x32_bf16 v[84:87], a[36:39], a[20:23], v[84:87]
    buffer_load_dwordx4 v0, s[4:7], s43 offen lds
    v_mfma_f32_16x16x32_bf16 v[88:91], a[36:39], a[24:27], v[88:91]
    ds_read_b128 a[84:87], v11 offset:43008
    s_add_u32 s43, s43, 0x20000
    s_bitcmp1_b32 s58, 9
    s_cselect_b32 s60, s48, 0x7f000000
    v_mfma_f32_16x16x32_bf16 v[92:95], a[36:39], a[28:31], v[92:95]
    buffer_load_dword a255, v18, s[32:35], s60 offen
    v_mfma_f32_16x16x32_bf16 v[96:99], a[40:43], a[0:3], v[96:99]
    ds_read_b128 a[88:91], v11 offset:45056
    s_add_u32 s60, s60, s59
    s_add_u32 s48, s48, s49
    v_mfma_f32_16x16x32_bf16 v[100:103], a[40:43], a[4:7], v[100:103]
    buffer_load_dword a255, v18, s[32:35], s60 offen
    v_mfma_f32_16x16x32_bf16 v[104:107], a[40:43], a[8:11], v[104:107]
    ds_read_b128 a[92:95], v11 offset:47104
    s_add_u32 m0, s51, 4096
    v_mfma_f32_16x16x32_bf16 v[108:111], a[40:43], a[12:15], v[108:111]
    buffer_load_dwordx4 v29, s[52:55], s3 offen nt lds
    v_mfma_f32_16x16x32_bf16 v[112:115], a[40:43], a[16:19], v[112:115]
    ds_read_b64_tr_b16 a[100:101], v13 offset:40960
    s_add_u32 s3, s3, 65536
    v_mfma_f32_16x16x32_bf16 v[116:119], a[40:43], a[20:23], v[116:119]
    buffer_store_dwordx4 a[204:207], v27, s[24:27], s94 offen sc1
    v_mfma_f32_16x16x32_bf16 v[120:123], a[40:43], a[24:27], v[120:123]
    ds_read_b64_tr_b16 a[102:103], v13 offset:41984
    s_add_u32 s94, s94, 8192
    v_mfma_f32_16x16x32_bf16 v[124:127], a[40:43], a[28:31], v[124:127]
    v_mfma_f32_16x16x32_bf16 v[128:131], a[44:47], a[0:3], v[128:131]
    ds_read_b64_tr_b16 a[104:105], v14 offset:40960
    v_mfma_f32_16x16x32_bf16 v[132:135], a[44:47], a[4:7], v[132:135]
    v_mfma_f32_16x16x32_bf16 v[136:139], a[44:47], a[8:11], v[136:139]
    ds_read_b64_tr_b16 a[106:107], v14 offset:41984
    v_mfma_f32_16x16x32_bf16 v[140:143], a[44:47], a[12:15], v[140:143]
    v_mfma_f32_16x16x32_bf16 v[144:147], a[44:47], a[16:19], v[144:147]
    ds_read_b64_tr_b16 a[108:109], v15 offset:8192
    v_mfma_f32_16x16x32_bf16 v[148:151], a[44:47], a[20:23], v[148:151]
    v_mfma_f32_16x16x32_bf16 v[152:155], a[44:47], a[24:27], v[152:155]
    ds_read_b64_tr_b16 a[110:111], v15 offset:9216
    v_mfma_f32_16x16x32_bf16 v[156:159], a[44:47], a[28:31], v[156:159]
    v_mfma_f32_16x16x32_bf16 v[160:163], a[48:51], a[0:3], v[160:163]
    ds_read_b64_tr_b16 a[112:113], v12 offset:57344
    v_mfma_f32_16x16x32_bf16 v[164:167], a[48:51], a[4:7], v[164:167]
    v_mfma_f32_16x16x32_bf16 v[168:171], a[48:51], a[8:11], v[168:171]
    ds_read_b64_tr_b16 a[114:115], v12 offset:58368
    v_mfma_f32_16x16x32_bf16 v[172:175], a[48:51], a[12:15], v[172:175]
    v_mfma_f32_16x16x32_bf16 v[176:179], a[48:51], a[16:19], v[176:179]
    ds_read_b64_tr_b16 a[116:117], v13 offset:57344
    v_mfma_f32_16x16x32_bf16 v[180:183], a[48:51], a[20:23], v[180:183]
    v_mfma_f32_16x16x32_bf16 v[184:187], a[48:51], a[24:27], v[184:187]
    ds_read_b64_tr_b16 a[118:119], v13 offset:58368
    v_mfma_f32_16x16x32_bf16 v[188:191], a[48:51], a[28:31], v[188:191]
    v_mfma_f32_16x16x32_bf16 v[192:195], a[52:55], a[0:3], v[192:195]
    ds_read_b64_tr_b16 a[120:121], v14 offset:57344
    v_mfma_f32_16x16x32_bf16 v[196:199], a[52:55], a[4:7], v[196:199]
    v_mfma_f32_16x16x32_bf16 v[200:203], a[52:55], a[8:11], v[200:203]
    ds_read_b64_tr_b16 a[122:123], v14 offset:58368
    v_mfma_f32_16x16x32_bf16 v[204:207], a[52:55], a[12:15], v[204:207]
    v_mfma_f32_16x16x32_bf16 v[208:211], a[52:55], a[16:19], v[208:211]
    ds_read_b64_tr_b16 a[124:125], v16 offset:8192
    v_mfma_f32_16x16x32_bf16 v[212:215], a[52:55], a[20:23], v[212:215]
    v_mfma_f32_16x16x32_bf16 v[216:219], a[52:55], a[24:27], v[216:219]
    ds_read_b64_tr_b16 a[126:127], v16 offset:9216
    v_mfma_f32_16x16x32_bf16 v[220:223], a[52:55], a[28:31], v[220:223]
    v_mfma_f32_16x16x32_bf16 v[224:227], a[56:59], a[0:3], v[224:227]
    ds_read_b64_tr_b16 a[160:161], v17 offset:8192
    v_mfma_f32_16x16x32_bf16 v[228:231], a[56:59], a[4:7], v[228:231]
    v_mfma_f32_16x16x32_bf16 v[232:235], a[56:59], a[8:11], v[232:235]
    ds_read_b64_tr_b16 a[162:163], v17 offset:8320
    v_mfma_f32_16x16x32_bf16 v[236:239], a[56:59], a[12:15], v[236:239]
    v_mfma_f32_16x16x32_bf16 v[240:243], a[56:59], a[16:19], v[240:243]
    ds_read_b64_tr_b16 a[164:165], v17 offset:9216
    v_mfma_f32_16x16x32_bf16 v[244:247], a[56:59], a[20:23], v[244:247]
    v_mfma_f32_16x16x32_bf16 v[248:251], a[56:59], a[24:27], v[248:251]
    ds_read_b64_tr_b16 a[166:167], v17 offset:9344
    v_mfma_f32_16x16x32_bf16 v[252:255], a[56:59], a[28:31], v[252:255]
    v_mfma_f32_16x16x32_bf16 a[128:131], a[60:63], a[0:3], a[128:131]
    v_mfma_f32_16x16x32_bf16 a[132:135], a[60:63], a[4:7], a[132:135]
    v_xor_b32 v15, s50, v15
    v_mfma_f32_16x16x32_bf16 a[136:139], a[60:63], a[8:11], a[136:139]
    v_mfma_f32_16x16x32_bf16 a[140:143], a[60:63], a[12:15], a[140:143]
    v_xor_b32 v16, s50, v16
    v_mfma_f32_16x16x32_bf16 a[144:147], a[60:63], a[16:19], a[144:147]
    v_mfma_f32_16x16x32_bf16 a[148:151], a[60:63], a[20:23], a[148:151]
    v_mfma_f32_16x16x32_bf16 a[152:155], a[60:63], a[24:27], a[152:155]
    v_mfma_f32_16x16x32_bf16 a[156:159], a[60:63], a[28:31], a[156:159]
    s_waitcnt vmcnt(4) lgkmcnt(0)
    s_barrier
    s_add_u32 m0, s45, 32768
    v_mfma_f32_16x16x32_bf16 v[32:35], a[96:99], a[64:67], v[32:35]
    buffer_load_dwordx4 v2, s[8:11], s40 offen offset:0 lds
    v_mfma_f32_16x16x32_bf16 v[36:39], a[96:99], a[68:71], v[36:39]
    ds_read_b64_tr_b16 a[32:33], v12 offset:0
    v_mfma_f32_16x16x32_bf16 v[40:43], a[96:99], a[72:75], v[40:43]
    v_permlane32_swap_b32 v25, v24
    v_mfma_f32_16x16x32_bf16 v[44:47], a[96:99], a[76:79], v[44:47]
    ds_read_b64_tr_b16 a[34:35], v12 offset:1024
    v_mfma_f32_16x16x32_bf16 v[48:51], a[96:99], a[80:83], v[48:51]
    buffer_load_dwordx4 v3, s[8:11], s40 offen offset:1024 lds
    v_add_f32 v25, v25, v24
    v_mfma_f32_16x16x32_bf16 v[52:55], a[96:99], a[84:87], v[52:55]
    ds_read_b128 a[0:3], v10 offset:0
    v_mfma_f32_16x16x32_bf16 v[56:59], a[96:99], a[88:91], v[56:59]
    v_add_f32_dpp v25, v25, v25 row_ror:8 row_mask:0xf bank_mask:0xf
    v_mfma_f32_16x16x32_bf16 v[60:63], a[96:99], a[92:95], v[60:63]
    ds_read_b128 a[4:7], v10 offset:2048
    v_mfma_f32_16x16x32_bf16 v[64:67], a[100:103], a[64:67], v[64:67]
    v_add_f32_dpp v25, v25, v25 row_ror:4 row_mask:0xf bank_mask:0xf
    v_mfma_f32_16x16x32_bf16 v[68:71], a[100:103], a[68:71], v[68:71]
    ds_read_b128 a[8:11], v10 offset:4096
    v_mfma_f32_16x16x32_bf16 v[72:75], a[100:103], a[72:75], v[72:75]
    buffer_load_dwordx4 v4, s[8:11], s40 offen offset:2048 lds
    v_add_f32_dpp v25, v25, v25 row_ror:2 row_mask:0xf bank_mask:0xf
    v_mfma_f32_16x16x32_bf16 v[76:79], a[100:103], a[76:79], v[76:79]
    ds_read_b128 a[12:15], v10 offset:6144
    v_mfma_f32_16x16x32_bf16 v[80:83], a[100:103], a[80:83], v[80:83]
    v_add_f32_dpp v25, v25, v25 row_ror:1 row_mask:0xf bank_mask:0xf
    v_mfma_f32_16x16x32_bf16 v[84:87], a[100:103], a[84:87], v[84:87]
    ds_read_b128 a[16:19], v10 offset:8192
    v_mfma_f32_16x16x32_bf16 v[88:91], a[100:103], a[88:91], v[88:91]
    buffer_load_dwordx4 v5, s[8:11], s40 offen offset:3072 lds
    v_mov_b32 v24, v25
    v_mfma_f32_16x16x32_bf16 v[92:95], a[100:103], a[92:95], v[92:95]
    ds_read_b128 a[20:23], v10 offset:10240
    v_mfma_f32_16x16x32_bf16 v[96:99], a[104:107], a[64:67], v[96:99]
    v_permlane16_swap_b32 v25, v24
    v_mfma_f32_16x16x32_bf16 v[100:103], a[104:107], a[68:71], v[100:103]
    ds_read_b128 a[24:27], v10 offset:12288
    v_mfma_f32_16x16x32_bf16 v[104:107], a[104:107], a[72:75], v[104:107]
    v_add_f32 v25, v25, v24
    v_mfma_f32_16x16x32_bf16 v[108:111], a[104:107], a[76:79], v[108:111]
    s_add_u32 m0, s45, 36864
    ds_read_b128 a[28:31], v10 offset:14336
    v_mfma_f32_16x16x32_bf16 v[112:115], a[104:107], a[80:83], v[112:115]
    buffer_load_dwordx4 v2, s[8:11], s41 offen offset:0 lds
    v_cvt_pk_bf16_f32 v25, v25, v25
    v_mfma_f32_16x16x32_bf16 v[116:119], a[104:107], a[84:87], v[116:119]
    ds_read_b64_tr_b16 a[36:37], v13 offset:0
    v_mfma_f32_16x16x32_bf16 v[120:123], a[104:107], a[88:91], v[120:123]
    v_lshlrev_b32 v25, 16, v25
    v_mfma_f32_16x16x32_bf16 v[124:127], a[104:107], a[92:95], v[124:127]
    ds_read_b64_tr_b16 a[38:39], v13 offset:1024
    v_mfma_f32_16x16x32_bf16 v[128:131], a[108:111], a[64:67], v[128:131]
    buffer_load_dwordx4 v3, s[8:11], s41 offen offset:1024 lds
    v_mul_f32 v25, 0xbfb8aa3b, v25
    v_mfma_f32_16x16x32_bf16 v[132:135], a[108:111], a[68:71], v[132:135]
    ds_read_b64_tr_b16 a[40:41], v14 offset:0
    v_mfma_f32_16x16x32_bf16 v[136:139], a[108:111], a[72:75], v[136:139]
    v_exp_f32 v25, v25
    v_mfma_f32_16x16x32_bf16 v[140:143], a[108:111], a[76:79], v[140:143]
    ds_read_b64_tr_b16 a[42:43], v14 offset:1024
    v_mfma_f32_16x16x32_bf16 v[144:147], a[108:111], a[80:83], v[144:147]
    buffer_load_dwordx4 v4, s[8:11], s41 offen offset:2048 lds
    v_add_f32 v25, 1.0, v25
    v_mfma_f32_16x16x32_bf16 v[148:151], a[108:111], a[84:87], v[148:151]
    ds_read_b64_tr_b16 a[44:45], v15 offset:0
    v_mfma_f32_16x16x32_bf16 a[168:171], a[216:219], a[160:163], a[168:171]
    v_rcp_f32 v25, v25
    v_mfma_f32_16x16x32_bf16 v[152:155], a[108:111], a[88:91], v[152:155]
    ds_read_b64_tr_b16 a[46:47], v15 offset:1024
    v_mfma_f32_16x16x32_bf16 v[156:159], a[108:111], a[92:95], v[156:159]
    v_cvt_pk_bf16_f32 v25, v25, v25
    v_mfma_f32_16x16x32_bf16 v[160:163], a[112:115], a[64:67], v[160:163]
    ds_read_b64_tr_b16 a[48:49], v12 offset:16384
    v_mfma_f32_16x16x32_bf16 v[164:167], a[112:115], a[68:71], v[164:167]
    buffer_load_dwordx4 v5, s[8:11], s41 offen offset:3072 lds
    v_lshlrev_b32 v24, 16, v25
    v_mfma_f32_16x16x32_bf16 v[168:171], a[112:115], a[72:75], v[168:171]
    ds_read_b64_tr_b16 a[50:51], v12 offset:17408
    v_mfma_f32_16x16x32_bf16 v[172:175], a[112:115], a[76:79], v[172:175]
    s_add_u32 s40, s40, 128
    s_add_u32 s41, s41, 128
    v_sub_f32 v25, 1.0, v24
    v_mfma_f32_16x16x32_bf16 v[176:179], a[112:115], a[80:83], v[176:179]
    s_add_u32 m0, s46, 32768
    ds_read_b64_tr_b16 a[52:53], v13 offset:16384
    v_mfma_f32_16x16x32_bf16 v[180:183], a[112:115], a[84:87], v[180:183]
    buffer_load_dwordx4 v6, s[12:15], s42 offen offset:0 lds
    v_cvt_pk_bf16_f32 v25, v25, v25
    v_mfma_f32_16x16x32_bf16 v[184:187], a[112:115], a[88:91], v[184:187]
    ds_read_b64_tr_b16 a[54:55], v13 offset:17408
    v_mfma_f32_16x16x32_bf16 v[188:191], a[112:115], a[92:95], v[188:191]
    v_lshlrev_b32 v25, 16, v25
    v_mfma_f32_16x16x32_bf16 v[192:195], a[116:119], a[64:67], v[192:195]
    ds_read_b64_tr_b16 a[56:57], v14 offset:16384
    v_mfma_f32_16x16x32_bf16 v[196:199], a[116:119], a[68:71], v[196:199]
    buffer_load_dwordx4 v7, s[12:15], s42 offen offset:1024 lds
    v_max_f32 v25, 0x2b800000, v25
    v_mfma_f32_16x16x32_bf16 v[200:203], a[116:119], a[72:75], v[200:203]
    ds_read_b64_tr_b16 a[58:59], v14 offset:17408
    v_mfma_f32_16x16x32_bf16 v[204:207], a[116:119], a[76:79], v[204:207]
    v_rcp_f32 v23, v25
    v_mfma_f32_16x16x32_bf16 v[208:211], a[116:119], a[80:83], v[208:211]
    ds_read_b64_tr_b16 a[60:61], v16 offset:0
    v_mfma_f32_16x16x32_bf16 v[212:215], a[116:119], a[84:87], v[212:215]
    v_mul_f32 v24, v24, v23
    v_mfma_f32_16x16x32_bf16 v[216:219], a[116:119], a[88:91], v[216:219]
    ds_read_b64_tr_b16 a[62:63], v16 offset:1024
    v_mfma_f32_16x16x32_bf16 v[220:223], a[116:119], a[92:95], v[220:223]
    buffer_load_dwordx4 v8, s[12:15], s42 offen offset:2048 lds
    v_mfma_f32_16x16x32_bf16 v[224:227], a[120:123], a[64:67], v[224:227]
    ds_read_b64_tr_b16 a[204:205], v28 offset:0
    v_mfma_f32_16x16x32_bf16 a[168:171], a[220:223], a[164:167], a[168:171]
    v_mfma_f32_16x16x32_bf16 v[228:231], a[120:123], a[68:71], v[228:231]
    ds_read_b64_tr_b16 a[206:207], v28 offset:2048
    v_mfma_f32_16x16x32_bf16 v[232:235], a[120:123], a[72:75], v[232:235]
    buffer_load_dwordx4 v9, s[12:15], s42 offen offset:3072 lds
    v_mfma_f32_16x16x32_bf16 v[236:239], a[120:123], a[76:79], v[236:239]
    v_mfma_f32_16x16x32_bf16 v[240:243], a[120:123], a[80:83], v[240:243]
    v_mfma_f32_16x16x32_bf16 v[244:247], a[120:123], a[84:87], v[244:247]
    v_mfma_f32_16x16x32_bf16 v[248:251], a[120:123], a[88:91], v[248:251]
    v_mfma_f32_16x16x32_bf16 v[252:255], a[120:123], a[92:95], v[252:255]
    s_add_u32 m0, s46, 49152
    v_mfma_f32_16x16x32_bf16 a[128:131], a[124:127], a[64:67], a[128:131]
    buffer_load_dwordx4 v6, s[16:19], s42 offen offset:0 lds
    v_mfma_f32_16x16x32_bf16 a[132:135], a[124:127], a[68:71], a[132:135]
    v_mfma_f32_16x16x32_bf16 a[136:139], a[124:127], a[72:75], a[136:139]
    v_mfma_f32_16x16x32_bf16 a[140:143], a[124:127], a[76:79], a[140:143]
    v_mfma_f32_16x16x32_bf16 a[144:147], a[124:127], a[80:83], a[144:147]
    v_mfma_f32_16x16x32_bf16 a[148:151], a[124:127], a[84:87], a[148:151]
    v_mfma_f32_16x16x32_bf16 a[152:155], a[124:127], a[88:91], a[152:155]
    v_mfma_f32_16x16x32_bf16 a[156:159], a[124:127], a[92:95], a[156:159]
    s_waitcnt lgkmcnt(0)
    v_mfma_f32_16x16x32_bf16 v[32:35], a[32:35], a[0:3], v[32:35]
    ds_read_b64_tr_b16 a[96:97], v12 offset:8192
    v_mfma_f32_16x16x32_bf16 v[36:39], a[32:35], a[4:7], v[36:39]
    v_add_u32 v21, 135168, v27
    v_mfma_f32_16x16x32_bf16 v[40:43], a[32:35], a[8:11], v[40:43]
    ds_read_b64_tr_b16 a[98:99], v12 offset:9216
    v_mfma_f32_16x16x32_bf16 v[44:47], a[32:35], a[12:15], v[44:47]
    s_lshl_b32 s82, s36, 10
    v_mfma_f32_16x16x32_bf16 v[48:51], a[32:35], a[16:19], v[48:51]
    ds_read_b128 a[64:67], v11 offset:0
    v_mfma_f32_16x16x32_bf16 v[52:55], a[32:35], a[20:23], v[52:55]
    v_add_u32 v22, s82, v21
    v_mfma_f32_16x16x32_bf16 v[56:59], a[32:35], a[24:27], v[56:59]
    ds_read_b128 a[68:71], v11 offset:2048
    v_mfma_f32_16x16x32_bf16 v[60:63], a[32:35], a[28:31], v[60:63]
    s_xor_b32 s82, s82, 2048
    v_mfma_f32_16x16x32_bf16 v[64:67], a[36:39], a[0:3], v[64:67]
    ds_read_b128 a[72:75], v11 offset:4096
    v_mfma_f32_16x16x32_bf16 v[68:71], a[36:39], a[4:7], v[68:71]
    v_add_u32 v21, s82, v21
    v_mfma_f32_16x16x32_bf16 v[72:75], a[36:39], a[8:11], v[72:75]
    ds_read_b128 a[76:79], v11 offset:6144
    v_mfma_f32_16x16x32_bf16 v[76:79], a[36:39], a[12:15], v[76:79]
    buffer_load_dwordx4 v7, s[16:19], s42 offen offset:1024 lds
    v_mfma_f32_16x16x32_bf16 v[80:83], a[36:39], a[16:19], v[80:83]
    ds_read_b128 a[80:83], v11 offset:8192
    v_mfma_f32_16x16x32_bf16 v[84:87], a[36:39], a[20:23], v[84:87]
    v_mfma_f32_16x16x32_bf16 v[88:91], a[36:39], a[24:27], v[88:91]
    ds_read_b128 a[84:87], v11 offset:10240
    v_mfma_f32_16x16x32_bf16 v[92:95], a[36:39], a[28:31], v[92:95]
    buffer_load_dwordx4 v8, s[16:19], s42 offen offset:2048 lds
    v_mfma_f32_16x16x32_bf16 v[96:99], a[40:43], a[0:3], v[96:99]
    ds_read_b128 a[88:91], v11 offset:12288
    v_mfma_f32_16x16x32_bf16 v[100:103], a[40:43], a[4:7], v[100:103]
    v_mfma_f32_16x16x32_bf16 v[104:107], a[40:43], a[8:11], v[104:107]
    ds_read_b128 a[92:95], v11 offset:14336
    v_mfma_f32_16x16x32_bf16 v[108:111], a[40:43], a[12:15], v[108:111]
    buffer_load_dwordx4 v9, s[16:19], s42 offen offset:3072 lds
    v_mfma_f32_16x16x32_bf16 v[112:115], a[40:43], a[16:19], v[112:115]
    ds_read_b64_tr_b16 a[100:101], v13 offset:8192
    s_add_u32 s42, s42, 458752
    v_mfma_f32_16x16x32_bf16 v[116:119], a[40:43], a[20:23], v[116:119]
    v_mfma_f32_16x16x32_bf16 v[120:123], a[40:43], a[24:27], v[120:123]
    ds_read_b64_tr_b16 a[102:103], v13 offset:9216
    s_add_u32 m0, s56, 2048
    v_mfma_f32_16x16x32_bf16 v[124:127], a[40:43], a[28:31], v[124:127]
    buffer_load_dwordx4 v0, s[4:7], s43 offen lds
    v_mfma_f32_16x16x32_bf16 v[128:131], a[44:47], a[0:3], v[128:131]
    ds_read_b64_tr_b16 a[104:105], v14 offset:8192
    s_add_u32 s43, s43, 0x20000
    s_bitcmp1_b32 s58, 10
    s_cselect_b32 s60, s48, 0x7f000000
    v_mfma_f32_16x16x32_bf16 v[132:135], a[44:47], a[4:7], v[132:135]
    buffer_load_dword a255, v18, s[32:35], s60 offen
    v_mfma_f32_16x16x32_bf16 v[136:139], a[44:47], a[8:11], v[136:139]
    ds_read_b64_tr_b16 a[106:107], v14 offset:9216
    s_add_u32 s60, s60, s59
    s_add_u32 s48, s48, s49
    v_mfma_f32_16x16x32_bf16 v[140:143], a[44:47], a[12:15], v[140:143]
    buffer_load_dword a255, v18, s[32:35], s60 offen
    v_mfma_f32_16x16x32_bf16 v[144:147], a[44:47], a[16:19], v[144:147]
    ds_read_b64_tr_b16 a[108:109], v15 offset:8192
    s_add_u32 m0, s51, 8192
    v_mfma_f32_16x16x32_bf16 v[148:151], a[44:47], a[20:23], v[148:151]
    buffer_load_dwordx4 v29, s[52:55], s3 offen nt lds
    v_mfma_f32_16x16x32_bf16 v[152:155], a[44:47], a[24:27], v[152:155]
    ds_read_b64_tr_b16 a[110:111], v15 offset:9216
    s_add_u32 s3, s3, 65536
    v_mfma_f32_16x16x32_bf16 v[156:159], a[44:47], a[28:31], v[156:159]
    buffer_store_dwordx4 a[204:207], v27, s[24:27], s94 offen sc1
    v_mfma_f32_16x16x32_bf16 v[160:163], a[48:51], a[0:3], v[160:163]
    ds_read_b64_tr_b16 a[112:113], v12 offset:24576
KM_PAD5:
    s_cbranch_execz KM_RET1
    s_nop 0
    s_add_u32 s94, s94, 8192
    v_mfma_f32_16x16x32_bf16 v[164:167], a[48:51], a[4:7], v[164:167]
    s_mov_b32 exec_lo, 1
    s_mov_b32 exec_hi, 1
    buffer_store_dwordx2 v[24:25], v26, s[24:27], 0 offen sc1
    s_mov_b64 exec, -1
    v_mfma_f32_16x16x32_bf16 v[168:171], a[48:51], a[8:11], v[168:171]
    ds_read_b64_tr_b16 a[114:115], v12 offset:25600
    v_mfma_f32_16x16x32_bf16 v[172:175], a[48:51], a[12:15], v[172:175]
    v_mfma_f32_16x16x32_bf16 v[176:179], a[48:51], a[16:19], v[176:179]
    ds_read_b64_tr_b16 a[116:117], v13 offset:24576
    v_mfma_f32_16x16x32_bf16 v[180:183], a[48:51], a[20:23], v[180:183]
    v_mfma_f32_16x16x32_bf16 v[184:187], a[48:51], a[24:27], v[184:187]
    ds_read_b64_tr_b16 a[118:119], v13 offset:25600
    v_mfma_f32_16x16x32_bf16 v[188:191], a[48:51], a[28:31], v[188:191]
    v_mfma_f32_16x16x32_bf16 v[192:195], a[52:55], a[0:3], v[192:195]
    ds_read_b64_tr_b16 a[120:121], v14 offset:24576
    v_mfma_f32_16x16x32_bf16 v[196:199], a[52:55], a[4:7], v[196:199]
    v_mfma_f32_16x16x32_bf16 v[200:203], a[52:55], a[8:11], v[200:203]
    ds_read_b64_tr_b16 a[122:123], v14 offset:25600
    v_mfma_f32_16x16x32_bf16 v[204:207], a[52:55], a[12:15], v[204:207]
    v_mfma_f32_16x16x32_bf16 v[208:211], a[52:55], a[16:19], v[208:211]
    ds_read_b64_tr_b16 a[124:125], v16 offset:8192
    v_mfma_f32_16x16x32_bf16 v[212:215], a[52:55], a[20:23], v[212:215]
    v_mfma_f32_16x16x32_bf16 v[216:219], a[52:55], a[24:27], v[216:219]
    ds_read_b64_tr_b16 a[126:127], v16 offset:9216
    v_mfma_f32_16x16x32_bf16 v[220:223], a[52:55], a[28:31], v[220:223]
    v_mfma_f32_16x16x32_bf16 v[224:227], a[56:59], a[0:3], v[224:227]
    ds_write_b128 v22, a[168:171]
    v_mfma_f32_16x16x32_bf16 v[228:231], a[56:59], a[4:7], v[228:231]
    v_mfma_f32_16x16x32_bf16 v[232:235], a[56:59], a[8:11], v[232:235]
    v_mfma_f32_16x16x32_bf16 v[236:239], a[56:59], a[12:15], v[236:239]
    v_mfma_f32_16x16x32_bf16 v[240:243], a[56:59], a[16:19], v[240:243]
    v_mfma_f32_16x16x32_bf16 v[244:247], a[56:59], a[20:23], v[244:247]
    v_mfma_f32_16x16x32_bf16 v[248:251], a[56:59], a[24:27], v[248:251]
    v_mfma_f32_16x16x32_bf16 v[252:255], a[56:59], a[28:31], v[252:255]
    v_mfma_f32_16x16x32_bf16 a[128:131], a[60:63], a[0:3], a[128:131]
    v_mfma_f32_16x16x32_bf16 a[132:135], a[60:63], a[4:7], a[132:135]
    v_xor_b32 v15, s50, v15
    v_mfma_f32_16x16x32_bf16 a[136:139], a[60:63], a[8:11], a[136:139]
    v_mfma_f32_16x16x32_bf16 a[140:143], a[60:63], a[12:15], a[140:143]
    v_xor_b32 v16, s50, v16
    v_mfma_f32_16x16x32_bf16 a[144:147], a[60:63], a[16:19], a[144:147]
    v_mfma_f32_16x16x32_bf16 a[148:151], a[60:63], a[20:23], a[148:151]
    v_mfma_f32_16x16x32_bf16 a[152:155], a[60:63], a[24:27], a[152:155]
    v_mfma_f32_16x16x32_bf16 a[156:159], a[60:63], a[28:31], a[156:159]
    s_waitcnt vmcnt(5) lgkmcnt(0)
    s_barrier
    s_add_u32 m0, s45, 0
    v_mfma_f32_16x16x32_bf16 v[32:35], a[96:99], a[64:67], v[32:35]
    buffer_load_dwordx4 v2, s[8:11], s40 offen offset:0 lds
    v_mfma_f32_16x16x32_bf16 v[36:39], a[96:99], a[68:71], v[36:39]
    ds_read_b64_tr_b16 a[32:33], v12 offset:32768
    v_mfma_f32_16x16x32_bf16 v[40:43], a[96:99], a[72:75], v[40:43]
    v_mfma_f32_16x16x32_bf16 v[44:47], a[96:99], a[76:79], v[44:47]
    ds_read_b64_tr_b16 a[34:35], v12 offset:33792
    s_lshl_b32 s82, s37, 3
    v_mfma_f32_16x16x32_bf16 v[48:51], a[96:99], a[80:83], v[48:51]
    buffer_load_dwordx4 v3, s[8:11], s40 offen offset:1024 lds
    v_mfma_f32_16x16x32_bf16 v[52:55], a[96:99], a[84:87], v[52:55]
    ds_read_b128 a[0:3], v10 offset:32768
    s_lshr_b32 s83, s38, 2
    v_mfma_f32_16x16x32_bf16 v[56:59], a[96:99], a[88:91], v[56:59]
    v_mfma_f32_16x16x32_bf16 v[60:63], a[96:99], a[92:95], v[60:63]
    ds_read_b128 a[4:7], v10 offset:34816
    s_add_u32 s82, s82, s83
    v_mfma_f32_16x16x32_bf16 v[64:67], a[100:103], a[64:67], v[64:67]
    v_mfma_f32_16x16x32_bf16 v[68:71], a[100:103], a[68:71], v[68:71]
    ds_read_b128 a[8:11], v10 offset:36864
    s_lshl_b32 s82, s82, 12
    v_mfma_f32_16x16x32_bf16 v[72:75], a[100:103], a[72:75], v[72:75]
    buffer_load_dwordx4 v4, s[8:11], s40 offen offset:2048 lds
    v_mfma_f32_16x16x32_bf16 v[76:79], a[100:103], a[76:79], v[76:79]
    ds_read_b128 a[12:15], v10 offset:38912
    s_add_u32 s82, s82, 0x1200000
    v_mfma_f32_16x16x32_bf16 v[80:83], a[100:103], a[80:83], v[80:83]
    v_mfma_f32_16x16x32_bf16 v[84:87], a[100:103], a[84:87], v[84:87]
    ds_read_b128 a[16:19], v10 offset:40960
    s_and_b32 s85, s38, 1
    v_mfma_f32_16x16x32_bf16 v[88:91], a[100:103], a[88:91], v[88:91]
    buffer_load_dwordx4 v5, s[8:11], s40 offen offset:3072 lds
    v_mfma_f32_16x16x32_bf16 v[92:95], a[100:103], a[92:95], v[92:95]
    ds_read_b128 a[20:23], v10 offset:43008
    s_lshl_b32 s83, s85, 3
    v_mfma_f32_16x16x32_bf16 v[96:99], a[104:107], a[64:67], v[96:99]
    v_mfma_f32_16x16x32_bf16 v[100:103], a[104:107], a[68:71], v[100:103]
    ds_read_b128 a[24:27], v10 offset:45056
    s_add_u32 s83, s83, s82
    v_mfma_f32_16x16x32_bf16 v[104:107], a[104:107], a[72:75], v[104:107]
    v_mfma_f32_16x16x32_bf16 v[108:111], a[104:107], a[76:79], v[108:111]
    s_add_u32 m0, s45, 4096
    ds_read_b128 a[28:31], v10 offset:47104
    s_lshl_b32 s85, s85, 8
    v_mfma_f32_16x16x32_bf16 v[112:115], a[104:107], a[80:83], v[112:115]
    buffer_load_dwordx4 v2, s[8:11], s41 offen offset:0 lds
    v_mfma_f32_16x16x32_bf16 v[116:119], a[104:107], a[84:87], v[116:119]
    ds_read_b64_tr_b16 a[36:37], v13 offset:32768
    s_add_u32 s82, s82, s85
    v_mfma_f32_16x16x32_bf16 v[120:123], a[104:107], a[88:91], v[120:123]
    v_mfma_f32_16x16x32_bf16 v[124:127], a[104:107], a[92:95], v[124:127]
    ds_read_b64_tr_b16 a[38:39], v13 offset:33792
    s_lshl_b32 s85, s36, 10
    v_mfma_f32_16x16x32_bf16 v[128:131], a[108:111], a[64:67], v[128:131]
    buffer_load_dwordx4 v3, s[8:11], s41 offen offset:1024 lds
    v_mfma_f32_16x16x32_bf16 v[132:135], a[108:111], a[68:71], v[132:135]
    ds_read_b64_tr_b16 a[40:41], v14 offset:32768
    s_add_u32 s82, s82, s85
    v_mfma_f32_16x16x32_bf16 v[136:139], a[108:111], a[72:75], v[136:139]
    v_mfma_f32_16x16x32_bf16 v[140:143], a[108:111], a[76:79], v[140:143]
    ds_read_b64_tr_b16 a[42:43], v14 offset:33792
    s_lshl_b32 s85, s36, 8
    v_mfma_f32_16x16x32_bf16 v[144:147], a[108:111], a[80:83], v[144:147]
    buffer_load_dwordx4 v4, s[8:11], s41 offen offset:2048 lds
    v_mfma_f32_16x16x32_bf16 v[148:151], a[108:111], a[84:87], v[148:151]
    ds_read_b64_tr_b16 a[44:45], v15 offset:0
    s_add_u32 s83, s83, s85
    v_mfma_f32_16x16x32_bf16 v[152:155], a[108:111], a[88:91], v[152:155]
    v_mfma_f32_16x16x32_bf16 v[156:159], a[108:111], a[92:95], v[156:159]
    ds_read_b64_tr_b16 a[46:47], v15 offset:1024
    s_and_b32 s85, s38, 2
    v_mfma_f32_16x16x32_bf16 v[160:163], a[112:115], a[64:67], v[160:163]
    v_mfma_f32_16x16x32_bf16 v[164:167], a[112:115], a[68:71], v[164:167]
    ds_read_b64_tr_b16 a[48:49], v12 offset:49152
    s_cmp_eq_u32 s85, 0
    s_cselect_b32 s84, 0x3e8293ee, 1.0
    s_cselect_b32 s82, 0x7f000000, s82
    s_cselect_b32 s83, s83, 0x7f000000
    v_mfma_f32_16x16x32_bf16 v[168:171], a[112:115], a[72:75], v[168:171]
    buffer_load_dwordx4 v5, s[8:11], s41 offen offset:3072 lds
    v_mfma_f32_16x16x32_bf16 v[172:175], a[112:115], a[76:79], v[172:175]
    ds_read_b64_tr_b16 a[50:51], v12 offset:50176
    s_cmp_ge_u32 s36, 2
    s_cselect_b32 s82, 0x7f000000, s82
    s_cselect_b32 s83, 0x7f000000, s83
    v_mfma_f32_16x16x32_bf16 v[176:179], a[112:115], a[80:83], v[176:179]
    s_add_u32 s40, s40, 128
    s_add_u32 s41, s41, 128
    v_mfma_f32_16x16x32_bf16 v[180:183], a[112:115], a[84:87], v[180:183]
    s_add_u32 m0, s46, 0
    ds_read_b64_tr_b16 a[52:53], v13 offset:49152
    v_mfma_f32_16x16x32_bf16 v[184:187], a[112:115], a[88:91], v[184:187]
    buffer_load_dwordx4 v6, s[12:15], s42 offen offset:0 lds
    v_mfma_f32_16x16x32_bf16 v[188:191], a[112:115], a[92:95], v[188:191]
    ds_read_b64_tr_b16 a[54:55], v13 offset:50176
    v_mfma_f32_16x16x32_bf16 v[192:195], a[116:119], a[64:67], v[192:195]
    v_mfma_f32_16x16x32_bf16 v[196:199], a[116:119], a[68:71], v[196:199]
    ds_read_b64_tr_b16 a[56:57], v14 offset:49152
    v_mfma_f32_16x16x32_bf16 v[200:203], a[116:119], a[72:75], v[200:203]
    buffer_load_dwordx4 v7, s[12:15], s42 offen offset:1024 lds
    v_mfma_f32_16x16x32_bf16 v[204:207], a[116:119], a[76:79], v[204:207]
    ds_read_b64_tr_b16 a[58:59], v14 offset:50176
    v_mfma_f32_16x16x32_bf16 v[208:211], a[116:119], a[80:83], v[208:211]
    v_mfma_f32_16x16x32_bf16 v[212:215], a[116:119], a[84:87], v[212:215]
    ds_read_b64_tr_b16 a[60:61], v16 offset:0
    v_mfma_f32_16x16x32_bf16 v[216:219], a[116:119], a[88:91], v[216:219]
    v_mfma_f32_16x16x32_bf16 v[220:223], a[116:119], a[92:95], v[220:223]
    ds_read_b64_tr_b16 a[62:63], v16 offset:1024
    v_mfma_f32_16x16x32_bf16 v[224:227], a[120:123], a[64:67], v[224:227]
    buffer_load_dwordx4 v8, s[12:15], s42 offen offset:2048 lds
    v_mfma_f32_16x16x32_bf16 v[228:231], a[120:123], a[68:71], v[228:231]
    ds_read_b64_tr_b16 a[204:205], v28 offset:4096
    v_mfma_f32_16x16x32_bf16 v[232:235], a[120:123], a[72:75], v[232:235]
    v_mfma_f32_16x16x32_bf16 v[236:239], a[120:123], a[76:79], v[236:239]
    ds_read_b64_tr_b16 a[206:207], v28 offset:6144
    v_mfma_f32_16x16x32_bf16 v[240:243], a[120:123], a[80:83], v[240:243]
    buffer_load_dwordx4 v9, s[12:15], s42 offen offset:3072 lds
    v_mfma_f32_16x16x32_bf16 v[244:247], a[120:123], a[84:87], v[244:247]
    ds_read_b128 a[160:163], v21
    v_mfma_f32_16x16x32_bf16 v[248:251], a[120:123], a[88:91], v[248:251]
    v_mfma_f32_16x16x32_bf16 v[252:255], a[120:123], a[92:95], v[252:255]
    v_mfma_f32_16x16x32_bf16 a[128:131], a[124:127], a[64:67], a[128:131]
    v_mfma_f32_16x16x32_bf16 a[132:135], a[124:127], a[68:71], a[132:135]
    s_add_u32 m0, s46, 16384
    v_mfma_f32_16x16x32_bf16 a[136:139], a[124:127], a[72:75], a[136:139]
    buffer_load_dwordx4 v6, s[16:19], s42 offen offset:0 lds
    v_mfma_f32_16x16x32_bf16 a[140:143], a[124:127], a[76:79], a[140:143]
    v_mfma_f32_16x16x32_bf16 a[144:147], a[124:127], a[80:83], a[144:147]
    v_mfma_f32_16x16x32_bf16 a[148:151], a[124:127], a[84:87], a[148:151]
    v_mfma_f32_16x16x32_bf16 a[152:155], a[124:127], a[88:91], a[152:155]
    v_mfma_f32_16x16x32_bf16 a[156:159], a[124:127], a[92:95], a[156:159]
    s_waitcnt lgkmcnt(0)
    v_mfma_f32_16x16x32_bf16 v[32:35], a[32:35], a[0:3], v[32:35]
    ds_read_b64_tr_b16 a[96:97], v12 offset:40960
    v_mfma_f32_16x16x32_bf16 v[36:39], a[32:35], a[4:7], v[36:39]
    buffer_load_dwordx4 v7, s[16:19], s42 offen offset:1024 lds
    v_mfma_f32_16x16x32_bf16 v[40:43], a[32:35], a[8:11], v[40:43]
    ds_read_b64_tr_b16 a[98:99], v12 offset:41984
    v_mfma_f32_16x16x32_bf16 v[44:47], a[32:35], a[12:15], v[44:47]
    v_mfma_f32_16x16x32_bf16 v[48:51], a[32:35], a[16:19], v[48:51]
    ds_read_b128 a[64:67], v11 offset:32768
    v_mfma_f32_16x16x32_bf16 v[52:55], a[32:35], a[20:23], v[52:55]
    buffer_load_dwordx4 v8, s[16:19], s42 offen offset:2048 lds
    v_mfma_f32_16x16x32_bf16 v[56:59], a[32:35], a[24:27], v[56:59]
    ds_read_b128 a[68:71], v11 offset:34816
    v_mfma_f32_16x16x32_bf16 v[60:63], a[32:35], a[28:31], v[60:63]
    v_mfma_f32_16x16x32_bf16 v[64:67], a[36:39], a[0:3], v[64:67]
    ds_read_b128 a[72:75], v11 offset:36864
    v_mfma_f32_16x16x32_bf16 v[68:71], a[36:39], a[4:7], v[68:71]
    buffer_load_dwordx4 v9, s[16:19], s42 offen offset:3072 lds
    v_mfma_f32_16x16x32_bf16 v[72:75], a[36:39], a[8:11], v[72:75]
    ds_read_b128 a[76:79], v11 offset:38912
    s_add_u32 s42, s42, 458752
    v_mfma_f32_16x16x32_bf16 v[76:79], a[36:39], a[12:15], v[76:79]
    v_mfma_f32_16x16x32_bf16 v[80:83], a[36:39], a[16:19], v[80:83]
    ds_read_b128 a[80:83], v11 offset:40960
    s_add_u32 m0, s56, 0
    v_mfma_f32_16x16x32_bf16 v[84:87], a[36:39], a[20:23], v[84:87]
    buffer_load_dwordx4 v0, s[4:7], s43 offen lds
    v_mfma_f32_16x16x32_bf16 v[88:91], a[36:39], a[24:27], v[88:91]
    ds_read_b128 a[84:87], v11 offset:43008
    s_add_u32 s43, s43, 0x20000
    s_bitcmp1_b32 s58, 11
    s_cselect_b32 s60, s48, 0x7f000000
    v_mfma_f32_16x16x32_bf16 v[92:95], a[36:39], a[28:31], v[92:95]
    buffer_load_dword a255, v18, s[32:35], s60 offen
    v_mfma_f32_16x16x32_bf16 v[96:99], a[40:43], a[0:3], v[96:99]
    ds_read_b128 a[88:91], v11 offset:45056
    s_add_u32 s60, s60, s59
    s_add_u32 s48, s48, s49
    v_mfma_f32_16x16x32_bf16 v[100:103], a[40:43], a[4:7], v[100:103]
    buffer_load_dword a255, v18, s[32:35], s60 offen
    v_lshrrev_b32 v19, 5, v20
    v_mfma_f32_16x16x32_bf16 v[104:107], a[40:43], a[8:11], v[104:107]
    ds_read_b128 a[92:95], v11 offset:47104
    s_add_u32 m0, s51, 0
    v_lshl_add_u32 v19, v19, 13, v29
    v_mfma_f32_16x16x32_bf16 v[108:111], a[40:43], a[12:15], v[108:111]
    buffer_load_dwordx4 v19, s[52:55], s44 offen nt lds
    v_mfma_f32_16x16x32_bf16 v[112:115], a[40:43], a[16:19], v[112:115]
    ds_read_b64_tr_b16 a[100:101], v13 offset:40960
    v_accvgpr_read_b32 v21, a168
    v_mfma_f32_16x16x32_bf16 v[116:119], a[40:43], a[20:23], v[116:119]
    buffer_store_dwordx4 a[204:207], v27, s[24:27], s94 offen sc1
    v_mfma_f32_16x16x32_bf16 v[120:123], a[40:43], a[24:27], v[120:123]
    ds_read_b64_tr_b16 a[102:103], v13 offset:41984
    s_add_u32 s94, s94, 8192
    v_accvgpr_read_b32 v22, a169
    v_mfma_f32_16x16x32_bf16 v[124:127], a[40:43], a[28:31], v[124:127]
    buffer_load_dword a254, off, s[72:75], 0 sc1
    v_mfma_f32_16x16x32_bf16 v[128:131], a[44:47], a[0:3], v[128:131]
    ds_read_b64_tr_b16 a[104:105], v14 offset:40960
    v_accvgpr_read_b32 v23, a170
    v_mfma_f32_16x16x32_bf16 v[132:135], a[44:47], a[4:7], v[132:135]
    v_accvgpr_read_b32 v24, a171
    v_accvgpr_read_b32 v1, a160
    v_mfma_f32_16x16x32_bf16 v[136:139], a[44:47], a[8:11], v[136:139]
    ds_read_b64_tr_b16 a[106:107], v14 offset:41984
    v_add_f32 v21, v21, v1
    v_mfma_f32_16x16x32_bf16 v[140:143], a[44:47], a[12:15], v[140:143]
    v_mul_f32 v21, s84, v21
    v_accvgpr_read_b32 v1, a161
    v_mfma_f32_16x16x32_bf16 v[144:147], a[44:47], a[16:19], v[144:147]
    ds_read_b64_tr_b16 a[108:109], v15 offset:8192
    v_add_f32 v22, v22, v1
    v_mfma_f32_16x16x32_bf16 v[148:151], a[44:47], a[20:23], v[148:151]
    v_mul_f32 v22, s84, v22
    v_accvgpr_read_b32 v1, a162
    v_mfma_f32_16x16x32_bf16 v[152:155], a[44:47], a[24:27], v[152:155]
    ds_read_b64_tr_b16 a[110:111], v15 offset:9216
    v_add_f32 v23, v23, v1
    v_mfma_f32_16x16x32_bf16 v[156:159], a[44:47], a[28:31], v[156:159]
    v_mul_f32 v23, s84, v23
    v_accvgpr_read_b32 v1, a163
    v_mfma_f32_16x16x32_bf16 v[160:163], a[48:51], a[0:3], v[160:163]
    ds_read_b64_tr_b16 a[112:113], v12 offset:57344
    v_add_f32 v24, v24, v1
    v_mfma_f32_16x16x32_bf16 v[164:167], a[48:51], a[4:7], v[164:167]
    v_mul_f32 v24, s84, v24
    v_cvt_pk_bf16_f32 v22, v21, v22
    v_mfma_f32_16x16x32_bf16 v[168:171], a[48:51], a[8:11], v[168:171]
    ds_read_b64_tr_b16 a[114:115], v12 offset:58368
    v_cvt_pk_bf16_f32 v23, v23, v24
    v_mfma_f32_16x16x32_bf16 v[172:175], a[48:51], a[12:15], v[172:175]
    v_and_b32 v1, 15, v20
    v_lshlrev_b32 v1, 4, v1
    v_mfma_f32_16x16x32_bf16 v[176:179], a[48:51], a[16:19], v[176:179]
    ds_read_b64_tr_b16 a[116:117], v13 offset:57344
    v_bfe_u32 v21, v20, 4, 1
    v_mfma_f32_16x16x32_bf16 v[180:183], a[48:51], a[20:23], v[180:183]
    v_lshl_add_u32 v1, v21, 9, v1
    v_lshrrev_b32 v21, 5, v20
    v_mfma_f32_16x16x32_bf16 v[184:187], a[48:51], a[24:27], v[184:187]
    ds_read_b64_tr_b16 a[118:119], v13 offset:58368
    v_lshl_add_u32 v1, v21, 3, v1
    v_mfma_f32_16x16x32_bf16 v[188:191], a[48:51], a[28:31], v[188:191]
    buffer_store_dwordx2 v[22:23], v1, s[24:27], s82 offen offset:2048 sc1
    v_mfma_f32_16x16x32_bf16 v[192:195], a[52:55], a[0:3], v[192:195]
    ds_read_b64_tr_b16 a[120:121], v14 offset:57344
    v_bfe_u32 v24, v20, 3, 1
    v_mfma_f32_16x16x32_bf16 v[196:199], a[52:55], a[4:7], v[196:199]
    v_lshlrev_b32 v24, 10, v24
    v_bfe_u32 v21, v20, 2, 1
    v_mfma_f32_16x16x32_bf16 v[200:203], a[52:55], a[8:11], v[200:203]
    ds_read_b64_tr_b16 a[122:123], v14 offset:58368
    v_lshl_add_u32 v24, v21, 9, v24
    v_mfma_f32_16x16x32_bf16 v[204:207], a[52:55], a[12:15], v[204:207]
    v_lshrrev_b32 v21, 4, v20
    v_lshl_add_u32 v24, v21, 6, v24
    v_mfma_f32_16x16x32_bf16 v[208:211], a[52:55], a[16:19], v[208:211]
    ds_read_b64_tr_b16 a[124:125], v16 offset:8192
    v_and_b32 v21, 3, v20
    v_mfma_f32_16x16x32_bf16 v[212:215], a[52:55], a[20:23], v[212:215]
    v_lshl_add_u32 v24, v21, 1, v24
    v_mfma_f32_16x16x32_bf16 v[216:219], a[52:55], a[24:27], v[216:219]
    ds_read_b64_tr_b16 a[126:127], v16 offset:9216
    v_mfma_f32_16x16x32_bf16 v[220:223], a[52:55], a[28:31], v[220:223]
    buffer_store_short v22, v24, s[24:27], s83 offen sc1
    v_mfma_f32_16x16x32_bf16 v[224:227], a[56:59], a[0:3], v[224:227]
    buffer_store_short_d16_hi v22, v24, s[24:27], s83 offen offset:16 sc1
    v_mfma_f32_16x16x32_bf16 v[228:231], a[56:59], a[4:7], v[228:231]
    buffer_store_short v23, v24, s[24:27], s83 offen offset:32 sc1
    v_mfma_f32_16x16x32_bf16 v[232:235], a[56:59], a[8:11], v[232:235]
    buffer_store_short_d16_hi v23, v24, s[24:27], s83 offen offset:48 sc1
    v_mfma_f32_16x16x32_bf16 v[236:239], a[56:59], a[12:15], v[236:239]
    v_mfma_f32_16x16x32_bf16 v[240:243], a[56:59], a[16:19], v[240:243]
    v_mfma_f32_16x16x32_bf16 v[244:247], a[56:59], a[20:23], v[244:247]
    v_mfma_f32_16x16x32_bf16 v[248:251], a[56:59], a[24:27], v[248:251]
    v_mfma_f32_16x16x32_bf16 v[252:255], a[56:59], a[28:31], v[252:255]
    v_mfma_f32_16x16x32_bf16 a[128:131], a[60:63], a[0:3], a[128:131]
    v_mfma_f32_16x16x32_bf16 a[132:135], a[60:63], a[4:7], a[132:135]
    v_xor_b32 v15, s50, v15
    v_mfma_f32_16x16x32_bf16 a[136:139], a[60:63], a[8:11], a[136:139]
    v_mfma_f32_16x16x32_bf16 a[140:143], a[60:63], a[12:15], a[140:143]
    v_xor_b32 v16, s50, v16
    v_mfma_f32_16x16x32_bf16 a[144:147], a[60:63], a[16:19], a[144:147]
    v_mfma_f32_16x16x32_bf16 a[148:151], a[60:63], a[20:23], a[148:151]
    v_mfma_f32_16x16x32_bf16 a[152:155], a[60:63], a[24:27], a[152:155]
    v_mfma_f32_16x16x32_bf16 a[156:159], a[60:63], a[28:31], a[156:159]
    s_waitcnt vmcnt(10) lgkmcnt(0)
    s_barrier
    s_add_u32 m0, s45, 32768
    v_mfma_f32_16x16x32_bf16 v[32:35], a[96:99], a[64:67], v[32:35]
    buffer_load_dwordx4 v2, s[8:11], s40 offen offset:0 lds
    v_mfma_f32_16x16x32_bf16 v[36:39], a[96:99], a[68:71], v[36:39]
    ds_read_b64_tr_b16 a[32:33], v12 offset:0
    v_mfma_f32_16x16x32_bf16 v[40:43], a[96:99], a[72:75], v[40:43]
    v_mfma_f32_16x16x32_bf16 v[44:47], a[96:99], a[76:79], v[44:47]
    ds_read_b64_tr_b16 a[34:35], v12 offset:1024
    v_mfma_f32_16x16x32_bf16 v[48:51], a[96:99], a[80:83], v[48:51]
    buffer_load_dwordx4 v3, s[8:11], s40 offen offset:1024 lds
    v_mfma_f32_16x16x32_bf16 v[52:55], a[96:99], a[84:87], v[52:55]
    ds_read_b128 a[0:3], v10 offset:0
    v_mfma_f32_16x16x32_bf16 v[56:59], a[96:99], a[88:91], v[56:59]
    v_mfma_f32_16x16x32_bf16 v[60:63], a[96:99], a[92:95], v[60:63]
    ds_read_b128 a[4:7], v10 offset:2048
    v_mfma_f32_16x16x32_bf16 v[64:67], a[100:103], a[64:67], v[64:67]
    v_mfma_f32_16x16x32_bf16 v[68:71], a[100:103], a[68:71], v[68:71]
    ds_read_b128 a[8:11], v10 offset:4096
    v_mfma_f32_16x16x32_bf16 v[72:75], a[100:103], a[72:75], v[72:75]
    buffer_load_dwordx4 v4, s[8:11], s40 offen offset:2048 lds
    v_mfma_f32_16x16x32_bf16 v[76:79], a[100:103], a[76:79], v[76:79]
    ds_read_b128 a[12:15], v10 offset:6144
    v_mfma_f32_16x16x32_bf16 v[80:83], a[100:103], a[80:83], v[80:83]
    v_mfma_f32_16x16x32_bf16 v[84:87], a[100:103], a[84:87], v[84:87]
    ds_read_b128 a[16:19], v10 offset:8192
    v_mfma_f32_16x16x32_bf16 v[88:91], a[100:103], a[88:91], v[88:91]
    buffer_load_dwordx4 v5, s[8:11], s40 offen offset:3072 lds
    v_mfma_f32_16x16x32_bf16 v[92:95], a[100:103], a[92:95], v[92:95]
    ds_read_b128 a[20:23], v10 offset:10240
    v_mfma_f32_16x16x32_bf16 v[96:99], a[104:107], a[64:67], v[96:99]
    v_mfma_f32_16x16x32_bf16 v[100:103], a[104:107], a[68:71], v[100:103]
    ds_read_b128 a[24:27], v10 offset:12288
    v_mfma_f32_16x16x32_bf16 v[104:107], a[104:107], a[72:75], v[104:107]
    v_mfma_f32_16x16x32_bf16 v[108:111], a[104:107], a[76:79], v[108:111]
    s_add_u32 m0, s45, 36864
    ds_read_b128 a[28:31], v10 offset:14336
    v_mfma_f32_16x16x32_bf16 v[112:115], a[104:107], a[80:83], v[112:115]
    buffer_load_dwordx4 v2, s[8:11], s41 offen offset:0 lds
    v_mfma_f32_16x16x32_bf16 v[116:119], a[104:107], a[84:87], v[116:119]
    ds_read_b64_tr_b16 a[36:37], v13 offset:0
    v_mfma_f32_16x16x32_bf16 v[120:123], a[104:107], a[88:91], v[120:123]
    v_mfma_f32_16x16x32_bf16 v[124:127], a[104:107], a[92:95], v[124:127]
    ds_read_b64_tr_b16 a[38:39], v13 offset:1024
    v_mfma_f32_16x16x32_bf16 v[128:131], a[108:111], a[64:67], v[128:131]
    buffer_load_dwordx4 v3, s[8:11], s41 offen offset:1024 lds
    v_mfma_f32_16x16x32_bf16 v[132:135], a[108:111], a[68:71], v[132:135]
    ds_read_b64_tr_b16 a[40:41], v14 offset:0
    v_mfma_f32_16x16x32_bf16 v[136:139], a[108:111], a[72:75], v[136:139]
    v_mfma_f32_16x16x32_bf16 v[140:143], a[108:111], a[76:79], v[140:143]
    ds_read_b64_tr_b16 a[42:43], v14 offset:1024
    v_mfma_f32_16x16x32_bf16 v[144:147], a[108:111], a[80:83], v[144:147]
    buffer_load_dwordx4 v4, s[8:11], s41 offen offset:2048 lds
    v_mfma_f32_16x16x32_bf16 v[148:151], a[108:111], a[84:87], v[148:151]
    ds_read_b64_tr_b16 a[44:45], v15 offset:0
    v_mfma_f32_16x16x32_bf16 v[152:155], a[108:111], a[88:91], v[152:155]
    v_mfma_f32_16x16x32_bf16 v[156:159], a[108:111], a[92:95], v[156:159]
    ds_read_b64_tr_b16 a[46:47], v15 offset:1024
    v_mfma_f32_16x16x32_bf16 v[160:163], a[112:115], a[64:67], v[160:163]
    v_mfma_f32_16x16x32_bf16 v[164:167], a[112:115], a[68:71], v[164:167]
    ds_read_b64_tr_b16 a[48:49], v12 offset:16384
    v_mfma_f32_16x16x32_bf16 v[168:171], a[112:115], a[72:75], v[168:171]
    buffer_load_dwordx4 v5, s[8:11], s41 offen offset:3072 lds
    v_mfma_f32_16x16x32_bf16 v[172:175], a[112:115], a[76:79], v[172:175]
    ds_read_b64_tr_b16 a[50:51], v12 offset:17408
    v_mfma_f32_16x16x32_bf16 v[176:179], a[112:115], a[80:83], v[176:179]
    s_add_u32 s40, s40, 128
    s_add_u32 s41, s41, 128
    v_mfma_f32_16x16x32_bf16 v[180:183], a[112:115], a[84:87], v[180:183]
    s_add_u32 m0, s46, 32768
    ds_read_b64_tr_b16 a[52:53], v13 offset:16384
    v_mfma_f32_16x16x32_bf16 v[184:187], a[112:115], a[88:91], v[184:187]
    buffer_load_dwordx4 v6, s[12:15], s42 offen offset:0 lds
    v_mfma_f32_16x16x32_bf16 v[188:191], a[112:115], a[92:95], v[188:191]
    ds_read_b64_tr_b16 a[54:55], v13 offset:17408
    v_mfma_f32_16x16x32_bf16 v[192:195], a[116:119], a[64:67], v[192:195]
    v_mfma_f32_16x16x32_bf16 v[196:199], a[116:119], a[68:71], v[196:199]
    ds_read_b64_tr_b16 a[56:57], v14 offset:16384
    v_mfma_f32_16x16x32_bf16 v[200:203], a[116:119], a[72:75], v[200:203]
    buffer_load_dwordx4 v7, s[12:15], s42 offen offset:1024 lds
    v_mfma_f32_16x16x32_bf16 v[204:207], a[116:119], a[76:79], v[204:207]
    ds_read_b64_tr_b16 a[58:59], v14 offset:17408
    v_mfma_f32_16x16x32_bf16 v[208:211], a[116:119], a[80:83], v[208:211]
    v_mfma_f32_16x16x32_bf16 v[212:215], a[116:119], a[84:87], v[212:215]
    ds_read_b64_tr_b16 a[60:61], v16 offset:0
    v_mfma_f32_16x16x32_bf16 v[216:219], a[116:119], a[88:91], v[216:219]
    v_mfma_f32_16x16x32_bf16 v[220:223], a[116:119], a[92:95], v[220:223]
    ds_read_b64_tr_b16 a[62:63], v16 offset:1024
    v_mfma_f32_16x16x32_bf16 v[224:227], a[120:123], a[64:67], v[224:227]
    buffer_load_dwordx4 v8, s[12:15], s42 offen offset:2048 lds
    v_mfma_f32_16x16x32_bf16 v[228:231], a[120:123], a[68:71], v[228:231]
    ds_read_b64_tr_b16 a[204:205], v28 offset:8192
    v_mfma_f32_16x16x32_bf16 v[232:235], a[120:123], a[72:75], v[232:235]
    v_mfma_f32_16x16x32_bf16 v[236:239], a[120:123], a[76:79], v[236:239]
    ds_read_b64_tr_b16 a[206:207], v28 offset:10240
    v_mfma_f32_16x16x32_bf16 v[240:243], a[120:123], a[80:83], v[240:243]
    buffer_load_dwordx4 v9, s[12:15], s42 offen offset:3072 lds
    v_mfma_f32_16x16x32_bf16 v[244:247], a[120:123], a[84:87], v[244:247]
    v_mfma_f32_16x16x32_bf16 v[248:251], a[120:123], a[88:91], v[248:251]
    v_mfma_f32_16x16x32_bf16 v[252:255], a[120:123], a[92:95], v[252:255]
    v_mfma_f32_16x16x32_bf16 a[128:131], a[124:127], a[64:67], a[128:131]
    v_mfma_f32_16x16x32_bf16 a[132:135], a[124:127], a[68:71], a[132:135]
    s_add_u32 m0, s46, 49152
    v_mfma_f32_16x16x32_bf16 a[136:139], a[124:127], a[72:75], a[136:139]
    buffer_load_dwordx4 v6, s[16:19], s42 offen offset:0 lds
    v_mfma_f32_16x16x32_bf16 a[140:143], a[124:127], a[76:79], a[140:143]
    v_mfma_f32_16x16x32_bf16 a[144:147], a[124:127], a[80:83], a[144:147]
    v_mfma_f32_16x16x32_bf16 a[148:151], a[124:127], a[84:87], a[148:151]
    v_mfma_f32_16x16x32_bf16 a[152:155], a[124:127], a[88:91], a[152:155]
    v_mfma_f32_16x16x32_bf16 a[156:159], a[124:127], a[92:95], a[156:159]
    s_waitcnt lgkmcnt(0)
    v_mfma_f32_16x16x32_bf16 v[32:35], a[32:35], a[0:3], v[32:35]
    ds_read_b64_tr_b16 a[96:97], v12 offset:8192
    v_mfma_f32_16x16x32_bf16 v[36:39], a[32:35], a[4:7], v[36:39]
    buffer_load_dwordx4 v7, s[16:19], s42 offen offset:1024 lds
    v_mfma_f32_16x16x32_bf16 v[40:43], a[32:35], a[8:11], v[40:43]
    ds_read_b64_tr_b16 a[98:99], v12 offset:9216
    v_mfma_f32_16x16x32_bf16 v[44:47], a[32:35], a[12:15], v[44:47]
    v_mfma_f32_16x16x32_bf16 v[48:51], a[32:35], a[16:19], v[48:51]
    ds_read_b128 a[64:67], v11 offset:0
    v_mfma_f32_16x16x32_bf16 v[52:55], a[32:35], a[20:23], v[52:55]
    buffer_load_dwordx4 v8, s[16:19], s42 offen offset:2048 lds
    v_mfma_f32_16x16x32_bf16 v[56:59], a[32:35], a[24:27], v[56:59]
    ds_read_b128 a[68:71], v11 offset:2048
    v_mfma_f32_16x16x32_bf16 v[60:63], a[32:35], a[28:31], v[60:63]
    v_mfma_f32_16x16x32_bf16 v[64:67], a[36:39], a[0:3], v[64:67]
    ds_read_b128 a[72:75], v11 offset:4096
    v_mfma_f32_16x16x32_bf16 v[68:71], a[36:39], a[4:7], v[68:71]
    buffer_load_dwordx4 v9, s[16:19], s42 offen offset:3072 lds
    v_mfma_f32_16x16x32_bf16 v[72:75], a[36:39], a[8:11], v[72:75]
    ds_read_b128 a[76:79], v11 offset:6144
    s_add_u32 s42, s42, 458752
    v_mfma_f32_16x16x32_bf16 v[76:79], a[36:39], a[12:15], v[76:79]
    v_mfma_f32_16x16x32_bf16 v[80:83], a[36:39], a[16:19], v[80:83]
    ds_read_b128 a[80:83], v11 offset:8192
    s_add_u32 m0, s56, 2048
    v_mfma_f32_16x16x32_bf16 v[84:87], a[36:39], a[20:23], v[84:87]
    buffer_load_dwordx4 v0, s[4:7], s43 offen lds
    v_mfma_f32_16x16x32_bf16 v[88:91], a[36:39], a[24:27], v[88:91]
    ds_read_b128 a[84:87], v11 offset:10240
    s_add_u32 s43, s43, 0x20000
    s_bitcmp1_b32 s58, 12
    s_cselect_b32 s60, s48, 0x7f000000
    v_mfma_f32_16x16x32_bf16 v[92:95], a[36:39], a[28:31], v[92:95]
    buffer_load_dword a255, v18, s[32:35], s60 offen
    v_mfma_f32_16x16x32_bf16 v[96:99], a[40:43], a[0:3], v[96:99]
    ds_read_b128 a[88:91], v11 offset:12288
    s_add_u32 s60, s60, s59
    s_add_u32 s48, s48, s49
    v_mfma_f32_16x16x32_bf16 v[100:103], a[40:43], a[4:7], v[100:103]
    buffer_load_dword a255, v18, s[32:35], s60 offen
    v_mfma_f32_16x16x32_bf16 v[104:107], a[40:43], a[8:11], v[104:107]
    ds_read_b128 a[92:95], v11 offset:14336
    s_add_u32 m0, s51, 4096
    v_mfma_f32_16x16x32_bf16 v[108:111], a[40:43], a[12:15], v[108:111]
    buffer_load_dwordx4 v29, s[76:79], s95 offen nt lds
    v_mfma_f32_16x16x32_bf16 v[112:115], a[40:43], a[16:19], v[112:115]
    ds_read_b64_tr_b16 a[100:101], v13 offset:8192
    s_add_u32 s95, s95, 65536
    v_mfma_f32_16x16x32_bf16 v[116:119], a[40:43], a[20:23], v[116:119]
    buffer_store_dwordx4 a[204:207], v27, s[24:27], s94 offen sc1
    v_mfma_f32_16x16x32_bf16 v[120:123], a[40:43], a[24:27], v[120:123]
    ds_read_b64_tr_b16 a[102:103], v13 offset:9216
    s_add_u32 s94, s94, 8192
    v_mfma_f32_16x16x32_bf16 v[124:127], a[40:43], a[28:31], v[124:127]
    v_mfma_f32_16x16x32_bf16 v[128:131], a[44:47], a[0:3], v[128:131]
    ds_read_b64_tr_b16 a[104:105], v14 offset:8192
    v_mfma_f32_16x16x32_bf16 v[132:135], a[44:47], a[4:7], v[132:135]
    v_mfma_f32_16x16x32_bf16 v[136:139], a[44:47], a[8:11], v[136:139]
    ds_read_b64_tr_b16 a[106:107], v14 offset:9216
    v_mfma_f32_16x16x32_bf16 v[140:143], a[44:47], a[12:15], v[140:143]
    v_mfma_f32_16x16x32_bf16 v[144:147], a[44:47], a[16:19], v[144:147]
    ds_read_b64_tr_b16 a[108:109], v15 offset:8192
    v_mfma_f32_16x16x32_bf16 v[148:151], a[44:47], a[20:23], v[148:151]
    v_mfma_f32_16x16x32_bf16 v[152:155], a[44:47], a[24:27], v[152:155]
    ds_read_b64_tr_b16 a[110:111], v15 offset:9216
    v_mfma_f32_16x16x32_bf16 v[156:159], a[44:47], a[28:31], v[156:159]
    v_mfma_f32_16x16x32_bf16 v[160:163], a[48:51], a[0:3], v[160:163]
    ds_read_b64_tr_b16 a[112:113], v12 offset:24576
    v_mfma_f32_16x16x32_bf16 v[164:167], a[48:51], a[4:7], v[164:167]
    v_mfma_f32_16x16x32_bf16 v[168:171], a[48:51], a[8:11], v[168:171]
    ds_read_b64_tr_b16 a[114:115], v12 offset:25600
    v_mfma_f32_16x16x32_bf16 v[172:175], a[48:51], a[12:15], v[172:175]
    v_mfma_f32_16x16x32_bf16 v[176:179], a[48:51], a[16:19], v[176:179]
    ds_read_b64_tr_b16 a[116:117], v13 offset:24576
    v_mfma_f32_16x16x32_bf16 v[180:183], a[48:51], a[20:23], v[180:183]
    v_mfma_f32_16x16x32_bf16 v[184:187], a[48:51], a[24:27], v[184:187]
    ds_read_b64_tr_b16 a[118:119], v13 offset:25600
    v_mfma_f32_16x16x32_bf16 v[188:191], a[48:51], a[28:31], v[188:191]
    v_mfma_f32_16x16x32_bf16 v[192:195], a[52:55], a[0:3], v[192:195]
    ds_read_b64_tr_b16 a[120:121], v14 offset:24576
    v_mfma_f32_16x16x32_bf16 v[196:199], a[52:55], a[4:7], v[196:199]
    v_mfma_f32_16x16x32_bf16 v[200:203], a[52:55], a[8:11], v[200:203]
    ds_read_b64_tr_b16 a[122:123], v14 offset:25600
    v_mfma_f32_16x16x32_bf16 v[204:207], a[52:55], a[12:15], v[204:207]
    v_mfma_f32_16x16x32_bf16 v[208:211], a[52:55], a[16:19], v[208:211]
    ds_read_b64_tr_b16 a[124:125], v16 offset:8192
    v_mfma_f32_16x16x32_bf16 v[212:215], a[52:55], a[20:23], v[212:215]
    v_mfma_f32_16x16x32_bf16 v[216:219], a[52:55], a[24:27], v[216:219]
    ds_read_b64_tr_b16 a[126:127], v16 offset:9216
    v_mfma_f32_16x16x32_bf16 v[220:223], a[52:55], a[28:31], v[220:223]
    v_mfma_f32_16x16x32_bf16 v[224:227], a[56:59], a[0:3], v[224:227]
    v_mfma_f32_16x16x32_bf16 v[228:231], a[56:59], a[4:7], v[228:231]
    v_mfma_f32_16x16x32_bf16 v[232:235], a[56:59], a[8:11], v[232:235]
    v_mfma_f32_16x16x32_bf16 v[236:239], a[56:59], a[12:15], v[236:239]
    v_mfma_f32_16x16x32_bf16 v[240:243], a[56:59], a[16:19], v[240:243]
    v_mfma_f32_16x16x32_bf16 v[244:247], a[56:59], a[20:23], v[244:247]
    v_mfma_f32_16x16x32_bf16 v[248:251], a[56:59], a[24:27], v[248:251]
    v_mfma_f32_16x16x32_bf16 v[252:255], a[56:59], a[28:31], v[252:255]
KM_PAD6:
    s_cbranch_execz KM_RET1
    s_nop 0
    v_mfma_f32_16x16x32_bf16 a[128:131], a[60:63], a[0:3], a[128:131]
    v_mfma_f32_16x16x32_bf16 a[132:135], a[60:63], a[4:7], a[132:135]
    v_xor_b32 v15, s50, v15
    v_mfma_f32_16x16x32_bf16 a[136:139], a[60:63], a[8:11], a[136:139]
    v_mfma_f32_16x16x32_bf16 a[140:143], a[60:63], a[12:15], a[140:143]
    v_xor_b32 v16, s50, v16
    v_mfma_f32_16x16x32_bf16 a[144:147], a[60:63], a[16:19], a[144:147]
    v_mfma_f32_16x16x32_bf16 a[148:151], a[60:63], a[20:23], a[148:151]
    v_mfma_f32_16x16x32_bf16 a[152:155], a[60:63], a[24:27], a[152:155]
    v_mfma_f32_16x16x32_bf16 a[156:159], a[60:63], a[28:31], a[156:159]
    s_waitcnt vmcnt(4) lgkmcnt(0)
    s_barrier
    s_add_u32 m0, s45, 0
    v_mfma_f32_16x16x32_bf16 v[32:35], a[96:99], a[64:67], v[32:35]
    buffer_load_dwordx4 v2, s[8:11], s40 offen offset:0 lds
    v_mfma_f32_16x16x32_bf16 v[36:39], a[96:99], a[68:71], v[36:39]
    ds_read_b64_tr_b16 a[32:33], v12 offset:32768
    v_mfma_f32_16x16x32_bf16 v[40:43], a[96:99], a[72:75], v[40:43]
    v_mfma_f32_16x16x32_bf16 v[44:47], a[96:99], a[76:79], v[44:47]
    ds_read_b64_tr_b16 a[34:35], v12 offset:33792
    v_mfma_f32_16x16x32_bf16 v[48:51], a[96:99], a[80:83], v[48:51]
    buffer_load_dwordx4 v3, s[8:11], s40 offen offset:1024 lds
    v_mfma_f32_16x16x32_bf16 v[52:55], a[96:99], a[84:87], v[52:55]
    ds_read_b128 a[0:3], v10 offset:32768
    v_mfma_f32_16x16x32_bf16 v[56:59], a[96:99], a[88:91], v[56:59]
    v_mfma_f32_16x16x32_bf16 v[60:63], a[96:99], a[92:95], v[60:63]
    ds_read_b128 a[4:7], v10 offset:34816
    v_mfma_f32_16x16x32_bf16 v[64:67], a[100:103], a[64:67], v[64:67]
    v_mfma_f32_16x16x32_bf16 v[68:71], a[100:103], a[68:71], v[68:71]
    ds_read_b128 a[8:11], v10 offset:36864
    v_mfma_f32_16x16x32_bf16 v[72:75], a[100:103], a[72:75], v[72:75]
    buffer_load_dwordx4 v4, s[8:11], s40 offen offset:2048 lds
    v_mfma_f32_16x16x32_bf16 v[76:79], a[100:103], a[76:79], v[76:79]
    ds_read_b128 a[12:15], v10 offset:38912
    v_mfma_f32_16x16x32_bf16 v[80:83], a[100:103], a[80:83], v[80:83]
    v_mfma_f32_16x16x32_bf16 v[84:87], a[100:103], a[84:87], v[84:87]
    ds_read_b128 a[16:19], v10 offset:40960
    v_mfma_f32_16x16x32_bf16 v[88:91], a[100:103], a[88:91], v[88:91]
    buffer_load_dwordx4 v5, s[8:11], s40 offen offset:3072 lds
    v_mfma_f32_16x16x32_bf16 v[92:95], a[100:103], a[92:95], v[92:95]
    ds_read_b128 a[20:23], v10 offset:43008
    v_mfma_f32_16x16x32_bf16 v[96:99], a[104:107], a[64:67], v[96:99]
    v_mfma_f32_16x16x32_bf16 v[100:103], a[104:107], a[68:71], v[100:103]
    ds_read_b128 a[24:27], v10 offset:45056
    v_mfma_f32_16x16x32_bf16 v[104:107], a[104:107], a[72:75], v[104:107]
    v_mfma_f32_16x16x32_bf16 v[108:111], a[104:107], a[76:79], v[108:111]
    s_add_u32 m0, s45, 4096
    ds_read_b128 a[28:31], v10 offset:47104
    v_mfma_f32_16x16x32_bf16 v[112:115], a[104:107], a[80:83], v[112:115]
    buffer_load_dwordx4 v2, s[8:11], s41 offen offset:0 lds
    v_mfma_f32_16x16x32_bf16 v[116:119], a[104:107], a[84:87], v[116:119]
    ds_read_b64_tr_b16 a[36:37], v13 offset:32768
    v_mfma_f32_16x16x32_bf16 v[120:123], a[104:107], a[88:91], v[120:123]
    v_mfma_f32_16x16x32_bf16 v[124:127], a[104:107], a[92:95], v[124:127]
    ds_read_b64_tr_b16 a[38:39], v13 offset:33792
    v_mfma_f32_16x16x32_bf16 v[128:131], a[108:111], a[64:67], v[128:131]
    buffer_load_dwordx4 v3, s[8:11], s41 offen offset:1024 lds
    v_mfma_f32_16x16x32_bf16 v[132:135], a[108:111], a[68:71], v[132:135]
    ds_read_b64_tr_b16 a[40:41], v14 offset:32768
    v_mfma_f32_16x16x32_bf16 v[136:139], a[108:111], a[72:75], v[136:139]
    v_mfma_f32_16x16x32_bf16 v[140:143], a[108:111], a[76:79], v[140:143]
    ds_read_b64_tr_b16 a[42:43], v14 offset:33792
    v_mfma_f32_16x16x32_bf16 v[144:147], a[108:111], a[80:83], v[144:147]
    buffer_load_dwordx4 v4, s[8:11], s41 offen offset:2048 lds
    v_mfma_f32_16x16x32_bf16 v[148:151], a[108:111], a[84:87], v[148:151]
    ds_read_b64_tr_b16 a[44:45], v15 offset:0
    v_mfma_f32_16x16x32_bf16 v[152:155], a[108:111], a[88:91], v[152:155]
    v_mfma_f32_16x16x32_bf16 v[156:159], a[108:111], a[92:95], v[156:159]
    ds_read_b64_tr_b16 a[46:47], v15 offset:1024
    v_mfma_f32_16x16x32_bf16 v[160:163], a[112:115], a[64:67], v[160:163]
    v_mfma_f32_16x16x32_bf16 v[164:167], a[112:115], a[68:71], v[164:167]
    ds_read_b64_tr_b16 a[48:49], v12 offset:49152
    v_mfma_f32_16x16x32_bf16 v[168:171], a[112:115], a[72:75], v[168:171]
    buffer_load_dwordx4 v5, s[8:11], s41 offen offset:3072 lds
    v_mfma_f32_16x16x32_bf16 v[172:175], a[112:115], a[76:79], v[172:175]
    ds_read_b64_tr_b16 a[50:51], v12 offset:50176
    v_mfma_f32_16x16x32_bf16 v[176:179], a[112:115], a[80:83], v[176:179]
    s_add_u32 s40, s40, 128
    s_add_u32 s41, s41, 128
    v_mfma_f32_16x16x32_bf16 v[180:183], a[112:115], a[84:87], v[180:183]
    s_add_u32 m0, s46, 0
    ds_read_b64_tr_b16 a[52:53], v13 offset:49152
    v_mfma_f32_16x16x32_bf16 v[184:187], a[112:115], a[88:91], v[184:187]
    buffer_load_dwordx4 v6, s[12:15], s42 offen offset:0 lds
    v_mfma_f32_16x16x32_bf16 v[188:191], a[112:115], a[92:95], v[188:191]
    ds_read_b64_tr_b16 a[54:55], v13 offset:50176
    v_mfma_f32_16x16x32_bf16 v[192:195], a[116:119], a[64:67], v[192:195]
    v_mfma_f32_16x16x32_bf16 v[196:199], a[116:119], a[68:71], v[196:199]
    ds_read_b64_tr_b16 a[56:57], v14 offset:49152
    v_mfma_f32_16x16x32_bf16 v[200:203], a[116:119], a[72:75], v[200:203]
    buffer_load_dwordx4 v7, s[12:15], s42 offen offset:1024 lds
    v_mfma_f32_16x16x32_bf16 v[204:207], a[116:119], a[76:79], v[204:207]
    ds_read_b64_tr_b16 a[58:59], v14 offset:50176
    v_mfma_f32_16x16x32_bf16 v[208:211], a[116:119], a[80:83], v[208:211]
    v_mfma_f32_16x16x32_bf16 v[212:215], a[116:119], a[84:87], v[212:215]
    ds_read_b64_tr_b16 a[60:61], v16 offset:0
    v_mfma_f32_16x16x32_bf16 v[216:219], a[116:119], a[88:91], v[216:219]
    v_mfma_f32_16x16x32_bf16 v[220:223], a[116:119], a[92:95], v[220:223]
    ds_read_b64_tr_b16 a[62:63], v16 offset:1024
    v_mfma_f32_16x16x32_bf16 v[224:227], a[120:123], a[64:67], v[224:227]
    buffer_load_dwordx4 v8, s[12:15], s42 offen offset:2048 lds
    v_mfma_f32_16x16x32_bf16 v[228:231], a[120:123], a[68:71], v[228:231]
    ds_read_b64_tr_b16 a[204:205], v28 offset:0
    v_mfma_f32_16x16x32_bf16 v[232:235], a[120:123], a[72:75], v[232:235]
    v_mfma_f32_16x16x32_bf16 v[236:239], a[120:123], a[76:79], v[236:239]
    ds_read_b64_tr_b16 a[206:207], v28 offset:2048
    v_mfma_f32_16x16x32_bf16 v[240:243], a[120:123], a[80:83], v[240:243]
    buffer_load_dwordx4 v9, s[12:15], s42 offen offset:3072 lds
    v_mfma_f32_16x16x32_bf16 v[244:247], a[120:123], a[84:87], v[244:247]
    v_mfma_f32_16x16x32_bf16 v[248:251], a[120:123], a[88:91], v[248:251]
    v_accvgpr_read_b32 v1, a254
    v_mfma_f32_16x16x32_bf16 v[252:255], a[120:123], a[92:95], v[252:255]
    v_mfma_f32_16x16x32_bf16 a[128:131], a[124:127], a[64:67], a[128:131]
    v_cmp_eq_u32 vcc, 0, v1
    v_mfma_f32_16x16x32_bf16 a[132:135], a[124:127], a[68:71], a[132:135]
    s_add_u32 m0, s46, 16384
    v_mfma_f32_16x16x32_bf16 a[136:139], a[124:127], a[72:75], a[136:139]
    buffer_load_dwordx4 v6, s[16:19], s42 offen offset:0 lds
    s_cbranch_vccnz KM_ZSPIN
KM_ZBACK:
    v_mfma_f32_16x16x32_bf16 a[140:143], a[124:127], a[76:79], a[140:143]
    v_mfma_f32_16x16x32_bf16 a[144:147], a[124:127], a[80:83], a[144:147]
    v_accvgpr_write_b32 a254, v1
    v_mfma_f32_16x16x32_bf16 a[148:151], a[124:127], a[84:87], a[148:151]
    v_mfma_f32_16x16x32_bf16 a[152:155], a[124:127], a[88:91], a[152:155]
    v_readfirstlane_b32 s89, v1
    v_mfma_f32_16x16x32_bf16 a[156:159], a[124:127], a[92:95], a[156:159]
    s_waitcnt lgkmcnt(0)
    v_mfma_f32_16x16x32_bf16 v[32:35], a[32:35], a[0:3], v[32:35]
    ds_read_b64_tr_b16 a[96:97], v12 offset:40960
    v_mfma_f32_16x16x32_bf16 v[36:39], a[32:35], a[4:7], v[36:39]
    buffer_load_dwordx4 v7, s[16:19], s42 offen offset:1024 lds
    v_mfma_f32_16x16x32_bf16 v[40:43], a[32:35], a[8:11], v[40:43]
    ds_read_b64_tr_b16 a[98:99], v12 offset:41984
    v_mfma_f32_16x16x32_bf16 v[44:47], a[32:35], a[12:15], v[44:47]
    v_mfma_f32_16x16x32_bf16 v[48:51], a[32:35], a[16:19], v[48:51]
    ds_read_b128 a[64:67], v11 offset:32768
    v_mfma_f32_16x16x32_bf16 v[52:55], a[32:35], a[20:23], v[52:55]
    buffer_load_dwordx4 v8, s[16:19], s42 offen offset:2048 lds
    v_mfma_f32_16x16x32_bf16 v[56:59], a[32:35], a[24:27], v[56:59]
    ds_read_b128 a[68:71], v11 offset:34816
    v_mfma_f32_16x16x32_bf16 v[60:63], a[32:35], a[28:31], v[60:63]
    v_mfma_f32_16x16x32_bf16 v[64:67], a[36:39], a[0:3], v[64:67]
    ds_read_b128 a[72:75], v11 offset:36864
    v_mfma_f32_16x16x32_bf16 v[68:71], a[36:39], a[4:7], v[68:71]
    buffer_load_dwordx4 v9, s[16:19], s42 offen offset:3072 lds
    v_mfma_f32_16x16x32_bf16 v[72:75], a[36:39], a[8:11], v[72:75]
    ds_read_b128 a[76:79], v11 offset:38912
    s_add_u32 s42, s42, 458752
    v_mfma_f32_16x16x32_bf16 v[76:79], a[36:39], a[12:15], v[76:79]
    v_mfma_f32_16x16x32_bf16 v[80:83], a[36:39], a[16:19], v[80:83]
    ds_read_b128 a[80:83], v11 offset:40960
    s_add_u32 m0, s56, 0
    v_mfma_f32_16x16x32_bf16 v[84:87], a[36:39], a[20:23], v[84:87]
    buffer_load_dwordx4 v0, s[4:7], s43 offen lds
    v_mfma_f32_16x16x32_bf16 v[88:91], a[36:39], a[24:27], v[88:91]
    ds_read_b128 a[84:87], v11 offset:43008
    s_add_u32 s43, s43, 0x20000
    s_bitcmp1_b32 s58, 13
    s_cselect_b32 s60, s48, 0x7f000000
    v_mfma_f32_16x16x32_bf16 v[92:95], a[36:39], a[28:31], v[92:95]
    buffer_load_dword a255, v18, s[32:35], s60 offen
    v_mfma_f32_16x16x32_bf16 v[96:99], a[40:43], a[0:3], v[96:99]
    ds_read_b128 a[88:91], v11 offset:45056
    s_add_u32 s60, s60, s59
    s_add_u32 s48, s48, s49
    v_mfma_f32_16x16x32_bf16 v[100:103], a[40:43], a[4:7], v[100:103]
    buffer_load_dword a255, v18, s[32:35], s60 offen
    v_mfma_f32_16x16x32_bf16 v[104:107], a[40:43], a[8:11], v[104:107]
    ds_read_b128 a[92:95], v11 offset:47104
    s_add_u32 m0, s51, 8192
    v_mfma_f32_16x16x32_bf16 v[108:111], a[40:43], a[12:15], v[108:111]
    buffer_load_dwordx4 v29, s[76:79], s95 offen nt lds
    v_mfma_f32_16x16x32_bf16 v[112:115], a[40:43], a[16:19], v[112:115]
    ds_read_b64_tr_b16 a[100:101], v13 offset:40960
    s_add_u32 s95, s95, 65536
    v_mfma_f32_16x16x32_bf16 v[116:119], a[40:43], a[20:23], v[116:119]
    buffer_store_dwordx4 a[204:207], v27, s[24:27], s94 offen sc1
    s_lshl_b32 s82, s37, 5
    v_mfma_f32_16x16x32_bf16 v[120:123], a[40:43], a[24:27], v[120:123]
    ds_read_b64_tr_b16 a[102:103], v13 offset:41984
    s_add_u32 s94, s94, 8192
    s_add_u32 s82, s82, s38
    s_lshl_b32 s82, s82, 7
    v_mfma_f32_16x16x32_bf16 v[124:127], a[40:43], a[28:31], v[124:127]
    s_add_u32 s82, s82, 0x1278000
    v_mfma_f32_16x16x32_bf16 v[128:131], a[44:47], a[0:3], v[128:131]
    ds_read_b64_tr_b16 a[104:105], v14 offset:40960
    s_cmp_eq_u32 s36, 0
    s_cselect_b32 s82, s82, 0x7f000000
    v_mfma_f32_16x16x32_bf16 v[132:135], a[44:47], a[4:7], v[132:135]
    s_mov_b64 exec, 1
    buffer_store_dword a254, off, s[24:27], s82 sc1
    s_mov_b64 exec, -1
    v_mfma_f32_16x16x32_bf16 v[136:139], a[44:47], a[8:11], v[136:139]
    ds_read_b64_tr_b16 a[106:107], v14 offset:41984
    v_mfma_f32_16x16x32_bf16 v[140:143], a[44:47], a[12:15], v[140:143]
    v_mfma_f32_16x16x32_bf16 v[144:147], a[44:47], a[16:19], v[144:147]
    ds_read_b64_tr_b16 a[108:109], v15 offset:8192
    v_mfma_f32_16x16x32_bf16 v[148:151], a[44:47], a[20:23], v[148:151]
    v_mfma_f32_16x16x32_bf16 v[152:155], a[44:47], a[24:27], v[152:155]
    ds_read_b64_tr_b16 a[110:111], v15 offset:9216
    v_mfma_f32_16x16x32_bf16 v[156:159], a[44:47], a[28:31], v[156:159]
    v_mfma_f32_16x16x32_bf16 v[160:163], a[48:51], a[0:3], v[160:163]
    ds_read_b64_tr_b16 a[112:113], v12 offset:57344
    v_mfma_f32_16x16x32_bf16 v[164:167], a[48:51], a[4:7], v[164:167]
    v_mfma_f32_16x16x32_bf16 v[168:171], a[48:51], a[8:11], v[168:171]
    ds_read_b64_tr_b16 a[114:115], v12 offset:58368
    v_mfma_f32_16x16x32_bf16 v[172:175], a[48:51], a[12:15], v[172:175]
    v_mfma_f32_16x16x32_bf16 v[176:179], a[48:51], a[16:19], v[176:179]
    ds_read_b64_tr_b16 a[116:117], v13 offset:57344
    v_mfma_f32_16x16x32_bf16 v[180:183], a[48:51], a[20:23], v[180:183]
    v_mfma_f32_16x16x32_bf16 v[184:187], a[48:51], a[24:27], v[184:187]
    ds_read_b64_tr_b16 a[118:119], v13 offset:58368
    v_mfma_f32_16x16x32_bf16 v[188:191], a[48:51], a[28:31], v[188:191]
    v_mfma_f32_16x16x32_bf16 v[192:195], a[52:55], a[0:3], v[192:195]
    ds_read_b64_tr_b16 a[120:121], v14 offset:57344
    v_mfma_f32_16x16x32_bf16 v[196:199], a[52:55], a[4:7], v[196:199]
    v_mfma_f32_16x16x32_bf16 v[200:203], a[52:55], a[8:11], v[200:203]
    ds_read_b64_tr_b16 a[122:123], v14 offset:58368
    v_mfma_f32_16x16x32_bf16 v[204:207], a[52:55], a[12:15], v[204:207]
    v_mfma_f32_16x16x32_bf16 v[208:211], a[52:55], a[16:19], v[208:211]
    ds_read_b64_tr_b16 a[124:125], v16 offset:8192
    v_mfma_f32_16x16x32_bf16 v[212:215], a[52:55], a[20:23], v[212:215]
    v_mfma_f32_16x16x32_bf16 v[216:219], a[52:55], a[24:27], v[216:219]
    ds_read_b64_tr_b16 a[126:127], v16 offset:9216
    v_mfma_f32_16x16x32_bf16 v[220:223], a[52:55], a[28:31], v[220:223]
    v_mfma_f32_16x16x32_bf16 v[224:227], a[56:59], a[0:3], v[224:227]
    v_mfma_f32_16x16x32_bf16 v[228:231], a[56:59], a[4:7], v[228:231]
    v_mfma_f32_16x16x32_bf16 v[232:235], a[56:59], a[8:11], v[232:235]
    v_mfma_f32_16x16x32_bf16 v[236:239], a[56:59], a[12:15], v[236:239]
    v_mfma_f32_16x16x32_bf16 v[240:243], a[56:59], a[16:19], v[240:243]
    v_mfma_f32_16x16x32_bf16 v[244:247], a[56:59], a[20:23], v[244:247]
    v_mfma_f32_16x16x32_bf16 v[248:251], a[56:59], a[24:27], v[248:251]
    v_mfma_f32_16x16x32_bf16 v[252:255], a[56:59], a[28:31], v[252:255]
    v_mfma_f32_16x16x32_bf16 a[128:131], a[60:63], a[0:3], a[128:131]
    v_mfma_f32_16x16x32_bf16 a[132:135], a[60:63], a[4:7], a[132:135]
    v_xor_b32 v15, s50, v15
    v_mfma_f32_16x16x32_bf16 a[136:139], a[60:63], a[8:11], a[136:139]
    v_mfma_f32_16x16x32_bf16 a[140:143], a[60:63], a[12:15], a[140:143]
    v_xor_b32 v16, s50, v16
    v_mfma_f32_16x16x32_bf16 a[144:147], a[60:63], a[16:19], a[144:147]
    v_mfma_f32_16x16x32_bf16 a[148:151], a[60:63], a[20:23], a[148:151]
    v_mfma_f32_16x16x32_bf16 a[152:155], a[60:63], a[24:27], a[152:155]
    v_mfma_f32_16x16x32_bf16 a[156:159], a[60:63], a[28:31], a[156:159]
    s_waitcnt vmcnt(5) lgkmcnt(0)
    s_barrier
    s_add_u32 m0, s45, 32768
    v_mfma_f32_16x16x32_bf16 v[32:35], a[96:99], a[64:67], v[32:35]
    buffer_load_dwordx4 v2, s[8:11], s40 offen offset:0 lds
    v_mfma_f32_16x16x32_bf16 v[36:39], a[96:99], a[68:71], v[36:39]
    ds_read_b64_tr_b16 a[32:33], v12 offset:0
    v_mfma_f32_16x16x32_bf16 v[40:43], a[96:99], a[72:75], v[40:43]
    v_mfma_f32_16x16x32_bf16 v[44:47], a[96:99], a[76:79], v[44:47]
    ds_read_b64_tr_b16 a[34:35], v12 offset:1024
    v_mfma_f32_16x16x32_bf16 v[48:51], a[96:99], a[80:83], v[48:51]
    buffer_load_dwordx4 v3, s[8:11], s40 offen offset:1024 lds
    v_mfma_f32_16x16x32_bf16 v[52:55], a[96:99], a[84:87], v[52:55]
    ds_read_b128 a[0:3], v10 offset:0
    v_mfma_f32_16x16x32_bf16 v[56:59], a[96:99], a[88:91], v[56:59]
    v_mfma_f32_16x16x32_bf16 v[60:63], a[96:99], a[92:95], v[60:63]
    ds_read_b128 a[4:7], v10 offset:2048
    v_mfma_f32_16x16x32_bf16 v[64:67], a[100:103], a[64:67], v[64:67]
    v_mfma_f32_16x16x32_bf16 v[68:71], a[100:103], a[68:71], v[68:71]
    ds_read_b128 a[8:11], v10 offset:4096
    v_mfma_f32_16x16x32_bf16 v[72:75], a[100:103], a[72:75], v[72:75]
    buffer_load_dwordx4 v4, s[8:11], s40 offen offset:2048 lds
    v_mfma_f32_16x16x32_bf16 v[76:79], a[100:103], a[76:79], v[76:79]
    ds_read_b128 a[12:15], v10 offset:6144
    v_mfma_f32_16x16x32_bf16 v[80:83], a[100:103], a[80:83], v[80:83]
    v_mfma_f32_16x16x32_bf16 v[84:87], a[100:103], a[84:87], v[84:87]
    ds_read_b128 a[16:19], v10 offset:8192
    v_mfma_f32_16x16x32_bf16 v[88:91], a[100:103], a[88:91], v[88:91]
    buffer_load_dwordx4 v5, s[8:11], s40 offen offset:3072 lds
    v_mfma_f32_16x16x32_bf16 v[92:95], a[100:103], a[92:95], v[92:95]
    ds_read_b128 a[20:23], v10 offset:10240
    v_mfma_f32_16x16x32_bf16 v[96:99], a[104:107], a[64:67], v[96:99]
    v_mfma_f32_16x16x32_bf16 v[100:103], a[104:107], a[68:71], v[100:103]
    ds_read_b128 a[24:27], v10 offset:12288
    v_mfma_f32_16x16x32_bf16 v[104:107], a[104:107], a[72:75], v[104:107]
    v_mfma_f32_16x16x32_bf16 v[108:111], a[104:107], a[76:79], v[108:111]
    s_add_u32 m0, s45, 36864
    ds_read_b128 a[28:31], v10 offset:14336
    v_mfma_f32_16x16x32_bf16 v[112:115], a[104:107], a[80:83], v[112:115]
    buffer_load_dwordx4 v2, s[8:11], s41 offen offset:0 lds
    v_mfma_f32_16x16x32_bf16 v[116:119], a[104:107], a[84:87], v[116:119]
    ds_read_b64_tr_b16 a[36:37], v13 offset:0
    v_mfma_f32_16x16x32_bf16 v[120:123], a[104:107], a[88:91], v[120:123]
    v_mfma_f32_16x16x32_bf16 v[124:127], a[104:107], a[92:95], v[124:127]
    ds_read_b64_tr_b16 a[38:39], v13 offset:1024
    v_mfma_f32_16x16x32_bf16 v[128:131], a[108:111], a[64:67], v[128:131]
    buffer_load_dwordx4 v3, s[8:11], s41 offen offset:1024 lds
    v_mfma_f32_16x16x32_bf16 v[132:135], a[108:111], a[68:71], v[132:135]
    ds_read_b64_tr_b16 a[40:41], v14 offset:0
    v_mfma_f32_16x16x32_bf16 v[136:139], a[108:111], a[72:75], v[136:139]
    v_mfma_f32_16x16x32_bf16 v[140:143], a[108:111], a[76:79], v[140:143]
    ds_read_b64_tr_b16 a[42:43], v14 offset:1024
    v_mfma_f32_16x16x32_bf16 v[144:147], a[108:111], a[80:83], v[144:147]
    buffer_load_dwordx4 v4, s[8:11], s41 offen offset:2048 lds
    v_mfma_f32_16x16x32_bf16 v[148:151], a[108:111], a[84:87], v[148:151]
    ds_read_b64_tr_b16 a[44:45], v15 offset:0
    v_mfma_f32_16x16x32_bf16 v[152:155], a[108:111], a[88:91], v[152:155]
    s_getpc_b64 s[76:77]
KM_PC2:
    s_add_u32 s76, s76, KM_EBACK-KM_PC2
    s_addc_u32 s77, s77, 0
    v_mfma_f32_16x16x32_bf16 v[156:159], a[108:111], a[92:95], v[156:159]
    ds_read_b64_tr_b16 a[46:47], v15 offset:1024
    v_mfma_f32_16x16x32_bf16 v[160:163], a[112:115], a[64:67], v[160:163]
    s_and_b32 s77, s77, 0xffff
    v_mfma_f32_16x16x32_bf16 v[164:167], a[112:115], a[68:71], v[164:167]
    ds_read_b64_tr_b16 a[48:49], v12 offset:16384
    v_mfma_f32_16x16x32_bf16 v[168:171], a[112:115], a[72:75], v[168:171]
    buffer_load_dwordx4 v5, s[8:11], s41 offen offset:3072 lds
    s_mov_b32 s78, KM_FALLBACK2-KM_EBACK
    v_mfma_f32_16x16x32_bf16 v[172:175], a[112:115], a[76:79], v[172:175]
    ds_read_b64_tr_b16 a[50:51], v12 offset:17408
    v_mfma_f32_16x16x32_bf16 v[176:179], a[112:115], a[80:83], v[176:179]
    s_add_u32 s40, s40, 128
    s_add_u32 s41, s41, 128
    s_mov_b32 s79, 0x00020000
    v_mfma_f32_16x16x32_bf16 v[180:183], a[112:115], a[84:87], v[180:183]
    s_add_u32 m0, s46, 32768
    ds_read_b64_tr_b16 a[52:53], v13 offset:16384
    v_mfma_f32_16x16x32_bf16 v[184:187], a[112:115], a[88:91], v[184:187]
    buffer_load_dwordx4 v6, s[12:15], s42 offen offset:0 lds
    s_lshr_b32 s51, s2, 3
    v_mfma_f32_16x16x32_bf16 v[188:191], a[112:115], a[92:95], v[188:191]
    ds_read_b64_tr_b16 a[54:55], v13 offset:17408
    v_mfma_f32_16x16x32_bf16 v[192:195], a[116:119], a[64:67], v[192:195]
    s_lshl_b32 s51, s51, 2
    s_add_u32 s51, s51, s36
    v_mfma_f32_16x16x32_bf16 v[196:199], a[116:119], a[68:71], v[196:199]
    ds_read_b64_tr_b16 a[56:57], v14 offset:16384
    v_mfma_f32_16x16x32_bf16 v[200:203], a[116:119], a[72:75], v[200:203]
    buffer_load_dwordx4 v7, s[12:15], s42 offen offset:1024 lds
    s_lshl_b32 s51, s51, 8
    v_mfma_f32_16x16x32_bf16 v[204:207], a[116:119], a[76:79], v[204:207]
    ds_read_b64_tr_b16 a[58:59], v14 offset:17408
    v_mfma_f32_16x16x32_bf16 v[208:211], a[116:119], a[80:83], v[208:211]
    v_and_b32 v1, 1, v20
    v_mfma_f32_16x16x32_bf16 v[212:215], a[116:119], a[84:87], v[212:215]
    ds_read_b64_tr_b16 a[60:61], v16 offset:0
    v_mfma_f32_16x16x32_bf16 v[216:219], a[116:119], a[88:91], v[216:219]
    v_lshlrev_b32 v1, 7, v1
    v_mfma_f32_16x16x32_bf16 v[220:223], a[116:119], a[92:95], v[220:223]
    ds_read_b64_tr_b16 a[62:63], v16 offset:1024
    v_mfma_f32_16x16x32_bf16 v[224:227], a[120:123], a[64:67], v[224:227]
    buffer_load_dwordx4 v8, s[12:15], s42 offen offset:2048 lds
    v_mfma_f32_16x16x32_bf16 v[228:231], a[120:123], a[68:71], v[228:231]
    ds_read_b64_tr_b16 a[204:205], v28 offset:4096
    v_mfma_f32_16x16x32_bf16 v[232:235], a[120:123], a[72:75], v[232:235]
    v_mfma_f32_16x16x32_bf16 v[236:239], a[120:123], a[76:79], v[236:239]
    ds_read_b64_tr_b16 a[206:207], v28 offset:6144
    v_mfma_f32_16x16x32_bf16 v[240:243], a[120:123], a[80:83], v[240:243]
    buffer_load_dwordx4 v9, s[12:15], s42 offen offset:3072 lds
    buffer_load_dword a255, v1, s[76:79], s51 offen
    v_mfma_f32_16x16x32_bf16 v[244:247], a[120:123], a[84:87], v[244:247]
    v_mfma_f32_16x16x32_bf16 v[248:251], a[120:123], a[88:91], v[248:251]
    v_mfma_f32_16x16x32_bf16 v[252:255], a[120:123], a[92:95], v[252:255]
    v_mfma_f32_16x16x32_bf16 a[128:131], a[124:127], a[64:67], a[128:131]
    v_mfma_f32_16x16x32_bf16 a[132:135], a[124:127], a[68:71], a[132:135]
    s_add_u32 m0, s46, 49152
    v_mfma_f32_16x16x32_bf16 a[136:139], a[124:127], a[72:75], a[136:139]
    buffer_load_dwordx4 v6, s[16:19], s42 offen offset:0 lds
    v_mfma_f32_16x16x32_bf16 a[140:143], a[124:127], a[76:79], a[140:143]
    v_mfma_f32_16x16x32_bf16 a[144:147], a[124:127], a[80:83], a[144:147]
    v_mfma_f32_16x16x32_bf16 a[148:151], a[124:127], a[84:87], a[148:151]
    v_mfma_f32_16x16x32_bf16 a[152:155], a[124:127], a[88:91], a[152:155]
    v_mfma_f32_16x16x32_bf16 a[156:159], a[124:127], a[92:95], a[156:159]
    s_waitcnt lgkmcnt(0)
    v_mfma_f32_16x16x32_bf16 v[32:35], a[32:35], a[0:3], v[32:35]
    ds_read_b64_tr_b16 a[96:97], v12 offset:8192
    v_mfma_f32_16x16x32_bf16 v[36:39], a[32:35], a[4:7], v[36:39]
    buffer_load_dwordx4 v7, s[16:19], s42 offen offset:1024 lds
    v_mfma_f32_16x16x32_bf16 v[40:43], a[32:35], a[8:11], v[40:43]
    ds_read_b64_tr_b16 a[98:99], v12 offset:9216
    v_mfma_f32_16x16x32_bf16 v[44:47], a[32:35], a[12:15], v[44:47]
    v_mfma_f32_16x16x32_bf16 v[48:51], a[32:35], a[16:19], v[48:51]
    ds_read_b128 a[64:67], v11 offset:0
    v_mfma_f32_16x16x32_bf16 v[52:55], a[32:35], a[20:23], v[52:55]
    buffer_load_dwordx4 v8, s[16:19], s42 offen offset:2048 lds
    v_mfma_f32_16x16x32_bf16 v[56:59], a[32:35], a[24:27], v[56:59]
    ds_read_b128 a[68:71], v11 offset:2048
    v_mfma_f32_16x16x32_bf16 v[60:63], a[32:35], a[28:31], v[60:63]
    v_mfma_f32_16x16x32_bf16 v[64:67], a[36:39], a[0:3], v[64:67]
    ds_read_b128 a[72:75], v11 offset:4096
    v_mfma_f32_16x16x32_bf16 v[68:71], a[36:39], a[4:7], v[68:71]
    buffer_load_dwordx4 v9, s[16:19], s42 offen offset:3072 lds
    v_mfma_f32_16x16x32_bf16 v[72:75], a[36:39], a[8:11], v[72:75]
    ds_read_b128 a[76:79], v11 offset:6144
    s_add_u32 s42, s42, 458752
    v_mfma_f32_16x16x32_bf16 v[76:79], a[36:39], a[12:15], v[76:79]
    v_mfma_f32_16x16x32_bf16 v[80:83], a[36:39], a[16:19], v[80:83]
    ds_read_b128 a[80:83], v11 offset:8192
    s_add_u32 m0, s56, 2048
    v_mfma_f32_16x16x32_bf16 v[84:87], a[36:39], a[20:23], v[84:87]
    buffer_load_dwordx4 v0, s[4:7], s43 offen lds
    v_mfma_f32_16x16x32_bf16 v[88:91], a[36:39], a[24:27], v[88:91]
    ds_read_b128 a[84:87], v11 offset:10240
    s_add_u32 s43, s43, 0x20000
    v_mfma_f32_16x16x32_bf16 v[92:95], a[36:39], a[28:31], v[92:95]
    buffer_store_dwordx4 a[204:207], v27, s[24:27], s100 offen sc1
    v_mfma_f32_16x16x32_bf16 v[96:99], a[40:43], a[0:3], v[96:99]
    ds_read_b128 a[88:91], v11 offset:12288
    s_add_u32 s100, s100, 8192
    v_mfma_f32_16x16x32_bf16 v[100:103], a[40:43], a[4:7], v[100:103]
    v_mfma_f32_16x16x32_bf16 v[104:107], a[40:43], a[8:11], v[104:107]
    ds_read_b128 a[92:95], v11 offset:14336
    v_mfma_f32_16x16x32_bf16 v[108:111], a[40:43], a[12:15], v[108:111]
    v_mfma_f32_16x16x32_bf16 v[112:115], a[40:43], a[16:19], v[112:115]
    ds_read_b64_tr_b16 a[100:101], v13 offset:8192
    v_mfma_f32_16x16x32_bf16 v[116:119], a[40:43], a[20:23], v[116:119]
    v_mfma_f32_16x16x32_bf16 v[120:123], a[40:43], a[24:27], v[120:123]
    ds_read_b64_tr_b16 a[102:103], v13 offset:9216
    v_mfma_f32_16x16x32_bf16 v[124:127], a[40:43], a[28:31], v[124:127]
    v_mfma_f32_16x16x32_bf16 v[128:131], a[44:47], a[0:3], v[128:131]
    ds_read_b64_tr_b16 a[104:105], v14 offset:8192
    v_mfma_f32_16x16x32_bf16 v[132:135], a[44:47], a[4:7], v[132:135]
    v_mfma_f32_16x16x32_bf16 v[136:139], a[44:47], a[8:11], v[136:139]
    ds_read_b64_tr_b16 a[106:107], v14 offset:9216
    v_mfma_f32_16x16x32_bf16 v[140:143], a[44:47], a[12:15], v[140:143]
    v_mfma_f32_16x16x32_bf16 v[144:147], a[44:47], a[16:19], v[144:147]
    ds_read_b64_tr_b16 a[108:109], v15 offset:8192
    v_mfma_f32_16x16x32_bf16 v[148:151], a[44:47], a[20:23], v[148:151]
    v_mfma_f32_16x16x32_bf16 v[152:155], a[44:47], a[24:27], v[152:155]
    ds_read_b64_tr_b16 a[110:111], v15 offset:9216
    v_mfma_f32_16x16x32_bf16 v[156:159], a[44:47], a[28:31], v[156:159]
    v_mfma_f32_16x16x32_bf16 v[160:163], a[48:51], a[0:3], v[160:163]
    ds_read_b64_tr_b16 a[112:113], v12 offset:24576
    v_mfma_f32_16x16x32_bf16 v[164:167], a[48:51], a[4:7], v[164:167]
    v_mfma_f32_16x16x32_bf16 v[168:171], a[48:51], a[8:11], v[168:171]
    ds_read_b64_tr_b16 a[114:115], v12 offset:25600
    v_mfma_f32_16x16x32_bf16 v[172:175], a[48:51], a[12:15], v[172:175]
    v_mfma_f32_16x16x32_bf16 v[176:179], a[48:51], a[16:19], v[176:179]
    ds_read_b64_tr_b16 a[116:117], v13 offset:24576
    v_mfma_f32_16x16x32_bf16 v[180:183], a[48:51], a[20:23], v[180:183]
    v_mfma_f32_16x16x32_bf16 v[184:187], a[48:51], a[24:27], v[184:187]
    ds_read_b64_tr_b16 a[118:119], v13 offset:25600
    v_mfma_f32_16x16x32_bf16 v[188:191], a[48:51], a[28:31], v[188:191]
    v_mfma_f32_16x16x32_bf16 v[192:195], a[52:55], a[0:3], v[192:195]
    ds_read_b64_tr_b16 a[120:121], v14 offset:24576
    v_mfma_f32_16x16x32_bf16 v[196:199], a[52:55], a[4:7], v[196:199]
    v_mfma_f32_16x16x32_bf16 v[200:203], a[52:55], a[8:11], v[200:203]
    ds_read_b64_tr_b16 a[122:123], v14 offset:25600
    v_mfma_f32_16x16x32_bf16 v[204:207], a[52:55], a[12:15], v[204:207]
    v_mfma_f32_16x16x32_bf16 v[208:211], a[52:55], a[16:19], v[208:211]
    ds_read_b64_tr_b16 a[124:125], v16 offset:8192
    v_mfma_f32_16x16x32_bf16 v[212:215], a[52:55], a[20:23], v[212:215]
    v_mfma_f32_16x16x32_bf16 v[216:219], a[52:55], a[24:27], v[216:219]
    ds_read_b64_tr_b16 a[126:127], v16 offset:9216
    v_mfma_f32_16x16x32_bf16 v[220:223], a[52:55], a[28:31], v[220:223]
    v_mfma_f32_16x16x32_bf16 v[224:227], a[56:59], a[0:3], v[224:227]
    v_mfma_f32_16x16x32_bf16 v[228:231], a[56:59], a[4:7], v[228:231]
    v_mfma_f32_16x16x32_bf16 v[232:235], a[56:59], a[8:11], v[232:235]
    v_mfma_f32_16x16x32_bf16 v[236:239], a[56:59], a[12:15], v[236:239]
    v_mfma_f32_16x16x32_bf16 v[240:243], a[56:59], a[16:19], v[240:243]
    v_mfma_f32_16x16x32_bf16 v[244:247], a[56:59], a[20:23], v[244:247]
    v_mfma_f32_16x16x32_bf16 v[248:251], a[56:59], a[24:27], v[248:251]
    v_mfma_f32_16x16x32_bf16 v[252:255], a[56:59], a[28:31], v[252:255]
    v_mfma_f32_16x16x32_bf16 a[128:131], a[60:63], a[0:3], a[128:131]
    v_mfma_f32_16x16x32_bf16 a[132:135], a[60:63], a[4:7], a[132:135]
    v_xor_b32 v15, s50, v15
    v_mfma_f32_16x16x32_bf16 a[136:139], a[60:63], a[8:11], a[136:139]
    v_mfma_f32_16x16x32_bf16 a[140:143], a[60:63], a[12:15], a[140:143]
    v_xor_b32 v16, s50, v16
    v_mfma_f32_16x16x32_bf16 a[144:147], a[60:63], a[16:19], a[144:147]
    v_mfma_f32_16x16x32_bf16 a[148:151], a[60:63], a[20:23], a[148:151]
    v_mfma_f32_16x16x32_bf16 a[152:155], a[60:63], a[24:27], a[152:155]
    v_mfma_f32_16x16x32_bf16 a[156:159], a[60:63], a[28:31], a[156:159]
    s_waitcnt vmcnt(1) lgkmcnt(0)
    s_barrier
    v_mfma_f32_16x16x32_bf16 v[32:35], a[96:99], a[64:67], v[32:35]
    v_lshlrev_b32 v18, 7, v20
    v_mfma_f32_16x16x32_bf16 v[36:39], a[96:99], a[68:71], v[36:39]
    ds_read_b64_tr_b16 a[32:33], v12 offset:32768
    v_mfma_f32_16x16x32_bf16 v[40:43], a[96:99], a[72:75], v[40:43]
    s_mov_b32 s88, 0x1278000
    v_mfma_f32_16x16x32_bf16 v[44:47], a[96:99], a[76:79], v[44:47]
    ds_read_b64_tr_b16 a[34:35], v12 offset:33792
    v_mfma_f32_16x16x32_bf16 v[48:51], a[96:99], a[80:83], v[48:51]
    v_mfma_f32_16x16x32_bf16 v[52:55], a[96:99], a[84:87], v[52:55]
    ds_read_b128 a[0:3], v10 offset:32768
    v_mfma_f32_16x16x32_bf16 v[56:59], a[96:99], a[88:91], v[56:59]
    v_mfma_f32_16x16x32_bf16 v[60:63], a[96:99], a[92:95], v[60:63]
    ds_read_b128 a[4:7], v10 offset:34816
    v_mfma_f32_16x16x32_bf16 v[64:67], a[100:103], a[64:67], v[64:67]
    v_mfma_f32_16x16x32_bf16 v[68:71], a[100:103], a[68:71], v[68:71]
    ds_read_b128 a[8:11], v10 offset:36864
    v_mfma_f32_16x16x32_bf16 v[72:75], a[100:103], a[72:75], v[72:75]
    buffer_load_dword v19, v18, s[24:27], s88 offen sc1
    v_mfma_f32_16x16x32_bf16 v[76:79], a[100:103], a[76:79], v[76:79]
    ds_read_b128 a[12:15], v10 offset:38912
    v_mfma_f32_16x16x32_bf16 v[80:83], a[100:103], a[80:83], v[80:83]
    v_mfma_f32_16x16x32_bf16 v[84:87], a[100:103], a[84:87], v[84:87]
    ds_read_b128 a[16:19], v10 offset:40960
    v_mfma_f32_16x16x32_bf16 v[88:91], a[100:103], a[88:91], v[88:91]
    v_mfma_f32_16x16x32_bf16 v[92:95], a[100:103], a[92:95], v[92:95]
    ds_read_b128 a[20:23], v10 offset:43008
    v_mfma_f32_16x16x32_bf16 v[96:99], a[104:107], a[64:67], v[96:99]
    v_mfma_f32_16x16x32_bf16 v[100:103], a[104:107], a[68:71], v[100:103]
    ds_read_b128 a[24:27], v10 offset:45056
    v_mfma_f32_16x16x32_bf16 v[104:107], a[104:107], a[72:75], v[104:107]
    v_mfma_f32_16x16x32_bf16 v[108:111], a[104:107], a[76:79], v[108:111]
    ds_read_b128 a[28:31], v10 offset:47104
    v_mfma_f32_16x16x32_bf16 v[112:115], a[104:107], a[80:83], v[112:115]
    v_mfma_f32_16x16x32_bf16 v[116:119], a[104:107], a[84:87], v[116:119]
    ds_read_b64_tr_b16 a[36:37], v13 offset:32768
    v_mfma_f32_16x16x32_bf16 v[120:123], a[104:107], a[88:91], v[120:123]
    v_mfma_f32_16x16x32_bf16 v[124:127], a[104:107], a[92:95], v[124:127]
    ds_read_b64_tr_b16 a[38:39], v13 offset:33792
    v_mfma_f32_16x16x32_bf16 v[128:131], a[108:111], a[64:67], v[128:131]
    v_mfma_f32_16x16x32_bf16 v[132:135], a[108:111], a[68:71], v[132:135]
    ds_read_b64_tr_b16 a[40:41], v14 offset:32768
    v_mfma_f32_16x16x32_bf16 v[136:139], a[108:111], a[72:75], v[136:139]
    v_mfma_f32_16x16x32_bf16 v[140:143], a[108:111], a[76:79], v[140:143]
    ds_read_b64_tr_b16 a[42:43], v14 offset:33792
    v_mfma_f32_16x16x32_bf16 v[144:147], a[108:111], a[80:83], v[144:147]
    v_mfma_f32_16x16x32_bf16 v[148:151], a[108:111], a[84:87], v[148:151]
    ds_read_b64_tr_b16 a[44:45], v15 offset:0
    v_mfma_f32_16x16x32_bf16 v[152:155], a[108:111], a[88:91], v[152:155]
    v_mfma_f32_16x16x32_bf16 v[156:159], a[108:111], a[92:95], v[156:159]
    ds_read_b64_tr_b16 a[46:47], v15 offset:1024
    v_mfma_f32_16x16x32_bf16 v[160:163], a[112:115], a[64:67], v[160:163]
    v_mfma_f32_16x16x32_bf16 v[164:167], a[112:115], a[68:71], v[164:167]
    ds_read_b64_tr_b16 a[48:49], v12 offset:49152
    v_mfma_f32_16x16x32_bf16 v[168:171], a[112:115], a[72:75], v[168:171]
    v_mfma_f32_16x16x32_bf16 v[172:175], a[112:115], a[76:79], v[172:175]
    ds_read_b64_tr_b16 a[50:51], v12 offset:50176
    v_mfma_f32_16x16x32_bf16 v[176:179], a[112:115], a[80:83], v[176:179]
    v_mfma_f32_16x16x32_bf16 v[180:183], a[112:115], a[84:87], v[180:183]
    ds_read_b64_tr_b16 a[52:53], v13 offset:49152
    v_mfma_f32_16x16x32_bf16 v[184:187], a[112:115], a[88:91], v[184:187]
KM_PAD7:
    s_cbranch_execz KM_RET1
    s_nop 0
    v_mfma_f32_16x16x32_bf16 v[188:191], a[112:115], a[92:95], v[188:191]
    ds_read_b64_tr_b16 a[54:55], v13 offset:50176
    v_mfma_f32_16x16x32_bf16 v[192:195], a[116:119], a[64:67], v[192:195]
    v_mfma_f32_16x16x32_bf16 v[196:199], a[116:119], a[68:71], v[196:199]
    ds_read_b64_tr_b16 a[56:57], v14 offset:49152
    v_mfma_f32_16x16x32_bf16 v[200:203], a[116:119], a[72:75], v[200:203]
    v_mfma_f32_16x16x32_bf16 v[204:207], a[116:119], a[76:79], v[204:207]
    ds_read_b64_tr_b16 a[58:59], v14 offset:50176
    v_mfma_f32_16x16x32_bf16 v[208:211], a[116:119], a[80:83], v[208:211]
    v_mfma_f32_16x16x32_bf16 v[212:215], a[116:119], a[84:87], v[212:215]
    ds_read_b64_tr_b16 a[60:61], v16 offset:0
    v_mfma_f32_16x16x32_bf16 v[216:219], a[116:119], a[88:91], v[216:219]
    v_mfma_f32_16x16x32_bf16 v[220:223], a[116:119], a[92:95], v[220:223]
    ds_read_b64_tr_b16 a[62:63], v16 offset:1024
    v_mfma_f32_16x16x32_bf16 v[224:227], a[120:123], a[64:67], v[224:227]
    v_mfma_f32_16x16x32_bf16 v[228:231], a[120:123], a[68:71], v[228:231]
    ds_read_b64_tr_b16 a[204:205], v28 offset:8192
    v_mfma_f32_16x16x32_bf16 v[232:235], a[120:123], a[72:75], v[232:235]
    v_mfma_f32_16x16x32_bf16 v[236:239], a[120:123], a[76:79], v[236:239]
    ds_read_b64_tr_b16 a[206:207], v28 offset:10240
    v_mfma_f32_16x16x32_bf16 v[240:243], a[120:123], a[80:83], v[240:243]
    v_mfma_f32_16x16x32_bf16 v[244:247], a[120:123], a[84:87], v[244:247]
    v_mfma_f32_16x16x32_bf16 v[248:251], a[120:123], a[88:91], v[248:251]
    v_mfma_f32_16x16x32_bf16 v[252:255], a[120:123], a[92:95], v[252:255]
    v_mfma_f32_16x16x32_bf16 a[128:131], a[124:127], a[64:67], a[128:131]
    v_mfma_f32_16x16x32_bf16 a[132:135], a[124:127], a[68:71], a[132:135]
    v_mfma_f32_16x16x32_bf16 a[136:139], a[124:127], a[72:75], a[136:139]
    v_mfma_f32_16x16x32_bf16 a[140:143], a[124:127], a[76:79], a[140:143]
    v_mfma_f32_16x16x32_bf16 a[144:147], a[124:127], a[80:83], a[144:147]
    v_mfma_f32_16x16x32_bf16 a[148:151], a[124:127], a[84:87], a[148:151]
    v_mfma_f32_16x16x32_bf16 a[152:155], a[124:127], a[88:91], a[152:155]
    v_mfma_f32_16x16x32_bf16 a[156:159], a[124:127], a[92:95], a[156:159]
    s_waitcnt vmcnt(0)
    v_cmp_ne_u32 vcc, s89, v19
    s_and_b32 s80, s2, 7
    s_lshr_b32 s81, s80, 1
    s_lshl_b32 s28, s37, 2
    s_cbranch_vccnz KM_ESPIN
KM_EBACK:
    s_add_u32 s28, s28, s81
    s_lshl_b32 s30, s36, 13
    s_add_u32 s82, s30, 0x1200000
    s_add_u32 s16, s86, s82
    s_addc_u32 s17, s87, 0
    v_add_u32 v30, 4096, v27
    s_bitcmp1_b32 s36, 0
    s_cbranch_scc1 KM_LAST1
    s_waitcnt lgkmcnt(0)
    v_mfma_f32_16x16x32_bf16 v[32:35], a[32:35], a[0:3], v[32:35]
    buffer_store_dwordx4 a[204:207], v27, s[24:27], s100 offen sc1
    v_mfma_f32_16x16x32_bf16 v[36:39], a[32:35], a[4:7], v[36:39]
    ds_read_b128 a[64:67], v11 offset:32768
    s_lshr_b32 s81, s36, 1
    s_lshl_b32 s82, s37, 1
    v_mfma_f32_16x16x32_bf16 v[40:43], a[32:35], a[8:11], v[40:43]
    ds_read_b128 a[68:71], v11 offset:34816
    s_add_u32 s82, s82, s81
    s_mul_i32 s82, s82, 112
    v_mfma_f32_16x16x32_bf16 v[44:47], a[32:35], a[12:15], v[44:47]
    ds_read_b128 a[72:75], v11 offset:36864
    s_lshr_b32 s83, s38, 1
    s_mul_i32 s83, s83, 7
    v_mfma_f32_16x16x32_bf16 v[48:51], a[32:35], a[16:19], v[48:51]
    ds_read_b128 a[76:79], v11 offset:38912
    s_add_u32 s82, s82, s83
    s_and_b32 s84, s38, 1
    v_mfma_f32_16x16x32_bf16 v[52:55], a[32:35], a[20:23], v[52:55]
    ds_read_b128 a[80:83], v11 offset:40960
    s_add_u32 s85, s82, 6
    s_lshl_b32 s85, s85, 13
    v_mfma_f32_16x16x32_bf16 v[56:59], a[32:35], a[24:27], v[56:59]
    ds_read_b128 a[84:87], v11 offset:43008
    s_mul_i32 s83, s84, 3
    s_add_u32 s82, s82, s83
    v_mfma_f32_16x16x32_bf16 v[60:63], a[32:35], a[28:31], v[60:63]
    ds_read_b128 a[88:91], v11 offset:45056
    s_add_u32 s82, s82, 0
    s_lshl_b32 s82, s82, 13
    v_mfma_f32_16x16x32_bf16 v[64:67], a[36:39], a[0:3], v[64:67]
    ds_read_b128 a[92:95], v11 offset:47104
    s_add_u32 s83, s82, 8192
    s_and_b32 s80, s80, 1
    v_mfma_f32_16x16x32_bf16 v[68:71], a[36:39], a[4:7], v[68:71]
    ds_read_b64_tr_b16 a[96:97], v12 offset:40960
    s_lshl_b32 s80, s80, 2
    s_and_b32 s90, s38, 3
    v_mfma_f32_16x16x32_bf16 v[72:75], a[36:39], a[8:11], v[72:75]
    ds_read_b64_tr_b16 a[98:99], v12 offset:41984
    s_add_u32 s29, s80, s90
    s_lshr_b32 s90, s28, 1
    v_mfma_f32_16x16x32_bf16 v[76:79], a[36:39], a[12:15], v[76:79]
    ds_read_b64_tr_b16 a[100:101], v13 offset:40960
    s_mul_i32 s90, s90, 112
    s_mul_i32 s91, s36, 28
    v_mfma_f32_16x16x32_bf16 v[80:83], a[36:39], a[16:19], v[80:83]
    ds_read_b64_tr_b16 a[102:103], v13 offset:41984
    s_add_u32 s90, s90, s91
    s_lshl_b32 s90, s90, 13
    v_mfma_f32_16x16x32_bf16 v[84:87], a[36:39], a[20:23], v[84:87]
    ds_read_b64_tr_b16 a[112:113], v12 offset:57344
    s_and_b32 s42, s28, 1
    s_lshl_b32 s42, s42, 12
    v_mfma_f32_16x16x32_bf16 v[88:91], a[36:39], a[24:27], v[88:91]
    ds_read_b64_tr_b16 a[114:115], v12 offset:58368
    s_add_u32 s90, s90, s42
    s_add_u32 s58, s86, s90
    s_addc_u32 s59, s87, 0
    v_mfma_f32_16x16x32_bf16 v[92:95], a[36:39], a[28:31], v[92:95]
    ds_read_b64_tr_b16 a[116:117], v13 offset:57344
    s_add_u32 s60, s58, 0x2000
    s_addc_u32 s61, s59, 0
    s_add_u32 s62, s58, 0x4000
    s_addc_u32 s63, s59, 0
    v_mfma_f32_16x16x32_bf16 v[160:163], a[48:51], a[0:3], v[160:163]
    ds_read_b64_tr_b16 a[118:119], v13 offset:58368
    s_add_u32 s70, s58, 0x6000
    s_addc_u32 s71, s59, 0
    s_mov_b64 s[12:13], s[70:71]
    v_mfma_f32_16x16x32_bf16 v[164:167], a[48:51], a[4:7], v[164:167]
    ds_read_b64_tr_b16 a[104:105], v14 offset:40960
    s_mul_i32 s90, s29, 144
    s_add_u32 s91, s91, s90
    v_mfma_f32_16x16x32_bf16 v[168:171], a[48:51], a[8:11], v[168:171]
    ds_read_b64_tr_b16 a[106:107], v14 offset:41984
    s_lshl_b32 s91, s91, 13
    s_add_u32 s91, s91, 0x1700000
    v_mfma_f32_16x16x32_bf16 v[172:175], a[48:51], a[12:15], v[172:175]
    ds_read_b64_tr_b16 a[108:109], v15 offset:8192
    s_add_u32 s64, s86, s91
    s_addc_u32 s65, s87, 0
    s_add_u32 s68, s64, 0x2000
    s_addc_u32 s69, s65, 0
    v_mfma_f32_16x16x32_bf16 v[176:179], a[48:51], a[16:19], v[176:179]
    ds_read_b64_tr_b16 a[110:111], v15 offset:9216
    s_mov_b64 s[14:15], s[68:69]
    s_add_u32 s18, s64, 221184
    s_addc_u32 s19, s65, 0
    v_mfma_f32_16x16x32_bf16 v[180:183], a[48:51], a[20:23], v[180:183]
    ds_read_b64_tr_b16 a[120:121], v14 offset:57344
    s_lshl_b32 s91, s36, 3
    s_add_u32 s90, s90, s91
    v_mfma_f32_16x16x32_bf16 v[184:187], a[48:51], a[24:27], v[184:187]
    ds_read_b64_tr_b16 a[122:123], v14 offset:58368
    s_lshl_b32 s90, s90, 13
    s_add_u32 s90, s90, 0x17e0000
    v_mfma_f32_16x16x32_bf16 v[188:191], a[48:51], a[28:31], v[188:191]
    ds_read_b64_tr_b16 a[124:125], v16 offset:8192
    s_add_u32 s32, s86, s90
    s_addc_u32 s33, s87, 0
    s_mul_i32 s31, s36, 24576
    v_mfma_f32_16x16x32_bf16 v[192:195], a[52:55], a[0:3], v[192:195]
    ds_read_b64_tr_b16 a[126:127], v16 offset:9216
    s_add_u32 s31, s31, 65536
    s_mov_b32 s35, s31
    v_mfma_f32_16x16x32_bf16 v[196:199], a[52:55], a[4:7], v[196:199]
    s_add_u32 s34, s30, 0x8000
    s_mov_b32 s39, 6
    v_mfma_f32_16x16x32_bf16 v[200:203], a[52:55], a[8:11], v[200:203]
    s_add_u32 m0, s30, 0
    s_add_u32 s66, s32, 16384
    s_addc_u32 s67, s33, 0
    s_mov_b32 s20, s96
    v_mfma_f32_16x16x32_bf16 v[204:207], a[52:55], a[12:15], v[204:207]
    global_load_lds_dwordx4 v27, s[16:17] offset:0 sc1
    global_load_lds_dwordx4 v27, s[16:17] offset:1024 sc1
    global_load_lds_dwordx4 v27, s[16:17] offset:2048 sc1
    global_load_lds_dwordx4 v27, s[16:17] offset:3072 sc1
    s_and_b32 s21, s97, 0xffff
    s_mov_b32 s22, 0x400000
    v_mfma_f32_16x16x32_bf16 v[208:211], a[52:55], a[16:19], v[208:211]
    s_mov_b32 s23, 0x00020000
    s_mov_b32 s10, s57
    v_mfma_f32_16x16x32_bf16 v[212:215], a[52:55], a[20:23], v[212:215]
    s_add_u32 m0, s30, 4096
    s_lshl_b32 s90, s28, 12
    s_add_u32 s11, s90, 0x1250000
    v_mfma_f32_16x16x32_bf16 v[216:219], a[52:55], a[24:27], v[216:219]
    global_load_lds_dwordx4 v30, s[16:17] offset:0 sc1
    global_load_lds_dwordx4 v30, s[16:17] offset:1024 sc1
    global_load_lds_dwordx4 v30, s[16:17] offset:2048 sc1
    global_load_lds_dwordx4 v30, s[16:17] offset:3072 sc1
    s_lshl_b32 s90, s36, 13
    s_add_u32 s9, s90, 0x1270000
    v_mfma_f32_16x16x32_bf16 v[220:223], a[52:55], a[28:31], v[220:223]
    s_lshl_b32 s90, s2, 7
    s_add_u32 s90, s90, 0x1270000
    s_add_u32 s16, s16, 0x8000
    s_addc_u32 s17, s17, 0
    s_cmp_eq_u32 s36, 0
    s_cselect_b32 s8, s90, 0x7f000000
    s_mov_b32 s3, s83
    s_waitcnt lgkmcnt(8)
    v_mfma_f32_16x16x32_bf16 v[32:35], a[96:99], a[64:67], v[32:35]
    v_mfma_f32_16x16x32_bf16 v[160:163], a[112:115], a[64:67], v[160:163]
    v_mfma_f32_16x16x32_bf16 v[64:67], a[100:103], a[64:67], v[64:67]
    v_mfma_f32_16x16x32_bf16 v[192:195], a[116:119], a[64:67], v[192:195]
    v_mfma_f32_16x16x32_bf16 v[36:39], a[96:99], a[68:71], v[36:39]
    v_mfma_f32_16x16x32_bf16 v[164:167], a[112:115], a[68:71], v[164:167]
    v_mfma_f32_16x16x32_bf16 v[68:71], a[100:103], a[68:71], v[68:71]
    v_mfma_f32_16x16x32_bf16 v[196:199], a[116:119], a[68:71], v[196:199]
    v_mfma_f32_16x16x32_bf16 v[40:43], a[96:99], a[72:75], v[40:43]
    v_mfma_f32_16x16x32_bf16 v[168:171], a[112:115], a[72:75], v[168:171]
    v_mfma_f32_16x16x32_bf16 v[72:75], a[100:103], a[72:75], v[72:75]
    v_mfma_f32_16x16x32_bf16 v[200:203], a[116:119], a[72:75], v[200:203]
    v_mfma_f32_16x16x32_bf16 v[44:47], a[96:99], a[76:79], v[44:47]
    v_max_f32 v32, 0, v32
    v_max_f32 v33, 0, v33
    v_mfma_f32_16x16x32_bf16 v[172:175], a[112:115], a[76:79], v[172:175]
    v_max_f32 v34, 0, v34
    v_max_f32 v35, 0, v35
    v_mfma_f32_16x16x32_bf16 v[76:79], a[100:103], a[76:79], v[76:79]
    v_mul_f32 v32, v32, v160
    v_mul_f32 v33, v33, v161
    v_mfma_f32_16x16x32_bf16 v[204:207], a[116:119], a[76:79], v[204:207]
    v_mul_f32 v34, v34, v162
    v_mul_f32 v35, v35, v163
    v_mfma_f32_16x16x32_bf16 v[48:51], a[96:99], a[80:83], v[48:51]
    v_max_f32 v64, 0, v64
    v_max_f32 v65, 0, v65
    v_mfma_f32_16x16x32_bf16 v[176:179], a[112:115], a[80:83], v[176:179]
    v_max_f32 v66, 0, v66
    v_max_f32 v67, 0, v67
    v_mfma_f32_16x16x32_bf16 v[80:83], a[100:103], a[80:83], v[80:83]
    v_mul_f32 v64, v64, v192
    v_mul_f32 v65, v65, v193
    v_mfma_f32_16x16x32_bf16 v[208:211], a[116:119], a[80:83], v[208:211]
    v_mul_f32 v66, v66, v194
    v_mul_f32 v67, v67, v195
    v_mfma_f32_16x16x32_bf16 v[52:55], a[96:99], a[84:87], v[52:55]
    v_cvt_pk_bf16_f32 v32, v32, v33
    v_cvt_pk_bf16_f32 v33, v34, v35
    v_mfma_f32_16x16x32_bf16 v[180:183], a[112:115], a[84:87], v[180:183]
    v_cvt_pk_bf16_f32 v34, v64, v65
    v_cvt_pk_bf16_f32 v35, v66, v67
    v_mfma_f32_16x16x32_bf16 v[84:87], a[100:103], a[84:87], v[84:87]
    buffer_store_dwordx4 v[32:35], v27, s[24:27], s82 offen offset:0 sc1
    v_mfma_f32_16x16x32_bf16 v[212:215], a[116:119], a[84:87], v[212:215]
    v_max_f32 v36, 0, v36
    v_max_f32 v37, 0, v37
    v_mfma_f32_16x16x32_bf16 v[56:59], a[96:99], a[88:91], v[56:59]
    v_max_f32 v38, 0, v38
    v_max_f32 v39, 0, v39
    v_mfma_f32_16x16x32_bf16 v[184:187], a[112:115], a[88:91], v[184:187]
    v_mul_f32 v36, v36, v164
    v_mul_f32 v37, v37, v165
    v_mfma_f32_16x16x32_bf16 v[88:91], a[100:103], a[88:91], v[88:91]
    v_mul_f32 v38, v38, v166
    v_mul_f32 v39, v39, v167
    v_mfma_f32_16x16x32_bf16 v[216:219], a[116:119], a[88:91], v[216:219]
    v_max_f32 v68, 0, v68
    v_max_f32 v69, 0, v69
    v_mfma_f32_16x16x32_bf16 v[60:63], a[96:99], a[92:95], v[60:63]
    v_max_f32 v70, 0, v70
    v_max_f32 v71, 0, v71
    v_mfma_f32_16x16x32_bf16 v[188:191], a[112:115], a[92:95], v[188:191]
    v_mul_f32 v68, v68, v196
    v_mul_f32 v69, v69, v197
    v_mfma_f32_16x16x32_bf16 v[92:95], a[100:103], a[92:95], v[92:95]
    v_mul_f32 v70, v70, v198
    v_mul_f32 v71, v71, v199
    v_mfma_f32_16x16x32_bf16 v[220:223], a[116:119], a[92:95], v[220:223]
    v_cvt_pk_bf16_f32 v36, v36, v37
    v_cvt_pk_bf16_f32 v37, v38, v39
    s_waitcnt lgkmcnt(0)
    v_mfma_f32_16x16x32_bf16 v[96:99], a[40:43], a[0:3], v[96:99]
    v_cvt_pk_bf16_f32 v38, v68, v69
    v_cvt_pk_bf16_f32 v39, v70, v71
    v_mfma_f32_16x16x32_bf16 v[100:103], a[40:43], a[4:7], v[100:103]
    buffer_store_dwordx4 v[36:39], v27, s[24:27], s82 offen offset:1024 sc1
    v_mfma_f32_16x16x32_bf16 v[104:107], a[40:43], a[8:11], v[104:107]
    v_max_f32 v40, 0, v40
    v_max_f32 v41, 0, v41
    v_mfma_f32_16x16x32_bf16 v[108:111], a[40:43], a[12:15], v[108:111]
    v_max_f32 v42, 0, v42
    v_max_f32 v43, 0, v43
    v_mfma_f32_16x16x32_bf16 v[112:115], a[40:43], a[16:19], v[112:115]
    v_mul_f32 v40, v40, v168
    v_mul_f32 v41, v41, v169
    v_mfma_f32_16x16x32_bf16 v[116:119], a[40:43], a[20:23], v[116:119]
    v_mul_f32 v42, v42, v170
    v_mul_f32 v43, v43, v171
    v_mfma_f32_16x16x32_bf16 v[120:123], a[40:43], a[24:27], v[120:123]
    v_max_f32 v72, 0, v72
    v_max_f32 v73, 0, v73
    v_mfma_f32_16x16x32_bf16 v[124:127], a[40:43], a[28:31], v[124:127]
    v_max_f32 v74, 0, v74
    v_max_f32 v75, 0, v75
    v_mfma_f32_16x16x32_bf16 v[128:131], a[44:47], a[0:3], v[128:131]
    v_mul_f32 v72, v72, v200
    v_mul_f32 v73, v73, v201
    v_mfma_f32_16x16x32_bf16 v[132:135], a[44:47], a[4:7], v[132:135]
    v_mul_f32 v74, v74, v202
    v_mul_f32 v75, v75, v203
    v_mfma_f32_16x16x32_bf16 v[136:139], a[44:47], a[8:11], v[136:139]
    v_cvt_pk_bf16_f32 v40, v40, v41
    v_cvt_pk_bf16_f32 v41, v42, v43
    v_mfma_f32_16x16x32_bf16 v[140:143], a[44:47], a[12:15], v[140:143]
    v_cvt_pk_bf16_f32 v42, v72, v73
    v_cvt_pk_bf16_f32 v43, v74, v75
    v_mfma_f32_16x16x32_bf16 v[144:147], a[44:47], a[16:19], v[144:147]
    buffer_store_dwordx4 v[40:43], v27, s[24:27], s82 offen offset:2048 sc1
    v_mfma_f32_16x16x32_bf16 v[148:151], a[44:47], a[20:23], v[148:151]
    v_max_f32 v44, 0, v44
    v_max_f32 v45, 0, v45
    v_mfma_f32_16x16x32_bf16 v[152:155], a[44:47], a[24:27], v[152:155]
    v_max_f32 v46, 0, v46
    v_max_f32 v47, 0, v47
    v_mfma_f32_16x16x32_bf16 v[156:159], a[44:47], a[28:31], v[156:159]
    v_mul_f32 v44, v44, v172
    v_mul_f32 v45, v45, v173
    v_mfma_f32_16x16x32_bf16 v[224:227], a[56:59], a[0:3], v[224:227]
    v_mul_f32 v46, v46, v174
    v_mul_f32 v47, v47, v175
    v_mfma_f32_16x16x32_bf16 v[228:231], a[56:59], a[4:7], v[228:231]
    v_max_f32 v76, 0, v76
    v_max_f32 v77, 0, v77
    v_mfma_f32_16x16x32_bf16 v[232:235], a[56:59], a[8:11], v[232:235]
    v_max_f32 v78, 0, v78
    v_max_f32 v79, 0, v79
    v_mfma_f32_16x16x32_bf16 v[236:239], a[56:59], a[12:15], v[236:239]
    v_mul_f32 v76, v76, v204
    v_mul_f32 v77, v77, v205
    v_mfma_f32_16x16x32_bf16 v[240:243], a[56:59], a[16:19], v[240:243]
    v_mul_f32 v78, v78, v206
    v_mul_f32 v79, v79, v207
    v_mfma_f32_16x16x32_bf16 v[244:247], a[56:59], a[20:23], v[244:247]
    v_cvt_pk_bf16_f32 v44, v44, v45
    v_cvt_pk_bf16_f32 v45, v46, v47
    v_mfma_f32_16x16x32_bf16 v[248:251], a[56:59], a[24:27], v[248:251]
    v_cvt_pk_bf16_f32 v46, v76, v77
    v_cvt_pk_bf16_f32 v47, v78, v79
    v_mfma_f32_16x16x32_bf16 v[252:255], a[56:59], a[28:31], v[252:255]
    buffer_store_dwordx4 v[44:47], v27, s[24:27], s82 offen offset:3072 sc1
    v_mfma_f32_16x16x32_bf16 a[128:131], a[60:63], a[0:3], a[128:131]
    v_max_f32 v48, 0, v48
    v_max_f32 v49, 0, v49
    v_mfma_f32_16x16x32_bf16 a[132:135], a[60:63], a[4:7], a[132:135]
    v_max_f32 v50, 0, v50
    v_max_f32 v51, 0, v51
    v_mfma_f32_16x16x32_bf16 a[136:139], a[60:63], a[8:11], a[136:139]
    v_mul_f32 v48, v48, v176
    v_mul_f32 v49, v49, v177
    v_mfma_f32_16x16x32_bf16 a[140:143], a[60:63], a[12:15], a[140:143]
    v_mul_f32 v50, v50, v178
    v_mul_f32 v51, v51, v179
    v_mfma_f32_16x16x32_bf16 a[144:147], a[60:63], a[16:19], a[144:147]
    v_max_f32 v80, 0, v80
    v_max_f32 v81, 0, v81
    v_mfma_f32_16x16x32_bf16 a[148:151], a[60:63], a[20:23], a[148:151]
    v_max_f32 v82, 0, v82
    v_max_f32 v83, 0, v83
    v_mfma_f32_16x16x32_bf16 a[152:155], a[60:63], a[24:27], a[152:155]
    v_mul_f32 v80, v80, v208
    v_mul_f32 v81, v81, v209
    v_mfma_f32_16x16x32_bf16 a[156:159], a[60:63], a[28:31], a[156:159]
    v_mul_f32 v82, v82, v210
    v_mul_f32 v83, v83, v211
    v_mfma_f32_16x16x32_bf16 v[96:99], a[104:107], a[64:67], v[96:99]
    v_cvt_pk_bf16_f32 v48, v48, v49
    v_cvt_pk_bf16_f32 v49, v50, v51
    v_mfma_f32_16x16x32_bf16 v[224:227], a[120:123], a[64:67], v[224:227]
    v_cvt_pk_bf16_f32 v50, v80, v81
    v_cvt_pk_bf16_f32 v51, v82, v83
    v_mfma_f32_16x16x32_bf16 v[128:131], a[108:111], a[64:67], v[128:131]
    buffer_store_dwordx4 v[48:51], v30, s[24:27], s82 offen offset:0 sc1
    v_mfma_f32_16x16x32_bf16 a[128:131], a[124:127], a[64:67], a[128:131]
    v_max_f32 v52, 0, v52
    v_max_f32 v53, 0, v53
    v_mfma_f32_16x16x32_bf16 v[100:103], a[104:107], a[68:71], v[100:103]
    v_max_f32 v54, 0, v54
    v_max_f32 v55, 0, v55
    v_mfma_f32_16x16x32_bf16 v[228:231], a[120:123], a[68:71], v[228:231]
    v_mul_f32 v52, v52, v180
    v_mul_f32 v53, v53, v181
    v_mfma_f32_16x16x32_bf16 v[132:135], a[108:111], a[68:71], v[132:135]
    v_mul_f32 v54, v54, v182
    v_mul_f32 v55, v55, v183
    v_mfma_f32_16x16x32_bf16 a[132:135], a[124:127], a[68:71], a[132:135]
    v_max_f32 v84, 0, v84
    v_max_f32 v85, 0, v85
    v_mfma_f32_16x16x32_bf16 v[104:107], a[104:107], a[72:75], v[104:107]
    v_max_f32 v86, 0, v86
    v_max_f32 v87, 0, v87
    v_mfma_f32_16x16x32_bf16 v[232:235], a[120:123], a[72:75], v[232:235]
    v_mul_f32 v84, v84, v212
    v_mul_f32 v85, v85, v213
    v_mfma_f32_16x16x32_bf16 v[136:139], a[108:111], a[72:75], v[136:139]
    v_mul_f32 v86, v86, v214
    v_mul_f32 v87, v87, v215
    v_mfma_f32_16x16x32_bf16 a[136:139], a[124:127], a[72:75], a[136:139]
    v_cvt_pk_bf16_f32 v52, v52, v53
    v_cvt_pk_bf16_f32 v53, v54, v55
    v_mfma_f32_16x16x32_bf16 v[108:111], a[104:107], a[76:79], v[108:111]
    v_cvt_pk_bf16_f32 v54, v84, v85
    v_cvt_pk_bf16_f32 v55, v86, v87
    v_mfma_f32_16x16x32_bf16 v[236:239], a[120:123], a[76:79], v[236:239]
    buffer_store_dwordx4 v[52:55], v30, s[24:27], s82 offen offset:1024 sc1
    v_mfma_f32_16x16x32_bf16 v[140:143], a[108:111], a[76:79], v[140:143]
    v_max_f32 v56, 0, v56
    v_max_f32 v57, 0, v57
    v_mfma_f32_16x16x32_bf16 a[140:143], a[124:127], a[76:79], a[140:143]
    v_max_f32 v58, 0, v58
    v_max_f32 v59, 0, v59
    v_mfma_f32_16x16x32_bf16 v[112:115], a[104:107], a[80:83], v[112:115]
    v_mul_f32 v56, v56, v184
    v_mul_f32 v57, v57, v185
    v_mfma_f32_16x16x32_bf16 v[240:243], a[120:123], a[80:83], v[240:243]
    v_mul_f32 v58, v58, v186
    v_mul_f32 v59, v59, v187
    v_mfma_f32_16x16x32_bf16 v[144:147], a[108:111], a[80:83], v[144:147]
    v_max_f32 v88, 0, v88
    v_max_f32 v89, 0, v89
    v_mfma_f32_16x16x32_bf16 a[144:147], a[124:127], a[80:83], a[144:147]
    v_max_f32 v90, 0, v90
    v_max_f32 v91, 0, v91
    v_mfma_f32_16x16x32_bf16 v[116:119], a[104:107], a[84:87], v[116:119]
    v_mul_f32 v88, v88, v216
    v_mul_f32 v89, v89, v217
    v_mfma_f32_16x16x32_bf16 v[244:247], a[120:123], a[84:87], v[244:247]
    v_mul_f32 v90, v90, v218
    v_mul_f32 v91, v91, v219
    v_mfma_f32_16x16x32_bf16 v[148:151], a[108:111], a[84:87], v[148:151]
    v_cvt_pk_bf16_f32 v56, v56, v57
    v_cvt_pk_bf16_f32 v57, v58, v59
    v_mfma_f32_16x16x32_bf16 a[148:151], a[124:127], a[84:87], a[148:151]
    v_cvt_pk_bf16_f32 v58, v88, v89
    v_cvt_pk_bf16_f32 v59, v90, v91
    v_mfma_f32_16x16x32_bf16 v[120:123], a[104:107], a[88:91], v[120:123]
    buffer_store_dwordx4 v[56:59], v30, s[24:27], s82 offen offset:2048 sc1
    v_mfma_f32_16x16x32_bf16 v[248:251], a[120:123], a[88:91], v[248:251]
    v_max_f32 v60, 0, v60
    v_max_f32 v61, 0, v61
    v_mfma_f32_16x16x32_bf16 v[152:155], a[108:111], a[88:91], v[152:155]
    v_max_f32 v62, 0, v62
    v_max_f32 v63, 0, v63
    v_mfma_f32_16x16x32_bf16 a[152:155], a[124:127], a[88:91], a[152:155]
    v_mul_f32 v60, v60, v188
    v_mul_f32 v61, v61, v189
    v_mfma_f32_16x16x32_bf16 v[124:127], a[104:107], a[92:95], v[124:127]
    v_mul_f32 v62, v62, v190
    v_mul_f32 v63, v63, v191
    v_mfma_f32_16x16x32_bf16 v[252:255], a[120:123], a[92:95], v[252:255]
    v_max_f32 v92, 0, v92
    v_max_f32 v93, 0, v93
    v_mfma_f32_16x16x32_bf16 v[156:159], a[108:111], a[92:95], v[156:159]
    v_max_f32 v94, 0, v94
    v_max_f32 v95, 0, v95
    v_mfma_f32_16x16x32_bf16 a[156:159], a[124:127], a[92:95], a[156:159]
    v_mul_f32 v92, v92, v220
    v_mul_f32 v93, v93, v221
    v_mul_f32 v94, v94, v222
    v_mul_f32 v95, v95, v223
    v_cvt_pk_bf16_f32 v60, v60, v61
    v_cvt_pk_bf16_f32 v61, v62, v63
    v_cvt_pk_bf16_f32 v62, v92, v93
    v_cvt_pk_bf16_f32 v63, v94, v95
    buffer_store_dwordx4 v[60:63], v30, s[24:27], s82 offen offset:3072 sc1
    v_accvgpr_read_b32 v12, a128
    v_accvgpr_read_b32 v13, a129
    v_accvgpr_read_b32 v14, a130
    v_accvgpr_read_b32 v15, a131
    v_max_f32 v96, 0, v96
    v_max_f32 v97, 0, v97
    v_max_f32 v98, 0, v98
    v_max_f32 v99, 0, v99
    v_pk_mul_f32 v[96:97], v[96:97], v[224:225]
    v_pk_mul_f32 v[98:99], v[98:99], v[226:227]
    v_max_f32 v128, 0, v128
    v_max_f32 v129, 0, v129
    v_max_f32 v130, 0, v130
    v_max_f32 v131, 0, v131
    v_pk_mul_f32 v[128:129], v[128:129], v[12:13]
    v_pk_mul_f32 v[130:131], v[130:131], v[14:15]
    v_cvt_pk_bf16_f32 v96, v96, v97
    v_cvt_pk_bf16_f32 v97, v98, v99
    v_cvt_pk_bf16_f32 v98, v128, v129
    v_cvt_pk_bf16_f32 v99, v130, v131
    buffer_store_dwordx4 v[96:99], v27, s[24:27], s83 offen offset:0 sc1
    v_accvgpr_read_b32 v16, a132
    v_accvgpr_read_b32 v17, a133
    v_accvgpr_read_b32 v18, a134
    v_accvgpr_read_b32 v19, a135
    v_max_f32 v100, 0, v100
    v_max_f32 v101, 0, v101
    v_max_f32 v102, 0, v102
    v_max_f32 v103, 0, v103
    v_pk_mul_f32 v[100:101], v[100:101], v[228:229]
    v_pk_mul_f32 v[102:103], v[102:103], v[230:231]
    v_max_f32 v132, 0, v132
    v_max_f32 v133, 0, v133
    v_max_f32 v134, 0, v134
    v_max_f32 v135, 0, v135
    v_pk_mul_f32 v[132:133], v[132:133], v[16:17]
    v_pk_mul_f32 v[134:135], v[134:135], v[18:19]
    v_cvt_pk_bf16_f32 v100, v100, v101
    v_cvt_pk_bf16_f32 v101, v102, v103
    v_cvt_pk_bf16_f32 v102, v132, v133
    v_cvt_pk_bf16_f32 v103, v134, v135
    buffer_store_dwordx4 v[100:103], v27, s[24:27], s83 offen offset:1024 sc1
    v_accvgpr_read_b32 v12, a136
    v_accvgpr_read_b32 v13, a137
    v_accvgpr_read_b32 v14, a138
    v_accvgpr_read_b32 v15, a139
    v_max_f32 v104, 0, v104
    v_max_f32 v105, 0, v105
    v_max_f32 v106, 0, v106
    v_max_f32 v107, 0, v107
    v_pk_mul_f32 v[104:105], v[104:105], v[232:233]
    v_pk_mul_f32 v[106:107], v[106:107], v[234:235]
    v_max_f32 v136, 0, v136
    v_max_f32 v137, 0, v137
    v_max_f32 v138, 0, v138
    v_max_f32 v139, 0, v139
    v_pk_mul_f32 v[136:137], v[136:137], v[12:13]
    v_pk_mul_f32 v[138:139], v[138:139], v[14:15]
    v_cvt_pk_bf16_f32 v104, v104, v105
    v_cvt_pk_bf16_f32 v105, v106, v107
    v_cvt_pk_bf16_f32 v106, v136, v137
    v_cvt_pk_bf16_f32 v107, v138, v139
    buffer_store_dwordx4 v[104:107], v27, s[24:27], s83 offen offset:2048 sc1
    v_accvgpr_read_b32 v16, a140
    v_accvgpr_read_b32 v17, a141
    v_accvgpr_read_b32 v18, a142
    v_accvgpr_read_b32 v19, a143
    v_max_f32 v108, 0, v108
    v_max_f32 v109, 0, v109
    v_max_f32 v110, 0, v110
    v_max_f32 v111, 0, v111
    v_pk_mul_f32 v[108:109], v[108:109], v[236:237]
    v_pk_mul_f32 v[110:111], v[110:111], v[238:239]
    v_max_f32 v140, 0, v140
    v_max_f32 v141, 0, v141
    v_max_f32 v142, 0, v142
    v_max_f32 v143, 0, v143
    v_pk_mul_f32 v[140:141], v[140:141], v[16:17]
    v_pk_mul_f32 v[142:143], v[142:143], v[18:19]
    v_cvt_pk_bf16_f32 v108, v108, v109
    v_cvt_pk_bf16_f32 v109, v110, v111
    v_cvt_pk_bf16_f32 v110, v140, v141
    v_cvt_pk_bf16_f32 v111, v142, v143
    buffer_store_dwordx4 v[108:111], v27, s[24:27], s83 offen offset:3072 sc1
    v_accvgpr_read_b32 v12, a144
    v_accvgpr_read_b32 v13, a145
    v_accvgpr_read_b32 v14, a146
    v_accvgpr_read_b32 v15, a147
    v_max_f32 v112, 0, v112
    v_max_f32 v113, 0, v113
    v_max_f32 v114, 0, v114
    v_max_f32 v115, 0, v115
    v_pk_mul_f32 v[112:113], v[112:113], v[240:241]
    v_pk_mul_f32 v[114:115], v[114:115], v[242:243]
    v_max_f32 v144, 0, v144
    v_max_f32 v145, 0, v145
    v_max_f32 v146, 0, v146
    v_max_f32 v147, 0, v147
    v_pk_mul_f32 v[144:145], v[144:145], v[12:13]
    v_pk_mul_f32 v[146:147], v[146:147], v[14:15]
    v_cvt_pk_bf16_f32 v112, v112, v113
    v_cvt_pk_bf16_f32 v113, v114, v115
    v_cvt_pk_bf16_f32 v114, v144, v145
    v_cvt_pk_bf16_f32 v115, v146, v147
    buffer_store_dwordx4 v[112:115], v30, s[24:27], s83 offen offset:0 sc1
    v_accvgpr_read_b32 v16, a148
    v_accvgpr_read_b32 v17, a149
    v_accvgpr_read_b32 v18, a150
    v_accvgpr_read_b32 v19, a151
    v_max_f32 v116, 0, v116
    v_max_f32 v117, 0, v117
    v_max_f32 v118, 0, v118
    v_max_f32 v119, 0, v119
    v_pk_mul_f32 v[116:117], v[116:117], v[244:245]
    v_pk_mul_f32 v[118:119], v[118:119], v[246:247]
    v_max_f32 v148, 0, v148
    v_max_f32 v149, 0, v149
    v_max_f32 v150, 0, v150
    v_max_f32 v151, 0, v151
    v_pk_mul_f32 v[148:149], v[148:149], v[16:17]
    v_pk_mul_f32 v[150:151], v[150:151], v[18:19]
    v_cvt_pk_bf16_f32 v116, v116, v117
    v_cvt_pk_bf16_f32 v117, v118, v119
    v_cvt_pk_bf16_f32 v118, v148, v149
    v_cvt_pk_bf16_f32 v119, v150, v151
    buffer_store_dwordx4 v[116:119], v30, s[24:27], s83 offen offset:1024 sc1
    v_accvgpr_read_b32 v12, a152
    v_accvgpr_read_b32 v13, a153
    v_accvgpr_read_b32 v14, a154
    v_accvgpr_read_b32 v15, a155
    v_max_f32 v120, 0, v120
    v_max_f32 v121, 0, v121
    v_max_f32 v122, 0, v122
    v_max_f32 v123, 0, v123
    v_pk_mul_f32 v[120:121], v[120:121], v[248:249]
    v_pk_mul_f32 v[122:123], v[122:123], v[250:251]
    v_max_f32 v152, 0, v152
    v_max_f32 v153, 0, v153
    v_max_f32 v154, 0, v154
    v_max_f32 v155, 0, v155
    v_pk_mul_f32 v[152:153], v[152:153], v[12:13]
    v_pk_mul_f32 v[154:155], v[154:155], v[14:15]
    v_cvt_pk_bf16_f32 v120, v120, v121
    v_cvt_pk_bf16_f32 v121, v122, v123
    v_cvt_pk_bf16_f32 v122, v152, v153
    v_cvt_pk_bf16_f32 v123, v154, v155
    buffer_store_dwordx4 v[120:123], v30, s[24:27], s83 offen offset:2048 sc1
    v_accvgpr_read_b32 v16, a156
    v_accvgpr_read_b32 v17, a157
    v_accvgpr_read_b32 v18, a158
    v_accvgpr_read_b32 v19, a159
    v_max_f32 v124, 0, v124
    v_max_f32 v125, 0, v125
    v_max_f32 v126, 0, v126
    v_max_f32 v127, 0, v127
    v_pk_mul_f32 v[124:125], v[124:125], v[252:253]
    v_pk_mul_f32 v[126:127], v[126:127], v[254:255]
    v_max_f32 v156, 0, v156
    v_max_f32 v157, 0, v157
    v_max_f32 v158, 0, v158
    v_max_f32 v159, 0, v159
    v_pk_mul_f32 v[156:157], v[156:157], v[16:17]
    v_pk_mul_f32 v[158:159], v[158:159], v[18:19]
    v_cvt_pk_bf16_f32 v124, v124, v125
    v_cvt_pk_bf16_f32 v125, v126, v127
    v_cvt_pk_bf16_f32 v126, v156, v157
    v_cvt_pk_bf16_f32 v127, v158, v159
    buffer_store_dwordx4 v[124:127], v30, s[24:27], s83 offen offset:3072 sc1
    s_branch KM_P2
KM_LAST1:
    s_waitcnt lgkmcnt(0)
    v_mfma_f32_16x16x32_bf16 v[96:99], a[40:43], a[0:3], v[96:99]
    buffer_store_dwordx4 a[204:207], v27, s[24:27], s100 offen sc1
    v_mfma_f32_16x16x32_bf16 v[100:103], a[40:43], a[4:7], v[100:103]
    ds_read_b128 a[64:67], v11 offset:32768
    s_lshr_b32 s81, s36, 1
    s_lshl_b32 s82, s37, 1
    v_mfma_f32_16x16x32_bf16 v[104:107], a[40:43], a[8:11], v[104:107]
    ds_read_b128 a[68:71], v11 offset:34816
    s_add_u32 s82, s82, s81
    s_mul_i32 s82, s82, 112
    v_mfma_f32_16x16x32_bf16 v[108:111], a[40:43], a[12:15], v[108:111]
    ds_read_b128 a[72:75], v11 offset:36864
    s_lshr_b32 s83, s38, 1
    s_mul_i32 s83, s83, 7
    v_mfma_f32_16x16x32_bf16 v[112:115], a[40:43], a[16:19], v[112:115]
    ds_read_b128 a[76:79], v11 offset:38912
    s_add_u32 s82, s82, s83
    s_and_b32 s84, s38, 1
    v_mfma_f32_16x16x32_bf16 v[116:119], a[40:43], a[20:23], v[116:119]
KM_PAD8:
    s_cbranch_execz KM_RET1
    s_nop 0
    ds_read_b128 a[80:83], v11 offset:40960
    s_add_u32 s85, s82, 6
    s_lshl_b32 s85, s85, 13
    v_mfma_f32_16x16x32_bf16 v[120:123], a[40:43], a[24:27], v[120:123]
    ds_read_b128 a[84:87], v11 offset:43008
    s_mul_i32 s83, s84, 3
    s_add_u32 s82, s82, s83
    v_mfma_f32_16x16x32_bf16 v[124:127], a[40:43], a[28:31], v[124:127]
    ds_read_b128 a[88:91], v11 offset:45056
    s_add_u32 s82, s82, 2
    s_lshl_b32 s82, s82, 13
    v_mfma_f32_16x16x32_bf16 v[128:131], a[44:47], a[0:3], v[128:131]
    ds_read_b128 a[92:95], v11 offset:47104
    s_add_u32 s83, s82, 8192
    s_lshl_b32 s84, s84, 9
    v_mfma_f32_16x16x32_bf16 v[132:135], a[44:47], a[4:7], v[132:135]
    ds_read_b64_tr_b16 a[104:105], v14 offset:40960
    s_add_u32 s85, s85, s84
    v_and_b32 v21, 15, v20
    v_mfma_f32_16x16x32_bf16 v[136:139], a[44:47], a[8:11], v[136:139]
    ds_read_b64_tr_b16 a[106:107], v14 offset:41984
    v_lshlrev_b32 v21, 4, v21
    v_bfe_u32 v24, v20, 4, 1
    v_mfma_f32_16x16x32_bf16 v[140:143], a[44:47], a[12:15], v[140:143]
    ds_read_b64_tr_b16 a[108:109], v15 offset:8192
    v_lshl_add_u32 v22, v24, 9, v21
    v_lshl_add_u32 v21, v24, 10, v21
    v_mfma_f32_16x16x32_bf16 v[144:147], a[44:47], a[16:19], v[144:147]
    ds_read_b64_tr_b16 a[110:111], v15 offset:9216
    v_lshrrev_b32 v24, 5, v20
    v_lshl_add_u32 v22, v24, 10, v22
    v_mfma_f32_16x16x32_bf16 v[148:151], a[44:47], a[20:23], v[148:151]
    ds_read_b64_tr_b16 a[120:121], v14 offset:57344
    v_lshl_add_u32 v21, v24, 8, v21
    s_lshl_b32 s81, s81, 13
    v_mfma_f32_16x16x32_bf16 v[152:155], a[44:47], a[24:27], v[152:155]
    ds_read_b64_tr_b16 a[122:123], v14 offset:58368
    s_add_u32 s81, s81, 65536
    v_add_u32 v22, s81, v22
    v_mfma_f32_16x16x32_bf16 v[156:159], a[44:47], a[28:31], v[156:159]
    ds_read_b64_tr_b16 a[124:125], v16 offset:8192
    v_add_u32 v23, 4096, v21
    s_and_b32 s80, s80, 1
    v_mfma_f32_16x16x32_bf16 v[224:227], a[56:59], a[0:3], v[224:227]
    ds_read_b64_tr_b16 a[126:127], v16 offset:9216
    s_lshl_b32 s80, s80, 2
    s_and_b32 s90, s38, 3
    v_mfma_f32_16x16x32_bf16 v[228:231], a[56:59], a[4:7], v[228:231]
    ds_read_b64_tr_b16 a[96:97], v12 offset:40960
    s_add_u32 s29, s80, s90
    s_lshr_b32 s90, s28, 1
    v_mfma_f32_16x16x32_bf16 v[232:235], a[56:59], a[8:11], v[232:235]
    ds_read_b64_tr_b16 a[98:99], v12 offset:41984
    s_mul_i32 s90, s90, 112
    s_mul_i32 s91, s36, 28
    v_mfma_f32_16x16x32_bf16 v[236:239], a[56:59], a[12:15], v[236:239]
    ds_read_b64_tr_b16 a[100:101], v13 offset:40960
    s_add_u32 s90, s90, s91
    s_lshl_b32 s90, s90, 13
    v_mfma_f32_16x16x32_bf16 v[240:243], a[56:59], a[16:19], v[240:243]
    ds_read_b64_tr_b16 a[102:103], v13 offset:41984
    s_and_b32 s42, s28, 1
    s_lshl_b32 s42, s42, 12
    v_mfma_f32_16x16x32_bf16 v[244:247], a[56:59], a[20:23], v[244:247]
    ds_read_b64_tr_b16 a[112:113], v12 offset:57344
    s_add_u32 s90, s90, s42
    s_add_u32 s58, s86, s90
    s_addc_u32 s59, s87, 0
    v_mfma_f32_16x16x32_bf16 v[248:251], a[56:59], a[24:27], v[248:251]
    ds_read_b64_tr_b16 a[114:115], v12 offset:58368
    s_add_u32 s60, s58, 0x2000
    s_addc_u32 s61, s59, 0
    s_add_u32 s62, s58, 0x4000
    s_addc_u32 s63, s59, 0
    v_mfma_f32_16x16x32_bf16 v[252:255], a[56:59], a[28:31], v[252:255]
    ds_read_b64_tr_b16 a[116:117], v13 offset:57344
    s_add_u32 s70, s58, 0x6000
    s_addc_u32 s71, s59, 0
    s_mov_b64 s[12:13], s[70:71]
    v_mfma_f32_16x16x32_bf16 a[128:131], a[60:63], a[0:3], a[128:131]
    ds_read_b64_tr_b16 a[118:119], v13 offset:58368
    s_mul_i32 s90, s29, 144
    s_add_u32 s91, s91, s90
    v_mfma_f32_16x16x32_bf16 a[132:135], a[60:63], a[4:7], a[132:135]
    s_lshl_b32 s91, s91, 13
    s_add_u32 s91, s91, 0x1700000
    v_mfma_f32_16x16x32_bf16 a[136:139], a[60:63], a[8:11], a[136:139]
    s_add_u32 m0, s30, 0
    s_add_u32 s64, s86, s91
    s_addc_u32 s65, s87, 0
    s_add_u32 s68, s64, 0x2000
    s_addc_u32 s69, s65, 0
    v_mfma_f32_16x16x32_bf16 a[140:143], a[60:63], a[12:15], a[140:143]
    global_load_lds_dwordx4 v27, s[16:17] offset:0 sc1
    global_load_lds_dwordx4 v27, s[16:17] offset:1024 sc1
    global_load_lds_dwordx4 v27, s[16:17] offset:2048 sc1
    global_load_lds_dwordx4 v27, s[16:17] offset:3072 sc1
    s_mov_b64 s[14:15], s[68:69]
    s_add_u32 s18, s64, 221184
    s_addc_u32 s19, s65, 0
    v_mfma_f32_16x16x32_bf16 a[144:147], a[60:63], a[16:19], a[144:147]
    s_lshl_b32 s91, s36, 3
    s_add_u32 s90, s90, s91
    v_mfma_f32_16x16x32_bf16 a[148:151], a[60:63], a[20:23], a[148:151]
    s_add_u32 m0, s30, 4096
    s_lshl_b32 s90, s90, 13
    s_add_u32 s90, s90, 0x17e0000
    v_mfma_f32_16x16x32_bf16 a[152:155], a[60:63], a[24:27], a[152:155]
    global_load_lds_dwordx4 v30, s[16:17] offset:0 sc1
    global_load_lds_dwordx4 v30, s[16:17] offset:1024 sc1
    global_load_lds_dwordx4 v30, s[16:17] offset:2048 sc1
    global_load_lds_dwordx4 v30, s[16:17] offset:3072 sc1
    s_add_u32 s32, s86, s90
    s_addc_u32 s33, s87, 0
    s_mul_i32 s31, s36, 24576
    v_mfma_f32_16x16x32_bf16 a[156:159], a[60:63], a[28:31], a[156:159]
    s_add_u32 s31, s31, 65536
    s_mov_b32 s35, s31
    s_add_u32 s16, s16, 0x8000
    s_addc_u32 s17, s17, 0
    s_add_u32 s34, s30, 0x8000
    s_mov_b32 s39, 6
    s_add_u32 s66, s32, 16384
    s_addc_u32 s67, s33, 0
    s_mov_b32 s20, s96
    s_and_b32 s21, s97, 0xffff
    s_mov_b32 s22, 0x400000
    s_mov_b32 s23, 0x00020000
    s_mov_b32 s10, s57
    s_lshl_b32 s90, s28, 12
    s_add_u32 s11, s90, 0x1250000
    s_lshl_b32 s90, s36, 13
    s_add_u32 s9, s90, 0x1270000
    s_lshl_b32 s90, s2, 7
    s_add_u32 s90, s90, 0x1270000
    s_cmp_eq_u32 s36, 0
    s_cselect_b32 s8, s90, 0x7f000000
    s_mov_b32 s3, s82
    s_waitcnt lgkmcnt(8)
    v_mfma_f32_16x16x32_bf16 v[128:131], a[108:111], a[64:67], v[128:131]
    v_mfma_f32_16x16x32_bf16 a[128:131], a[124:127], a[64:67], a[128:131]
    v_mfma_f32_16x16x32_bf16 v[132:135], a[108:111], a[68:71], v[132:135]
    v_mfma_f32_16x16x32_bf16 a[132:135], a[124:127], a[68:71], a[132:135]
    v_mfma_f32_16x16x32_bf16 v[136:139], a[108:111], a[72:75], v[136:139]
    v_mfma_f32_16x16x32_bf16 a[136:139], a[124:127], a[72:75], a[136:139]
    v_mfma_f32_16x16x32_bf16 v[140:143], a[108:111], a[76:79], v[140:143]
    v_mfma_f32_16x16x32_bf16 a[140:143], a[124:127], a[76:79], a[140:143]
    v_mfma_f32_16x16x32_bf16 v[144:147], a[108:111], a[80:83], v[144:147]
    v_mfma_f32_16x16x32_bf16 a[144:147], a[124:127], a[80:83], a[144:147]
    v_mfma_f32_16x16x32_bf16 v[148:151], a[108:111], a[84:87], v[148:151]
    v_accvgpr_read_b32 v12, a128
    v_accvgpr_read_b32 v13, a129
    v_mfma_f32_16x16x32_bf16 a[148:151], a[124:127], a[84:87], a[148:151]
    v_accvgpr_read_b32 v14, a130
    v_accvgpr_read_b32 v15, a131
    v_mfma_f32_16x16x32_bf16 v[152:155], a[108:111], a[88:91], v[152:155]
    v_cvt_pk_bf16_f32 v128, v128, v129
    v_cvt_pk_bf16_f32 v129, v130, v131
    v_mfma_f32_16x16x32_bf16 a[152:155], a[124:127], a[88:91], a[152:155]
    v_cvt_pk_bf16_f32 v130, v12, v13
    v_cvt_pk_bf16_f32 v131, v14, v15
    v_mfma_f32_16x16x32_bf16 v[156:159], a[108:111], a[92:95], v[156:159]
    ds_write_b128 v22, v[128:131] offset:0
    v_mfma_f32_16x16x32_bf16 a[156:159], a[124:127], a[92:95], a[156:159]
    v_accvgpr_read_b32 v16, a132
    v_accvgpr_read_b32 v17, a133
    v_mfma_f32_16x16x32_bf16 v[96:99], a[104:107], a[64:67], v[96:99]
    v_accvgpr_read_b32 v18, a134
    v_accvgpr_read_b32 v19, a135
    v_mfma_f32_16x16x32_bf16 v[224:227], a[120:123], a[64:67], v[224:227]
    v_cvt_pk_bf16_f32 v132, v132, v133
    v_cvt_pk_bf16_f32 v133, v134, v135
    v_mfma_f32_16x16x32_bf16 v[100:103], a[104:107], a[68:71], v[100:103]
    v_cvt_pk_bf16_f32 v134, v16, v17
    v_cvt_pk_bf16_f32 v135, v18, v19
    v_mfma_f32_16x16x32_bf16 v[228:231], a[120:123], a[68:71], v[228:231]
    ds_write_b128 v22, v[132:135] offset:256
    v_mfma_f32_16x16x32_bf16 v[104:107], a[104:107], a[72:75], v[104:107]
    v_accvgpr_read_b32 v12, a136
    v_accvgpr_read_b32 v13, a137
    v_mfma_f32_16x16x32_bf16 v[232:235], a[120:123], a[72:75], v[232:235]
    v_accvgpr_read_b32 v14, a138
    v_accvgpr_read_b32 v15, a139
    v_mfma_f32_16x16x32_bf16 v[108:111], a[104:107], a[76:79], v[108:111]
    v_cvt_pk_bf16_f32 v136, v136, v137
    v_cvt_pk_bf16_f32 v137, v138, v139
    v_mfma_f32_16x16x32_bf16 v[236:239], a[120:123], a[76:79], v[236:239]
    v_cvt_pk_bf16_f32 v138, v12, v13
    v_cvt_pk_bf16_f32 v139, v14, v15
    v_mfma_f32_16x16x32_bf16 v[112:115], a[104:107], a[80:83], v[112:115]
    ds_write_b128 v22, v[136:139] offset:2048
    v_mfma_f32_16x16x32_bf16 v[240:243], a[120:123], a[80:83], v[240:243]
    v_accvgpr_read_b32 v16, a140
    v_accvgpr_read_b32 v17, a141
    v_mfma_f32_16x16x32_bf16 v[116:119], a[104:107], a[84:87], v[116:119]
    v_accvgpr_read_b32 v18, a142
    v_accvgpr_read_b32 v19, a143
    v_mfma_f32_16x16x32_bf16 v[244:247], a[120:123], a[84:87], v[244:247]
    v_cvt_pk_bf16_f32 v140, v140, v141
    v_cvt_pk_bf16_f32 v141, v142, v143
    v_mfma_f32_16x16x32_bf16 v[120:123], a[104:107], a[88:91], v[120:123]
    v_cvt_pk_bf16_f32 v142, v16, v17
    v_cvt_pk_bf16_f32 v143, v18, v19
    v_mfma_f32_16x16x32_bf16 v[248:251], a[120:123], a[88:91], v[248:251]
    ds_write_b128 v22, v[140:143] offset:2304
    v_mfma_f32_16x16x32_bf16 v[124:127], a[104:107], a[92:95], v[124:127]
    v_accvgpr_read_b32 v12, a144
    v_accvgpr_read_b32 v13, a145
    v_mfma_f32_16x16x32_bf16 v[252:255], a[120:123], a[92:95], v[252:255]
    v_accvgpr_read_b32 v14, a146
    v_accvgpr_read_b32 v15, a147
    s_waitcnt lgkmcnt(4)
    v_mfma_f32_16x16x32_bf16 v[32:35], a[32:35], a[0:3], v[32:35]
    v_cvt_pk_bf16_f32 v144, v144, v145
    v_cvt_pk_bf16_f32 v145, v146, v147
    v_mfma_f32_16x16x32_bf16 v[36:39], a[32:35], a[4:7], v[36:39]
    v_cvt_pk_bf16_f32 v146, v12, v13
    v_cvt_pk_bf16_f32 v147, v14, v15
    v_mfma_f32_16x16x32_bf16 v[40:43], a[32:35], a[8:11], v[40:43]
    ds_write_b128 v22, v[144:147] offset:4096
    v_mfma_f32_16x16x32_bf16 v[44:47], a[32:35], a[12:15], v[44:47]
    v_accvgpr_read_b32 v16, a148
    v_accvgpr_read_b32 v17, a149
    v_mfma_f32_16x16x32_bf16 v[48:51], a[32:35], a[16:19], v[48:51]
    v_accvgpr_read_b32 v18, a150
    v_accvgpr_read_b32 v19, a151
    v_mfma_f32_16x16x32_bf16 v[52:55], a[32:35], a[20:23], v[52:55]
    v_cvt_pk_bf16_f32 v148, v148, v149
    v_cvt_pk_bf16_f32 v149, v150, v151
    v_mfma_f32_16x16x32_bf16 v[56:59], a[32:35], a[24:27], v[56:59]
    v_cvt_pk_bf16_f32 v150, v16, v17
    v_cvt_pk_bf16_f32 v151, v18, v19
    v_mfma_f32_16x16x32_bf16 v[60:63], a[32:35], a[28:31], v[60:63]
    ds_write_b128 v22, v[148:151] offset:4352
    v_mfma_f32_16x16x32_bf16 v[64:67], a[36:39], a[0:3], v[64:67]
    v_accvgpr_read_b32 v12, a152
    v_accvgpr_read_b32 v13, a153
    v_mfma_f32_16x16x32_bf16 v[68:71], a[36:39], a[4:7], v[68:71]
    v_accvgpr_read_b32 v14, a154
    v_accvgpr_read_b32 v15, a155
    v_mfma_f32_16x16x32_bf16 v[72:75], a[36:39], a[8:11], v[72:75]
    v_cvt_pk_bf16_f32 v152, v152, v153
    v_cvt_pk_bf16_f32 v153, v154, v155
    v_mfma_f32_16x16x32_bf16 v[76:79], a[36:39], a[12:15], v[76:79]
    v_cvt_pk_bf16_f32 v154, v12, v13
    v_cvt_pk_bf16_f32 v155, v14, v15
    v_mfma_f32_16x16x32_bf16 v[80:83], a[36:39], a[16:19], v[80:83]
    ds_write_b128 v22, v[152:155] offset:6144
    v_mfma_f32_16x16x32_bf16 v[84:87], a[36:39], a[20:23], v[84:87]
    v_accvgpr_read_b32 v16, a156
    v_accvgpr_read_b32 v17, a157
    v_mfma_f32_16x16x32_bf16 v[88:91], a[36:39], a[24:27], v[88:91]
    v_accvgpr_read_b32 v18, a158
    v_accvgpr_read_b32 v19, a159
    v_mfma_f32_16x16x32_bf16 v[92:95], a[36:39], a[28:31], v[92:95]
    v_cvt_pk_bf16_f32 v156, v156, v157
    v_cvt_pk_bf16_f32 v157, v158, v159
    v_mfma_f32_16x16x32_bf16 v[160:163], a[48:51], a[0:3], v[160:163]
    v_cvt_pk_bf16_f32 v158, v16, v17
    v_cvt_pk_bf16_f32 v159, v18, v19
    v_mfma_f32_16x16x32_bf16 v[164:167], a[48:51], a[4:7], v[164:167]
    ds_write_b128 v22, v[156:159] offset:6400
    v_mfma_f32_16x16x32_bf16 v[168:171], a[48:51], a[8:11], v[168:171]
    v_max_f32 v96, 0, v96
    v_max_f32 v97, 0, v97
    v_mfma_f32_16x16x32_bf16 v[172:175], a[48:51], a[12:15], v[172:175]
    v_max_f32 v98, 0, v98
    v_max_f32 v99, 0, v99
    v_mfma_f32_16x16x32_bf16 v[176:179], a[48:51], a[16:19], v[176:179]
    v_mul_f32 v96, v96, v224
    v_mul_f32 v97, v97, v225
    v_mfma_f32_16x16x32_bf16 v[180:183], a[48:51], a[20:23], v[180:183]
    v_mul_f32 v98, v98, v226
    v_mul_f32 v99, v99, v227
    v_mfma_f32_16x16x32_bf16 v[184:187], a[48:51], a[24:27], v[184:187]
    v_max_f32 v100, 0, v100
    v_max_f32 v101, 0, v101
    v_mfma_f32_16x16x32_bf16 v[188:191], a[48:51], a[28:31], v[188:191]
    v_max_f32 v102, 0, v102
    v_max_f32 v103, 0, v103
    v_mfma_f32_16x16x32_bf16 v[192:195], a[52:55], a[0:3], v[192:195]
    v_mul_f32 v100, v100, v228
    v_mul_f32 v101, v101, v229
    v_mfma_f32_16x16x32_bf16 v[196:199], a[52:55], a[4:7], v[196:199]
    v_mul_f32 v102, v102, v230
    v_mul_f32 v103, v103, v231
    v_mfma_f32_16x16x32_bf16 v[200:203], a[52:55], a[8:11], v[200:203]
    v_cvt_pk_bf16_f32 v96, v96, v97
    v_cvt_pk_bf16_f32 v97, v98, v99
    v_mfma_f32_16x16x32_bf16 v[204:207], a[52:55], a[12:15], v[204:207]
    v_cvt_pk_bf16_f32 v98, v100, v101
    v_cvt_pk_bf16_f32 v99, v102, v103
    v_mfma_f32_16x16x32_bf16 v[208:211], a[52:55], a[16:19], v[208:211]
    s_nop 1
    v_permlane16_swap_b32 v96, v98
    v_mfma_f32_16x16x32_bf16 v[212:215], a[52:55], a[20:23], v[212:215]
    v_permlane16_swap_b32 v97, v99
    v_mfma_f32_16x16x32_bf16 v[216:219], a[52:55], a[24:27], v[216:219]
    buffer_store_dwordx4 v[96:99], v21, s[24:27], s85 offen offset:0 sc1
    v_mfma_f32_16x16x32_bf16 v[220:223], a[52:55], a[28:31], v[220:223]
    v_max_f32 v104, 0, v104
    v_max_f32 v105, 0, v105
    v_mfma_f32_16x16x32_bf16 v[32:35], a[96:99], a[64:67], v[32:35]
    v_max_f32 v106, 0, v106
    v_max_f32 v107, 0, v107
    v_mfma_f32_16x16x32_bf16 v[160:163], a[112:115], a[64:67], v[160:163]
    v_mul_f32 v104, v104, v232
    v_mul_f32 v105, v105, v233
    v_mfma_f32_16x16x32_bf16 v[64:67], a[100:103], a[64:67], v[64:67]
    v_mul_f32 v106, v106, v234
    v_mul_f32 v107, v107, v235
    v_mfma_f32_16x16x32_bf16 v[192:195], a[116:119], a[64:67], v[192:195]
    v_max_f32 v108, 0, v108
    v_max_f32 v109, 0, v109
    v_mfma_f32_16x16x32_bf16 v[36:39], a[96:99], a[68:71], v[36:39]
    v_max_f32 v110, 0, v110
    v_max_f32 v111, 0, v111
    v_mfma_f32_16x16x32_bf16 v[164:167], a[112:115], a[68:71], v[164:167]
    v_mul_f32 v108, v108, v236
    v_mul_f32 v109, v109, v237
    v_mfma_f32_16x16x32_bf16 v[68:71], a[100:103], a[68:71], v[68:71]
    v_mul_f32 v110, v110, v238
    v_mul_f32 v111, v111, v239
    v_mfma_f32_16x16x32_bf16 v[196:199], a[116:119], a[68:71], v[196:199]
    v_cvt_pk_bf16_f32 v104, v104, v105
    v_cvt_pk_bf16_f32 v105, v106, v107
    v_mfma_f32_16x16x32_bf16 v[40:43], a[96:99], a[72:75], v[40:43]
    v_cvt_pk_bf16_f32 v106, v108, v109
    v_cvt_pk_bf16_f32 v107, v110, v111
    v_mfma_f32_16x16x32_bf16 v[168:171], a[112:115], a[72:75], v[168:171]
    s_nop 1
    v_permlane16_swap_b32 v104, v106
    v_mfma_f32_16x16x32_bf16 v[72:75], a[100:103], a[72:75], v[72:75]
    v_permlane16_swap_b32 v105, v107
    v_mfma_f32_16x16x32_bf16 v[200:203], a[116:119], a[72:75], v[200:203]
    buffer_store_dwordx4 v[104:107], v21, s[24:27], s85 offen offset:2048 sc1
    v_mfma_f32_16x16x32_bf16 v[44:47], a[96:99], a[76:79], v[44:47]
    v_max_f32 v112, 0, v112
    v_max_f32 v113, 0, v113
    v_mfma_f32_16x16x32_bf16 v[172:175], a[112:115], a[76:79], v[172:175]
    v_max_f32 v114, 0, v114
    v_max_f32 v115, 0, v115
    v_mfma_f32_16x16x32_bf16 v[76:79], a[100:103], a[76:79], v[76:79]
    v_mul_f32 v112, v112, v240
    v_mul_f32 v113, v113, v241
    v_mfma_f32_16x16x32_bf16 v[204:207], a[116:119], a[76:79], v[204:207]
    v_mul_f32 v114, v114, v242
    v_mul_f32 v115, v115, v243
    v_mfma_f32_16x16x32_bf16 v[48:51], a[96:99], a[80:83], v[48:51]
    v_max_f32 v116, 0, v116
    v_max_f32 v117, 0, v117
    v_mfma_f32_16x16x32_bf16 v[176:179], a[112:115], a[80:83], v[176:179]
    v_max_f32 v118, 0, v118
    v_max_f32 v119, 0, v119
    v_mfma_f32_16x16x32_bf16 v[80:83], a[100:103], a[80:83], v[80:83]
    v_mul_f32 v116, v116, v244
    v_mul_f32 v117, v117, v245
    v_mfma_f32_16x16x32_bf16 v[208:211], a[116:119], a[80:83], v[208:211]
    v_mul_f32 v118, v118, v246
    v_mul_f32 v119, v119, v247
    v_mfma_f32_16x16x32_bf16 v[52:55], a[96:99], a[84:87], v[52:55]
    v_cvt_pk_bf16_f32 v112, v112, v113
    v_cvt_pk_bf16_f32 v113, v114, v115
    v_mfma_f32_16x16x32_bf16 v[180:183], a[112:115], a[84:87], v[180:183]
    v_cvt_pk_bf16_f32 v114, v116, v117
    v_cvt_pk_bf16_f32 v115, v118, v119
    v_mfma_f32_16x16x32_bf16 v[84:87], a[100:103], a[84:87], v[84:87]
    s_nop 1
    v_permlane16_swap_b32 v112, v114
    v_mfma_f32_16x16x32_bf16 v[212:215], a[116:119], a[84:87], v[212:215]
    v_permlane16_swap_b32 v113, v115
    v_mfma_f32_16x16x32_bf16 v[56:59], a[96:99], a[88:91], v[56:59]
    buffer_store_dwordx4 v[112:115], v23, s[24:27], s85 offen offset:0 sc1
    v_mfma_f32_16x16x32_bf16 v[184:187], a[112:115], a[88:91], v[184:187]
    v_max_f32 v120, 0, v120
    v_max_f32 v121, 0, v121
    v_mfma_f32_16x16x32_bf16 v[88:91], a[100:103], a[88:91], v[88:91]
    v_max_f32 v122, 0, v122
    v_max_f32 v123, 0, v123
    v_mfma_f32_16x16x32_bf16 v[216:219], a[116:119], a[88:91], v[216:219]
    v_mul_f32 v120, v120, v248
    v_mul_f32 v121, v121, v249
    v_mfma_f32_16x16x32_bf16 v[60:63], a[96:99], a[92:95], v[60:63]
    v_mul_f32 v122, v122, v250
    v_mul_f32 v123, v123, v251
    v_mfma_f32_16x16x32_bf16 v[188:191], a[112:115], a[92:95], v[188:191]
    v_max_f32 v124, 0, v124
    v_max_f32 v125, 0, v125
    v_mfma_f32_16x16x32_bf16 v[92:95], a[100:103], a[92:95], v[92:95]
    v_max_f32 v126, 0, v126
    v_max_f32 v127, 0, v127
    v_mfma_f32_16x16x32_bf16 v[220:223], a[116:119], a[92:95], v[220:223]
    v_mul_f32 v124, v124, v252
    v_mul_f32 v125, v125, v253
    v_mul_f32 v126, v126, v254
    v_mul_f32 v127, v127, v255
    v_cvt_pk_bf16_f32 v120, v120, v121
    v_cvt_pk_bf16_f32 v121, v122, v123
    v_cvt_pk_bf16_f32 v122, v124, v125
    v_cvt_pk_bf16_f32 v123, v126, v127
    s_nop 1
    v_permlane16_swap_b32 v120, v122
    v_permlane16_swap_b32 v121, v123
    buffer_store_dwordx4 v[120:123], v23, s[24:27], s85 offen offset:2048 sc1
    v_max_f32 v32, 0, v32
    v_max_f32 v33, 0, v33
    v_max_f32 v34, 0, v34
    v_max_f32 v35, 0, v35
    v_pk_mul_f32 v[32:33], v[32:33], v[160:161]
    v_pk_mul_f32 v[34:35], v[34:35], v[162:163]
    v_max_f32 v64, 0, v64
    v_max_f32 v65, 0, v65
    v_max_f32 v66, 0, v66
    v_max_f32 v67, 0, v67
    v_pk_mul_f32 v[64:65], v[64:65], v[192:193]
    v_pk_mul_f32 v[66:67], v[66:67], v[194:195]
    v_cvt_pk_bf16_f32 v32, v32, v33
    v_cvt_pk_bf16_f32 v33, v34, v35
    v_cvt_pk_bf16_f32 v34, v64, v65
    v_cvt_pk_bf16_f32 v35, v66, v67
    buffer_store_dwordx4 v[32:35], v27, s[24:27], s82 offen offset:0 sc1
    v_max_f32 v36, 0, v36
    v_max_f32 v37, 0, v37
    v_max_f32 v38, 0, v38
    v_max_f32 v39, 0, v39
    v_pk_mul_f32 v[36:37], v[36:37], v[164:165]
    v_pk_mul_f32 v[38:39], v[38:39], v[166:167]
    v_max_f32 v68, 0, v68
    v_max_f32 v69, 0, v69
    v_max_f32 v70, 0, v70
    v_max_f32 v71, 0, v71
    v_pk_mul_f32 v[68:69], v[68:69], v[196:197]
    v_pk_mul_f32 v[70:71], v[70:71], v[198:199]
    v_cvt_pk_bf16_f32 v36, v36, v37
    v_cvt_pk_bf16_f32 v37, v38, v39
    v_cvt_pk_bf16_f32 v38, v68, v69
    v_cvt_pk_bf16_f32 v39, v70, v71
    buffer_store_dwordx4 v[36:39], v27, s[24:27], s82 offen offset:1024 sc1
    v_max_f32 v40, 0, v40
    v_max_f32 v41, 0, v41
    v_max_f32 v42, 0, v42
    v_max_f32 v43, 0, v43
    v_pk_mul_f32 v[40:41], v[40:41], v[168:169]
    v_pk_mul_f32 v[42:43], v[42:43], v[170:171]
    v_max_f32 v72, 0, v72
    v_max_f32 v73, 0, v73
    v_max_f32 v74, 0, v74
    v_max_f32 v75, 0, v75
    v_pk_mul_f32 v[72:73], v[72:73], v[200:201]
    v_pk_mul_f32 v[74:75], v[74:75], v[202:203]
    v_cvt_pk_bf16_f32 v40, v40, v41
    v_cvt_pk_bf16_f32 v41, v42, v43
    v_cvt_pk_bf16_f32 v42, v72, v73
    v_cvt_pk_bf16_f32 v43, v74, v75
    buffer_store_dwordx4 v[40:43], v27, s[24:27], s82 offen offset:2048 sc1
    v_max_f32 v44, 0, v44
    v_max_f32 v45, 0, v45
    v_max_f32 v46, 0, v46
    v_max_f32 v47, 0, v47
    v_pk_mul_f32 v[44:45], v[44:45], v[172:173]
    v_pk_mul_f32 v[46:47], v[46:47], v[174:175]
    v_max_f32 v76, 0, v76
    v_max_f32 v77, 0, v77
    v_max_f32 v78, 0, v78
    v_max_f32 v79, 0, v79
    v_pk_mul_f32 v[76:77], v[76:77], v[204:205]
    v_pk_mul_f32 v[78:79], v[78:79], v[206:207]
    v_cvt_pk_bf16_f32 v44, v44, v45
    v_cvt_pk_bf16_f32 v45, v46, v47
    v_cvt_pk_bf16_f32 v46, v76, v77
    v_cvt_pk_bf16_f32 v47, v78, v79
    buffer_store_dwordx4 v[44:47], v27, s[24:27], s82 offen offset:3072 sc1
    v_max_f32 v48, 0, v48
    v_max_f32 v49, 0, v49
    v_max_f32 v50, 0, v50
    v_max_f32 v51, 0, v51
    v_pk_mul_f32 v[48:49], v[48:49], v[176:177]
    v_pk_mul_f32 v[50:51], v[50:51], v[178:179]
    v_max_f32 v80, 0, v80
    v_max_f32 v81, 0, v81
    v_max_f32 v82, 0, v82
    v_max_f32 v83, 0, v83
    v_pk_mul_f32 v[80:81], v[80:81], v[208:209]
    v_pk_mul_f32 v[82:83], v[82:83], v[210:211]
    v_cvt_pk_bf16_f32 v48, v48, v49
    v_cvt_pk_bf16_f32 v49, v50, v51
    v_cvt_pk_bf16_f32 v50, v80, v81
    v_cvt_pk_bf16_f32 v51, v82, v83
    buffer_store_dwordx4 v[48:51], v30, s[24:27], s82 offen offset:0 sc1
    v_max_f32 v52, 0, v52
    v_max_f32 v53, 0, v53
    v_max_f32 v54, 0, v54
    v_max_f32 v55, 0, v55
    v_pk_mul_f32 v[52:53], v[52:53], v[180:181]
    v_pk_mul_f32 v[54:55], v[54:55], v[182:183]
    v_max_f32 v84, 0, v84
    v_max_f32 v85, 0, v85
    v_max_f32 v86, 0, v86
    v_max_f32 v87, 0, v87
    v_pk_mul_f32 v[84:85], v[84:85], v[212:213]
    v_pk_mul_f32 v[86:87], v[86:87], v[214:215]
    v_cvt_pk_bf16_f32 v52, v52, v53
    v_cvt_pk_bf16_f32 v53, v54, v55
    v_cvt_pk_bf16_f32 v54, v84, v85
    v_cvt_pk_bf16_f32 v55, v86, v87
    buffer_store_dwordx4 v[52:55], v30, s[24:27], s82 offen offset:1024 sc1
    v_max_f32 v56, 0, v56
    v_max_f32 v57, 0, v57
    v_max_f32 v58, 0, v58
    v_max_f32 v59, 0, v59
    v_pk_mul_f32 v[56:57], v[56:57], v[184:185]
    v_pk_mul_f32 v[58:59], v[58:59], v[186:187]
    v_max_f32 v88, 0, v88
    v_max_f32 v89, 0, v89
    v_max_f32 v90, 0, v90
    v_max_f32 v91, 0, v91
    v_pk_mul_f32 v[88:89], v[88:89], v[216:217]
    v_pk_mul_f32 v[90:91], v[90:91], v[218:219]
    v_cvt_pk_bf16_f32 v56, v56, v57
    v_cvt_pk_bf16_f32 v57, v58, v59
    v_cvt_pk_bf16_f32 v58, v88, v89
    v_cvt_pk_bf16_f32 v59, v90, v91
    buffer_store_dwordx4 v[56:59], v30, s[24:27], s82 offen offset:2048 sc1
    v_max_f32 v60, 0, v60
    v_max_f32 v61, 0, v61
    v_max_f32 v62, 0, v62
    v_max_f32 v63, 0, v63
    v_pk_mul_f32 v[60:61], v[60:61], v[188:189]
    v_pk_mul_f32 v[62:63], v[62:63], v[190:191]
    v_max_f32 v92, 0, v92
    v_max_f32 v93, 0, v93
    v_max_f32 v94, 0, v94
    v_max_f32 v95, 0, v95
    v_pk_mul_f32 v[92:93], v[92:93], v[220:221]
    v_pk_mul_f32 v[94:95], v[94:95], v[222:223]
    v_cvt_pk_bf16_f32 v60, v60, v61
    v_cvt_pk_bf16_f32 v61, v62, v63
    v_cvt_pk_bf16_f32 v62, v92, v93
    v_cvt_pk_bf16_f32 v63, v94, v95
    buffer_store_dwordx4 v[60:63], v30, s[24:27], s82 offen offset:3072 sc1
KM_P2:
    v_mov_b32 v16, v20
    v_mov_b32 v1, v27
    v_mov_b32 v2, v30
    v_mov_b32_e64 v3, v27
    s_lshl_b32 s80, s36, 12
    s_add_u32 s80, s80, 65536
    v_add_u32 v24, s80, v27
    s_waitcnt vmcnt(12)
    s_waitcnt lgkmcnt(0)
    s_barrier
    ds_read_b128 a[44:47], v24 offset:0
    ds_read_b128 a[48:51], v24 offset:1024
    ds_read_b128 a[52:55], v24 offset:2048
    ds_read_b128 a[56:59], v24 offset:3072
    ds_read_b128 a[60:63], v3 offset:0
    ds_read_b128 a[64:67], v3 offset:1024
    ds_read_b128 a[76:79], v3 offset:2048
    ds_read_b128 a[80:83], v3 offset:3072
    s_add_u32 s80, s36, 0
    s_and_b32 s80, s80, 3
    s_lshl_b32 s80, s80, 11
    v_add_u32 v4, s80, v1
    s_add_u32 s80, s36, 1
    s_and_b32 s80, s80, 3
    s_lshl_b32 s80, s80, 11
    v_add_u32 v5, s80, v1
    s_add_u32 s80, s36, 2
    s_and_b32 s80, s80, 3
    s_lshl_b32 s80, s80, 11
    v_add_u32 v6, s80, v1
    s_add_u32 s80, s36, 3
    s_and_b32 s80, s80, 3
    s_lshl_b32 s80, s80, 11
    v_add_u32_e64 v7, s80, v1
    s_waitcnt lgkmcnt(2)
    v_mfma_f32_32x32x16_bf16 v[32:47], a[60:63], a[44:47], 0
    v_mfma_f32_32x32x16_bf16 v[32:47], a[64:67], a[48:51], v[32:47]
    v_add_u32 v8, s31, v4
    v_add_u32 v12, s30, v4
    v_add_u32 v9, s31, v5
    v_add_u32 v13, s30, v5
    v_add_u32 v10, s31, v6
    v_add_u32 v14, s30, v6
    v_add_u32 v11, s31, v7
    v_add_u32 v15, s30, v7
    v_bfe_u32 v26, v16, 4, 1
    v_bfe_u32 v27, v16, 2, 1
    v_cmp_eq_u32 vcc, v26, v27
    v_mov_b32 v26, 0x3f803f80
    s_lshl_b32 s40, s28, 9
    s_add_u32 s40, s40, 0x1240000
    v_cndmask_b32 v26, 0, v26, vcc
    v_accvgpr_write_b32 a40, v26
    v_accvgpr_write_b32 a41, v26
    v_accvgpr_write_b32 a42, v26
    v_accvgpr_write_b32 a43, v26
    s_lshl_b32 s41, s37, 11
    s_lshl_b32 s80, s36, 9
    s_add_u32 s41, s41, s80
    s_add_u32 s41, s41, 0x1240000
    v_and_b32 v26, 31, v16
    v_lshlrev_b32 v26, 3, v26
    v_and_b32 v27, 15, v16
    v_lshlrev_b32 v27, 3, v27
    v_lshlrev_b32 v25, 7, v16
    v_mov_b32 v24, s89
    v_exp_f32 v32, v32
    v_exp_f32 v33, v33
    v_mfma_f32_32x32x16_bf16 v[48:63], a[60:63], a[52:55], 0
    ds_read_b128 a[68:71], v3 offset:4096
    ds_read_b128 a[72:75], v3 offset:5120
    v_exp_f32 v34, v34
    v_exp_f32 v35, v35
    v_mfma_f32_32x32x16_bf16 v[48:63], a[64:67], a[56:59], v[48:63]
    s_waitcnt lgkmcnt(0)
    v_cvt_pk_bf16_f32 v64, v32, v33
    v_exp_f32 v36, v36
    v_exp_f32_e64 v37, v37
    v_cvt_pk_bf16_f32 v65, v34, v35
    v_exp_f32 v38, v38
    v_exp_f32 v39, v39
    v_cvt_pk_bf16_f32 v66, v36, v37
    v_exp_f32 v40, v40
    v_exp_f32 v41, v41
    v_cvt_pk_bf16_f32 v67, v38, v39
    v_exp_f32 v42, v42
    v_exp_f32 v43, v43
    v_cvt_pk_bf16_f32 v68, v40, v41
    v_exp_f32 v44, v44
    v_exp_f32 v45, v45
    v_cvt_pk_bf16_f32 v69, v42, v43
    v_exp_f32 v46, v46
    v_exp_f32 v47, v47
    v_cvt_pk_bf16_f32 v70, v44, v45
    v_cvt_pk_bf16_f32 v71, v46, v47
    v_exp_f32 v48, v48
    v_exp_f32 v49, v49
    v_mfma_f32_32x32x16_bf16 v[32:47], a[68:71], a[44:47], 0
    v_exp_f32 v50, v50
    v_exp_f32 v51, v51
    v_cvt_pk_bf16_f32 v72, v48, v49
    v_exp_f32_e64 v52, v52
    v_mfma_f32_32x32x16_bf16 v[32:47], a[72:75], a[48:51], v[32:47]
    ds_read_b128 a[84:87], v3 offset:6144
    v_exp_f32_e64 v53, v53
    v_cvt_pk_bf16_f32 v73, v50, v51
    v_exp_f32_e64 v54, v54
    v_mfma_f32_32x32x16_bf16 v[96:111], a[76:79], v[64:67], 0
    v_exp_f32_e64 v55, v55
    v_cvt_pk_bf16_f32 v74, v52, v53
    v_exp_f32 v56, v56
    v_exp_f32 v57, v57
    v_mfma_f32_16x16x32_bf16 a[32:35], a[40:43], v[64:67], 0
    ds_read_b128 a[88:91], v3 offset:7168
    v_cvt_pk_bf16_f32 v75, v54, v55
    v_mfma_f32_32x32x16_bf16 v[96:111], a[80:83], v[68:71], v[96:111]
    v_exp_f32 v58, v58
    v_exp_f32 v59, v59
    v_cvt_pk_bf16_f32 v76, v56, v57
    v_exp_f32_e64 v60, v60
    v_mfma_f32_16x16x32_bf16 a[32:35], a[40:43], v[68:71], a[32:35]
    v_exp_f32_e64 v61, v61
    v_cvt_pk_bf16_f32 v77, v58, v59
    v_exp_f32 v62, v62
    v_exp_f32 v63, v63
    v_cvt_pk_bf16_f32 v78, v60, v61
    v_cvt_pk_bf16_f32 v79, v62, v63
    v_exp_f32 v32, v32
    v_exp_f32 v33, v33
    v_mfma_f32_32x32x16_bf16 v[48:63], a[68:71], a[52:55], 0
    v_exp_f32 v34, v34
    v_exp_f32 v35, v35
    v_cvt_pk_bf16_f32 v64, v32, v33
    v_exp_f32_e64 v36, v36
    v_mfma_f32_32x32x16_bf16 v[48:63], a[72:75], a[56:59], v[48:63]
    ds_read_b128 a[60:63], v3 offset:8192
    v_exp_f32_e64 v37, v37
    v_cvt_pk_bf16_f32 v65, v34, v35
    v_exp_f32_e64 v38, v38
    v_mfma_f32_32x32x16_bf16 v[112:127], a[76:79], v[72:75], 0
    v_exp_f32_e64 v39, v39
    v_cvt_pk_bf16_f32 v66, v36, v37
    v_exp_f32 v40, v40
    v_exp_f32 v41, v41
    v_mfma_f32_16x16x32_bf16 a[36:39], a[40:43], v[72:75], 0
    ds_read_b128 a[64:67], v3 offset:9216
    v_cvt_pk_bf16_f32 v67, v38, v39
    v_mfma_f32_32x32x16_bf16 v[112:127], a[80:83], v[76:79], v[112:127]
    v_exp_f32 v42, v42
    v_exp_f32 v43, v43
    v_cvt_pk_bf16_f32 v68, v40, v41
    v_exp_f32_e64 v44, v44
    v_mfma_f32_16x16x32_bf16 a[36:39], a[40:43], v[76:79], a[36:39]
    s_waitcnt lgkmcnt(0)
    v_exp_f32 v45, v45
    v_cvt_pk_bf16_f32 v69, v42, v43
    v_exp_f32 v46, v46
    v_exp_f32 v47, v47
    v_cvt_pk_bf16_f32 v70, v44, v45
    v_cvt_pk_bf16_f32 v71, v46, v47
    v_exp_f32 v48, v48
    v_exp_f32 v49, v49
    v_mfma_f32_32x32x16_bf16 v[32:47], a[60:63], a[44:47], 0
    v_exp_f32 v50, v50
    v_exp_f32 v51, v51
    v_cvt_pk_bf16_f32 v72, v48, v49
    v_exp_f32_e64 v52, v52
    v_mfma_f32_32x32x16_bf16 v[32:47], a[64:67], a[48:51], v[32:47]
    ds_read_b128 a[76:79], v3 offset:10240
    v_exp_f32_e64 v53, v53
    v_cvt_pk_bf16_f32 v73, v50, v51
    v_exp_f32_e64 v54, v54
    v_mfma_f32_32x32x16_bf16 v[96:111], a[84:87], v[64:67], v[96:111]
    v_exp_f32_e64 v55, v55
    v_cvt_pk_bf16_f32 v74, v52, v53
    v_exp_f32 v56, v56
    v_exp_f32 v57, v57
    v_mfma_f32_16x16x32_bf16 a[32:35], a[40:43], v[64:67], a[32:35]
    ds_read_b128 a[80:83], v3 offset:11264
    v_cvt_pk_bf16_f32 v75, v54, v55
    v_mfma_f32_32x32x16_bf16 v[96:111], a[88:91], v[68:71], v[96:111]
    v_exp_f32 v58, v58
    v_exp_f32 v59, v59
    v_cvt_pk_bf16_f32 v76, v56, v57
    v_exp_f32_e64 v60, v60
    v_mfma_f32_16x16x32_bf16 a[32:35], a[40:43], v[68:71], a[32:35]
    v_exp_f32_e64 v61, v61
    v_cvt_pk_bf16_f32 v77, v58, v59
    v_exp_f32 v62, v62
    v_exp_f32 v63, v63
    v_cvt_pk_bf16_f32 v78, v60, v61
    v_cvt_pk_bf16_f32 v79, v62, v63
    v_exp_f32 v32, v32
    v_exp_f32 v33, v33
    v_mfma_f32_32x32x16_bf16 v[48:63], a[60:63], a[52:55], 0
    v_exp_f32 v34, v34
    v_exp_f32 v35, v35
    v_cvt_pk_bf16_f32 v64, v32, v33
    v_exp_f32_e64 v36, v36
    v_mfma_f32_32x32x16_bf16 v[48:63], a[64:67], a[56:59], v[48:63]
    ds_read_b128 a[68:71], v3 offset:12288
    v_exp_f32_e64 v37, v37
    v_cvt_pk_bf16_f32 v65, v34, v35
    v_exp_f32_e64 v38, v38
    v_mfma_f32_32x32x16_bf16 v[112:127], a[84:87], v[72:75], v[112:127]
    v_exp_f32_e64 v39, v39
    v_cvt_pk_bf16_f32 v66, v36, v37
    v_exp_f32 v40, v40
    v_exp_f32 v41, v41
    v_mfma_f32_16x16x32_bf16 a[36:39], a[40:43], v[72:75], a[36:39]
    ds_read_b128 a[72:75], v3 offset:13312
    v_cvt_pk_bf16_f32 v67, v38, v39
    v_mfma_f32_32x32x16_bf16 v[112:127], a[88:91], v[76:79], v[112:127]
    v_exp_f32 v42, v42
    v_exp_f32 v43, v43
    v_cvt_pk_bf16_f32 v68, v40, v41
    v_exp_f32_e64 v44, v44
    v_mfma_f32_16x16x32_bf16 a[36:39], a[40:43], v[76:79], a[36:39]
    s_waitcnt lgkmcnt(0)
    v_exp_f32 v45, v45
    v_cvt_pk_bf16_f32 v69, v42, v43
    v_exp_f32 v46, v46
    v_exp_f32 v47, v47
    v_cvt_pk_bf16_f32 v70, v44, v45
    v_cvt_pk_bf16_f32 v71, v46, v47
    v_exp_f32 v48, v48
    v_exp_f32 v49, v49
    v_mfma_f32_32x32x16_bf16 v[32:47], a[68:71], a[44:47], 0
    v_exp_f32 v50, v50
    v_exp_f32 v51, v51
    v_cvt_pk_bf16_f32 v72, v48, v49
    v_exp_f32_e64 v52, v52
    v_mfma_f32_32x32x16_bf16 v[32:47], a[72:75], a[48:51], v[32:47]
    ds_read_b128 a[84:87], v3 offset:14336
    v_exp_f32_e64 v53, v53
    v_cvt_pk_bf16_f32 v73, v50, v51
    v_exp_f32_e64 v54, v54
    v_mfma_f32_32x32x16_bf16 v[96:111], a[76:79], v[64:67], v[96:111]
    s_waitcnt vmcnt(0)
    s_barrier
    s_mov_b64 exec, 1
    buffer_store_dword v24, off, s[24:27], s8 sc1
    s_mov_b64 exec, -1
    v_mfma_f32_16x16x32_bf16 a[32:35], a[40:43], v[64:67], a[32:35]
    ds_read_b128 a[88:91], v3 offset:15360
    v_exp_f32_e64 v55, v55
    v_mfma_f32_32x32x16_bf16 v[96:111], a[80:83], v[68:71], v[96:111]
    v_cvt_pk_bf16_f32 v74, v52, v53
    v_exp_f32 v56, v56
    v_exp_f32 v57, v57
    v_cvt_pk_bf16_f32 v75, v54, v55
    v_mfma_f32_16x16x32_bf16 a[32:35], a[40:43], v[68:71], a[32:35]
    v_exp_f32 v58, v58
    v_exp_f32 v59, v59
    v_cvt_pk_bf16_f32 v76, v56, v57
    v_exp_f32 v60, v60
    v_exp_f32 v61, v61
    v_cvt_pk_bf16_f32 v77, v58, v59
    v_exp_f32 v62, v62
    v_exp_f32 v63, v63
    v_cvt_pk_bf16_f32 v78, v60, v61
    v_cvt_pk_bf16_f32 v79, v62, v63
    v_exp_f32 v32, v32
    v_exp_f32 v33, v33
    v_mfma_f32_32x32x16_bf16 v[48:63], a[68:71], a[52:55], 0
    v_exp_f32 v34, v34
    v_exp_f32 v35, v35
    v_cvt_pk_bf16_f32 v64, v32, v33
    v_exp_f32_e64 v36, v36
    v_mfma_f32_32x32x16_bf16 v[48:63], a[72:75], a[56:59], v[48:63]
    ds_read_b128 a[60:63], v3 offset:16384
    v_exp_f32_e64 v37, v37
    v_cvt_pk_bf16_f32 v65, v34, v35
    v_exp_f32_e64 v38, v38
    v_mfma_f32_32x32x16_bf16 v[112:127], a[76:79], v[72:75], v[112:127]
    v_exp_f32_e64 v39, v39
    v_cvt_pk_bf16_f32 v66, v36, v37
    v_exp_f32 v40, v40
    v_exp_f32 v41, v41
    v_mfma_f32_16x16x32_bf16 a[36:39], a[40:43], v[72:75], a[36:39]
    ds_read_b128 a[64:67], v3 offset:17408
    v_cvt_pk_bf16_f32 v67, v38, v39
    v_mfma_f32_32x32x16_bf16 v[112:127], a[80:83], v[76:79], v[112:127]
    v_exp_f32 v42, v42
    v_exp_f32 v43, v43
    v_cvt_pk_bf16_f32 v68, v40, v41
    v_exp_f32_e64 v44, v44
    v_mfma_f32_16x16x32_bf16 a[36:39], a[40:43], v[76:79], a[36:39]
    s_waitcnt lgkmcnt(0)
    v_exp_f32 v45, v45
    v_cvt_pk_bf16_f32 v69, v42, v43
    v_exp_f32 v46, v46
    v_exp_f32 v47, v47
    v_cvt_pk_bf16_f32 v70, v44, v45
    v_cvt_pk_bf16_f32 v71, v46, v47
    v_exp_f32 v48, v48
    v_exp_f32 v49, v49
    v_mfma_f32_32x32x16_bf16 v[32:47], a[60:63], a[44:47], 0
    v_exp_f32 v50, v50
    v_exp_f32 v51, v51
    v_cvt_pk_bf16_f32 v72, v48, v49
    v_exp_f32_e64 v52, v52
    v_mfma_f32_32x32x16_bf16 v[32:47], a[64:67], a[48:51], v[32:47]
    ds_read_b128 a[76:79], v3 offset:18432
    v_exp_f32_e64 v53, v53
    v_cvt_pk_bf16_f32 v73, v50, v51
    v_exp_f32_e64 v54, v54
    v_mfma_f32_32x32x16_bf16 v[96:111], a[84:87], v[64:67], v[96:111]
    s_add_u32 m0, s34, 0
    v_exp_f32 v55, v55
    v_cvt_pk_bf16_f32 v74, v52, v53
    v_exp_f32 v56, v56
    v_exp_f32 v57, v57
    v_mfma_f32_16x16x32_bf16 a[32:35], a[40:43], v[64:67], a[32:35]
    ds_read_b128 a[80:83], v3 offset:19456
    v_cvt_pk_bf16_f32 v75, v54, v55
    v_mfma_f32_32x32x16_bf16 v[96:111], a[88:91], v[68:71], v[96:111]
    global_load_lds_dwordx4 v1, s[16:17] offset:0 sc1
    v_exp_f32 v58, v58
    v_exp_f32 v59, v59
    v_cvt_pk_bf16_f32 v76, v56, v57
    v_mfma_f32_16x16x32_bf16 a[32:35], a[40:43], v[68:71], a[32:35]
    v_exp_f32 v60, v60
    v_exp_f32 v61, v61
    v_cvt_pk_bf16_f32 v77, v58, v59
    v_exp_f32 v62, v62
    v_exp_f32 v63, v63
    v_cvt_pk_bf16_f32 v78, v60, v61
    v_cvt_pk_bf16_f32 v79, v62, v63
    v_exp_f32 v32, v32
    v_exp_f32 v33, v33
    v_mfma_f32_32x32x16_bf16 v[48:63], a[60:63], a[52:55], 0
    global_load_lds_dwordx4 v1, s[16:17] offset:1024 sc1
    v_exp_f32 v34, v34
    v_exp_f32 v35, v35
    v_cvt_pk_bf16_f32 v64, v32, v33
    v_mfma_f32_32x32x16_bf16 v[48:63], a[64:67], a[56:59], v[48:63]
    ds_read_b128 a[68:71], v3 offset:20480
    v_exp_f32 v36, v36
    v_exp_f32 v37, v37
    v_cvt_pk_bf16_f32 v65, v34, v35
    v_mfma_f32_32x32x16_bf16 v[112:127], a[84:87], v[72:75], v[112:127]
    global_load_lds_dwordx4 v1, s[16:17] offset:2048 sc1
    v_exp_f32 v38, v38
    v_exp_f32 v39, v39
    v_cvt_pk_bf16_f32 v66, v36, v37
    v_mfma_f32_16x16x32_bf16 a[36:39], a[40:43], v[72:75], a[36:39]
    ds_read_b128 a[72:75], v3 offset:21504
    v_exp_f32_e64 v40, v40
    v_mfma_f32_32x32x16_bf16 v[112:127], a[88:91], v[76:79], v[112:127]
    global_load_lds_dwordx4 v1, s[16:17] offset:3072 sc1
    v_exp_f32_e64 v41, v41
    v_cvt_pk_bf16_f32 v67, v38, v39
    v_exp_f32_e64 v42, v42
    v_mfma_f32_16x16x32_bf16 a[36:39], a[40:43], v[76:79], a[36:39]
    s_waitcnt lgkmcnt(0)
    v_exp_f32 v43, v43
    v_cvt_pk_bf16_f32 v68, v40, v41
    v_exp_f32 v44, v44
    v_exp_f32 v45, v45
    v_cvt_pk_bf16_f32 v69, v42, v43
    v_exp_f32 v46, v46
    v_exp_f32 v47, v47
    v_cvt_pk_bf16_f32 v70, v44, v45
    v_cvt_pk_bf16_f32 v71, v46, v47
    v_exp_f32 v48, v48
    v_exp_f32 v49, v49
    v_mfma_f32_32x32x16_bf16 v[32:47], a[68:71], a[44:47], 0
    v_exp_f32 v50, v50
    v_exp_f32 v51, v51
    v_cvt_pk_bf16_f32 v72, v48, v49
    v_exp_f32_e64 v52, v52
    v_mfma_f32_32x32x16_bf16 v[32:47], a[72:75], a[48:51], v[32:47]
    ds_read_b128 a[84:87], v3 offset:22528
    v_exp_f32_e64 v53, v53
    v_cvt_pk_bf16_f32 v73, v50, v51
    v_exp_f32_e64 v54, v54
    v_mfma_f32_32x32x16_bf16 v[96:111], a[76:79], v[64:67], v[96:111]
    v_exp_f32_e64 v55, v55
    v_cvt_pk_bf16_f32 v74, v52, v53
    v_exp_f32 v56, v56
    v_exp_f32 v57, v57
    v_mfma_f32_16x16x32_bf16 a[32:35], a[40:43], v[64:67], a[32:35]
    ds_read_b128 a[88:91], v3 offset:23552
    v_cvt_pk_bf16_f32 v75, v54, v55
    v_mfma_f32_32x32x16_bf16 v[96:111], a[80:83], v[68:71], v[96:111]
    v_exp_f32 v58, v58
    v_exp_f32 v59, v59
    v_cvt_pk_bf16_f32 v76, v56, v57
    v_exp_f32_e64 v60, v60
    v_mfma_f32_16x16x32_bf16 a[32:35], a[40:43], v[68:71], a[32:35]
    v_exp_f32_e64 v61, v61
    v_cvt_pk_bf16_f32 v77, v58, v59
    v_exp_f32 v62, v62
    v_exp_f32 v63, v63
    v_cvt_pk_bf16_f32 v78, v60, v61
    v_cvt_pk_bf16_f32 v79, v62, v63
    v_exp_f32 v32, v32
    v_exp_f32 v33, v33
    v_mfma_f32_32x32x16_bf16 v[48:63], a[68:71], a[52:55], 0
    v_exp_f32 v34, v34
    v_exp_f32 v35, v35
    v_cvt_pk_bf16_f32 v64, v32, v33
    v_exp_f32_e64 v36, v36
    v_mfma_f32_32x32x16_bf16 v[48:63], a[72:75], a[56:59], v[48:63]
    ds_read_b128 a[60:63], v3 offset:24576
    v_exp_f32_e64 v37, v37
    v_cvt_pk_bf16_f32 v65, v34, v35
    v_exp_f32_e64 v38, v38
    v_mfma_f32_32x32x16_bf16 v[112:127], a[76:79], v[72:75], v[112:127]
    s_add_u32 m0, s34, 4096
    v_exp_f32_e64 v39, v39
    v_cvt_pk_bf16_f32 v66, v36, v37
    v_exp_f32 v40, v40
    v_exp_f32 v41, v41
    v_mfma_f32_16x16x32_bf16 a[36:39], a[40:43], v[72:75], a[36:39]
    ds_read_b128 a[64:67], v3 offset:25600
    v_cvt_pk_bf16_f32 v67, v38, v39
    v_mfma_f32_32x32x16_bf16 v[112:127], a[80:83], v[76:79], v[112:127]
    global_load_lds_dwordx4 v2, s[16:17] offset:0 sc1
    v_exp_f32 v42, v42
    v_exp_f32 v43, v43
    v_cvt_pk_bf16_f32 v68, v40, v41
    v_mfma_f32_16x16x32_bf16 a[36:39], a[40:43], v[76:79], a[36:39]
    s_waitcnt lgkmcnt(0)
    v_exp_f32 v44, v44
    v_exp_f32_e64 v45, v45
    v_cvt_pk_bf16_f32 v69, v42, v43
    v_exp_f32 v46, v46
    v_exp_f32 v47, v47
    v_cvt_pk_bf16_f32 v70, v44, v45
    v_cvt_pk_bf16_f32 v71, v46, v47
    v_exp_f32 v48, v48
    v_exp_f32 v49, v49
    v_mfma_f32_32x32x16_bf16 v[32:47], a[60:63], a[44:47], 0
    global_load_lds_dwordx4 v2, s[16:17] offset:1024 sc1
    v_exp_f32 v50, v50
    v_exp_f32 v51, v51
    v_cvt_pk_bf16_f32 v72, v48, v49
    v_mfma_f32_32x32x16_bf16 v[32:47], a[64:67], a[48:51], v[32:47]
    ds_read_b128 a[76:79], v3 offset:26624
    v_exp_f32 v52, v52
    v_exp_f32 v53, v53
    v_cvt_pk_bf16_f32 v73, v50, v51
    v_mfma_f32_32x32x16_bf16 v[96:111], a[84:87], v[64:67], v[96:111]
    global_load_lds_dwordx4 v2, s[16:17] offset:2048 sc1
    v_exp_f32 v54, v54
    v_exp_f32 v55, v55
    v_cvt_pk_bf16_f32 v74, v52, v53
    v_mfma_f32_16x16x32_bf16 a[32:35], a[40:43], v[64:67], a[32:35]
    ds_read_b128 a[80:83], v3 offset:27648
    v_exp_f32_e64 v56, v56
    v_mfma_f32_32x32x16_bf16 v[96:111], a[88:91], v[68:71], v[96:111]
    global_load_lds_dwordx4 v2, s[16:17] offset:3072 sc1
    v_exp_f32_e64 v57, v57
    v_cvt_pk_bf16_f32 v75, v54, v55
    v_exp_f32_e64 v58, v58
    v_mfma_f32_16x16x32_bf16 a[32:35], a[40:43], v[68:71], a[32:35]
    s_add_u32 s16, s16, 0x8000
    s_addc_u32 s17, s17, 0
    v_exp_f32 v59, v59
    v_cvt_pk_bf16_f32 v76, v56, v57
    v_exp_f32 v60, v60
    v_exp_f32 v61, v61
    v_cvt_pk_bf16_f32 v77, v58, v59
    v_exp_f32 v62, v62
    v_exp_f32 v63, v63
    v_cvt_pk_bf16_f32 v78, v60, v61
    v_cvt_pk_bf16_f32 v79, v62, v63
    v_exp_f32 v32, v32
    v_exp_f32 v33, v33
    v_mfma_f32_32x32x16_bf16 v[48:63], a[60:63], a[52:55], 0
    s_xor_b32 s34, s34, 0x8000
    v_exp_f32 v34, v34
    v_exp_f32 v35, v35
    v_cvt_pk_bf16_f32 v64, v32, v33
    v_exp_f32_e64 v36, v36
    v_mfma_f32_32x32x16_bf16 v[48:63], a[64:67], a[56:59], v[48:63]
    ds_read_b128 a[68:71], v3 offset:28672
    v_exp_f32_e64 v37, v37
    v_cvt_pk_bf16_f32 v65, v34, v35
    v_exp_f32_e64 v38, v38
    v_mfma_f32_32x32x16_bf16 v[112:127], a[84:87], v[72:75], v[112:127]
    v_exp_f32_e64 v39, v39
    v_cvt_pk_bf16_f32 v66, v36, v37
    v_exp_f32 v40, v40
    v_exp_f32 v41, v41
    v_mfma_f32_16x16x32_bf16 a[36:39], a[40:43], v[72:75], a[36:39]
    ds_read_b128 a[72:75], v3 offset:29696
    v_cvt_pk_bf16_f32 v67, v38, v39
    v_mfma_f32_32x32x16_bf16 v[112:127], a[88:91], v[76:79], v[112:127]
    v_exp_f32 v42, v42
    v_exp_f32 v43, v43
    v_cvt_pk_bf16_f32 v68, v40, v41
    v_exp_f32_e64 v44, v44
    v_mfma_f32_16x16x32_bf16 a[36:39], a[40:43], v[76:79], a[36:39]
    s_waitcnt lgkmcnt(0)
    v_exp_f32 v45, v45
    v_cvt_pk_bf16_f32 v69, v42, v43
    v_exp_f32 v46, v46
    v_exp_f32 v47, v47
    v_cvt_pk_bf16_f32 v70, v44, v45
    v_cvt_pk_bf16_f32 v71, v46, v47
    v_exp_f32 v48, v48
    v_exp_f32 v49, v49
    v_mfma_f32_32x32x16_bf16 v[32:47], a[68:71], a[44:47], 0
    v_exp_f32 v50, v50
    v_exp_f32 v51, v51
    v_cvt_pk_bf16_f32 v72, v48, v49
    v_exp_f32_e64 v52, v52
    v_mfma_f32_32x32x16_bf16 v[32:47], a[72:75], a[48:51], v[32:47]
    ds_read_b128 a[84:87], v3 offset:30720
    v_exp_f32_e64 v53, v53
    v_cvt_pk_bf16_f32 v73, v50, v51
    v_exp_f32_e64 v54, v54
    v_mfma_f32_32x32x16_bf16 v[96:111], a[76:79], v[64:67], v[96:111]
    v_exp_f32_e64 v55, v55
    v_cvt_pk_bf16_f32 v74, v52, v53
    v_exp_f32 v56, v56
    v_exp_f32 v57, v57
    v_mfma_f32_16x16x32_bf16 a[32:35], a[40:43], v[64:67], a[32:35]
    ds_read_b128 a[88:91], v3 offset:31744
    v_cvt_pk_bf16_f32 v75, v54, v55
    v_mfma_f32_32x32x16_bf16 v[96:111], a[80:83], v[68:71], v[96:111]
    v_exp_f32 v58, v58
    v_exp_f32 v59, v59
    v_cvt_pk_bf16_f32 v76, v56, v57
    v_exp_f32_e64 v60, v60
    v_mfma_f32_16x16x32_bf16 a[32:35], a[40:43], v[68:71], a[32:35]
    v_exp_f32_e64 v61, v61
    v_cvt_pk_bf16_f32 v77, v58, v59
    v_exp_f32 v62, v62
    v_exp_f32 v63, v63
    v_cvt_pk_bf16_f32 v78, v60, v61
    v_cvt_pk_bf16_f32 v79, v62, v63
    v_exp_f32 v32, v32
    v_exp_f32 v33, v33
    v_mfma_f32_32x32x16_bf16 v[48:63], a[68:71], a[52:55], 0
    s_waitcnt vmcnt(0) lgkmcnt(0)
    s_barrier
    v_xor_b32 v3, 0x8000, v3
    v_exp_f32 v34, v34
    v_exp_f32 v35, v35
    v_mfma_f32_32x32x16_bf16 v[48:63], a[72:75], a[56:59], v[48:63]
    v_cvt_pk_bf16_f32 v64, v32, v33
    v_exp_f32 v36, v36
    v_exp_f32 v37, v37
    v_cvt_pk_bf16_f32 v65, v34, v35
    v_mfma_f32_32x32x16_bf16 v[112:127], a[76:79], v[72:75], v[112:127]
    ds_read_b128 a[60:63], v3 offset:0
    v_exp_f32 v38, v38
    v_exp_f32 v39, v39
    v_cvt_pk_bf16_f32 v66, v36, v37
    v_mfma_f32_16x16x32_bf16 a[36:39], a[40:43], v[72:75], a[36:39]
    v_exp_f32_e64 v40, v40
    v_mfma_f32_32x32x16_bf16 v[112:127], a[80:83], v[76:79], v[112:127]
    ds_read_b128 a[64:67], v3 offset:1024
    v_exp_f32_e64 v41, v41
    v_cvt_pk_bf16_f32 v67, v38, v39
    v_exp_f32_e64 v42, v42
    v_mfma_f32_16x16x32_bf16 a[36:39], a[40:43], v[76:79], a[36:39]
    s_waitcnt lgkmcnt(0)
    v_exp_f32 v43, v43
    v_cvt_pk_bf16_f32 v68, v40, v41
    v_exp_f32 v44, v44
    v_exp_f32 v45, v45
    v_cvt_pk_bf16_f32 v69, v42, v43
    v_exp_f32 v46, v46
    v_exp_f32 v47, v47
    v_cvt_pk_bf16_f32 v70, v44, v45
    v_cvt_pk_bf16_f32 v71, v46, v47
    v_exp_f32 v48, v48
    v_exp_f32 v49, v49
    v_mfma_f32_32x32x16_bf16 v[32:47], a[60:63], a[44:47], 0
    v_exp_f32 v50, v50
    v_exp_f32 v51, v51
    v_cvt_pk_bf16_f32 v72, v48, v49
    v_exp_f32_e64 v52, v52
    v_mfma_f32_32x32x16_bf16 v[32:47], a[64:67], a[48:51], v[32:47]
    ds_read_b128 a[76:79], v3 offset:2048
    v_exp_f32_e64 v53, v53
    v_cvt_pk_bf16_f32 v73, v50, v51
    v_exp_f32_e64 v54, v54
    v_mfma_f32_32x32x16_bf16 v[96:111], a[84:87], v[64:67], v[96:111]
    v_exp_f32_e64 v55, v55
    v_cvt_pk_bf16_f32 v74, v52, v53
    v_exp_f32 v56, v56
    v_exp_f32 v57, v57
    v_mfma_f32_16x16x32_bf16 a[32:35], a[40:43], v[64:67], a[32:35]
    ds_read_b128 a[80:83], v3 offset:3072
    v_cvt_pk_bf16_f32 v75, v54, v55
    v_mfma_f32_32x32x16_bf16 v[96:111], a[88:91], v[68:71], v[96:111]
    v_exp_f32 v58, v58
    v_exp_f32 v59, v59
    v_cvt_pk_bf16_f32 v76, v56, v57
    v_exp_f32_e64 v60, v60
    v_mfma_f32_16x16x32_bf16 a[32:35], a[40:43], v[68:71], a[32:35]
    v_exp_f32_e64 v61, v61
    v_cvt_pk_bf16_f32 v77, v58, v59
    v_exp_f32 v62, v62
    v_exp_f32 v63, v63
    v_cvt_pk_bf16_f32 v78, v60, v61
    v_cvt_pk_bf16_f32 v79, v62, v63
    v_exp_f32 v32, v32
    v_exp_f32 v33, v33
    v_mfma_f32_32x32x16_bf16 v[48:63], a[60:63], a[52:55], 0
    v_exp_f32 v34, v34
    v_exp_f32 v35, v35
    v_cvt_pk_bf16_f32 v64, v32, v33
    v_exp_f32_e64 v36, v36
    v_mfma_f32_32x32x16_bf16 v[48:63], a[64:67], a[56:59], v[48:63]
    ds_read_b128 a[68:71], v3 offset:4096
    v_exp_f32_e64 v37, v37
    v_cvt_pk_bf16_f32 v65, v34, v35
    v_exp_f32_e64 v38, v38
    v_mfma_f32_32x32x16_bf16 v[112:127], a[84:87], v[72:75], v[112:127]
    buffer_load_dword v28, v25, s[24:27], s9 offen sc1
    v_exp_f32_e64 v39, v39
    v_cvt_pk_bf16_f32 v66, v36, v37
    v_exp_f32_e64 v40, v40
    v_mfma_f32_16x16x32_bf16 a[36:39], a[40:43], v[72:75], a[36:39]
    ds_read_b128 a[72:75], v3 offset:5120
    v_exp_f32_e64 v41, v41
    v_mfma_f32_32x32x16_bf16 v[112:127], a[88:91], v[76:79], v[112:127]
    v_cvt_pk_bf16_f32 v67, v38, v39
    v_exp_f32 v42, v42
    v_exp_f32 v43, v43
    v_cvt_pk_bf16_f32 v68, v40, v41
    v_mfma_f32_16x16x32_bf16 a[36:39], a[40:43], v[76:79], a[36:39]
    s_waitcnt lgkmcnt(0)
    v_exp_f32 v44, v44
    v_exp_f32_e64 v45, v45
    v_cvt_pk_bf16_f32 v69, v42, v43
    v_exp_f32 v46, v46
    v_exp_f32 v47, v47
    v_cvt_pk_bf16_f32 v70, v44, v45
    v_cvt_pk_bf16_f32 v71, v46, v47
    v_exp_f32 v48, v48
    v_exp_f32 v49, v49
    v_mfma_f32_32x32x16_bf16 v[32:47], a[68:71], a[44:47], 0
    v_exp_f32 v50, v50
    v_exp_f32 v51, v51
    v_cvt_pk_bf16_f32 v72, v48, v49
    v_exp_f32_e64 v52, v52
    v_mfma_f32_32x32x16_bf16 v[32:47], a[72:75], a[48:51], v[32:47]
    ds_read_b128 a[84:87], v3 offset:6144
    v_exp_f32_e64 v53, v53
    v_cvt_pk_bf16_f32 v73, v50, v51
    v_exp_f32_e64 v54, v54
    v_mfma_f32_32x32x16_bf16 v[96:111], a[76:79], v[64:67], v[96:111]
    v_exp_f32_e64 v55, v55
    v_cvt_pk_bf16_f32 v74, v52, v53
    v_exp_f32 v56, v56
    v_exp_f32 v57, v57
    v_mfma_f32_16x16x32_bf16 a[32:35], a[40:43], v[64:67], a[32:35]
    ds_read_b128 a[88:91], v3 offset:7168
    v_cvt_pk_bf16_f32 v75, v54, v55
    v_mfma_f32_32x32x16_bf16 v[96:111], a[80:83], v[68:71], v[96:111]
    v_exp_f32 v58, v58
    v_exp_f32 v59, v59
    v_cvt_pk_bf16_f32 v76, v56, v57
    v_exp_f32_e64 v60, v60
    v_mfma_f32_16x16x32_bf16 a[32:35], a[40:43], v[68:71], a[32:35]
    v_exp_f32_e64 v61, v61
    v_cvt_pk_bf16_f32 v77, v58, v59
    v_exp_f32 v62, v62
    v_exp_f32 v63, v63
    v_cvt_pk_bf16_f32 v78, v60, v61
    v_cvt_pk_bf16_f32 v79, v62, v63
    v_exp_f32 v32, v32
    v_exp_f32 v33, v33
    v_mfma_f32_32x32x16_bf16 v[48:63], a[68:71], a[52:55], 0
    v_exp_f32 v34, v34
    v_exp_f32 v35, v35
    v_cvt_pk_bf16_f32 v64, v32, v33
    v_exp_f32_e64 v36, v36
    v_mfma_f32_32x32x16_bf16 v[48:63], a[72:75], a[56:59], v[48:63]
    ds_read_b128 a[60:63], v3 offset:8192
    v_exp_f32_e64 v37, v37
    v_cvt_pk_bf16_f32 v65, v34, v35
    v_exp_f32_e64 v38, v38
    v_mfma_f32_32x32x16_bf16 v[112:127], a[76:79], v[72:75], v[112:127]
    s_waitcnt vmcnt(0)
    v_cmp_ne_u32 vcc, s89, v28
    s_nop 0
    s_cbranch_vccnz KM_HSPIN
KM_HBACK:
    s_barrier
    global_load_dwordx4 a[156:159], v1, s[58:59] offset:0 sc1
    global_load_dwordx4 a[160:163], v1, s[58:59] offset:1024 sc1
    global_load_dwordx4 a[164:167], v1, s[58:59] offset:2048 sc1
    global_load_dwordx4 a[168:171], v1, s[58:59] offset:3072 sc1
    v_mfma_f32_16x16x32_bf16 a[36:39], a[40:43], v[72:75], a[36:39]
    ds_read_b128 a[64:67], v3 offset:9216
    v_exp_f32 v39, v39
    v_mfma_f32_32x32x16_bf16 v[112:127], a[80:83], v[76:79], v[112:127]
    global_load_dwordx4 a[92:95], v4, s[64:65] offset:0 sc1
    global_load_dwordx4 a[96:99], v4, s[64:65] offset:1024 sc1
    global_load_dwordx4 a[100:103], v5, s[64:65] offset:0 sc1
    global_load_dwordx4 a[104:107], v5, s[64:65] offset:1024 sc1
    v_mfma_f32_16x16x32_bf16 a[36:39], a[40:43], v[76:79], a[36:39]
    s_waitcnt lgkmcnt(0)
    v_cvt_pk_bf16_f32 v66, v36, v37
    v_exp_f32 v40, v40
    v_exp_f32_e64 v41, v41
    v_cvt_pk_bf16_f32 v67, v38, v39
    v_exp_f32 v42, v42
    v_exp_f32 v43, v43
    v_cvt_pk_bf16_f32 v68, v40, v41
    v_exp_f32 v44, v44
    v_exp_f32 v45, v45
    v_cvt_pk_bf16_f32 v69, v42, v43
    v_exp_f32 v46, v46
    v_exp_f32 v47, v47
    v_cvt_pk_bf16_f32 v70, v44, v45
    v_cvt_pk_bf16_f32 v71, v46, v47
    v_exp_f32 v48, v48
    v_exp_f32 v49, v49
    v_mfma_f32_32x32x16_bf16 v[32:47], a[60:63], a[44:47], 0
    v_exp_f32 v50, v50
    v_exp_f32 v51, v51
    v_cvt_pk_bf16_f32 v72, v48, v49
    v_exp_f32_e64 v52, v52
    v_mfma_f32_32x32x16_bf16 v[32:47], a[64:67], a[48:51], v[32:47]
    ds_read_b128 a[76:79], v3 offset:10240
    v_exp_f32_e64 v53, v53
    v_cvt_pk_bf16_f32 v73, v50, v51
    v_exp_f32_e64 v54, v54
    v_mfma_f32_32x32x16_bf16 v[96:111], a[84:87], v[64:67], v[96:111]
    global_load_dwordx4 a[108:111], v6, s[64:65] offset:0 sc1
    global_load_dwordx4 a[112:115], v6, s[64:65] offset:1024 sc1
    global_load_dwordx4 a[116:119], v7, s[64:65] offset:0 sc1
    global_load_dwordx4 a[120:123], v7, s[64:65] offset:1024 sc1
    v_mfma_f32_16x16x32_bf16 a[32:35], a[40:43], v[64:67], a[32:35]
    ds_read_b128 a[80:83], v3 offset:11264
    v_exp_f32_e64 v55, v55
    v_mfma_f32_32x32x16_bf16 v[96:111], a[88:91], v[68:71], v[96:111]
    v_cvt_pk_bf16_f32 v74, v52, v53
    v_exp_f32 v56, v56
    v_exp_f32 v57, v57
    v_cvt_pk_bf16_f32 v75, v54, v55
    v_mfma_f32_16x16x32_bf16 a[32:35], a[40:43], v[68:71], a[32:35]
    v_exp_f32 v58, v58
    v_exp_f32 v59, v59
    v_cvt_pk_bf16_f32 v76, v56, v57
    v_exp_f32 v60, v60
    v_exp_f32 v61, v61
    v_cvt_pk_bf16_f32 v77, v58, v59
    v_exp_f32 v62, v62
    v_exp_f32 v63, v63
    v_cvt_pk_bf16_f32 v78, v60, v61
    v_cvt_pk_bf16_f32 v79, v62, v63
    v_exp_f32 v32, v32
    v_exp_f32 v33, v33
    v_mfma_f32_32x32x16_bf16 v[48:63], a[60:63], a[52:55], 0
    v_exp_f32 v34, v34
    v_exp_f32 v35, v35
    v_cvt_pk_bf16_f32 v64, v32, v33
    v_exp_f32_e64 v36, v36
    v_mfma_f32_32x32x16_bf16 v[48:63], a[64:67], a[56:59], v[48:63]
    ds_read_b128 a[68:71], v3 offset:12288
    v_exp_f32_e64 v37, v37
    v_cvt_pk_bf16_f32 v65, v34, v35
    v_exp_f32_e64 v38, v38
    v_mfma_f32_32x32x16_bf16 v[112:127], a[84:87], v[72:75], v[112:127]
    global_load_dwordx4 a[124:127], v4, s[68:69] offset:0 sc1
    global_load_dwordx4 a[128:131], v4, s[68:69] offset:1024 sc1
    global_load_dwordx4 a[132:135], v5, s[68:69] offset:0 sc1
    global_load_dwordx4 a[136:139], v5, s[68:69] offset:1024 sc1
    v_mfma_f32_16x16x32_bf16 a[36:39], a[40:43], v[72:75], a[36:39]
    ds_read_b128 a[72:75], v3 offset:13312
    v_exp_f32_e64 v39, v39
    v_mfma_f32_32x32x16_bf16 v[112:127], a[88:91], v[76:79], v[112:127]
    v_cvt_pk_bf16_f32 v66, v36, v37
    v_exp_f32 v40, v40
    v_exp_f32 v41, v41
    v_cvt_pk_bf16_f32 v67, v38, v39
    v_mfma_f32_16x16x32_bf16 a[36:39], a[40:43], v[76:79], a[36:39]
    s_waitcnt lgkmcnt(0)
    v_exp_f32 v42, v42
    v_exp_f32_e64 v43, v43
    v_cvt_pk_bf16_f32 v68, v40, v41
    v_exp_f32 v44, v44
    v_exp_f32 v45, v45
    v_cvt_pk_bf16_f32 v69, v42, v43
    v_exp_f32 v46, v46
    v_exp_f32 v47, v47
    v_cvt_pk_bf16_f32 v70, v44, v45
    v_cvt_pk_bf16_f32 v71, v46, v47
    v_exp_f32 v48, v48
    v_exp_f32 v49, v49
    v_mfma_f32_32x32x16_bf16 v[32:47], a[68:71], a[44:47], 0
    v_exp_f32 v50, v50
    v_exp_f32 v51, v51
    v_cvt_pk_bf16_f32 v72, v48, v49
    v_exp_f32_e64 v52, v52
    v_mfma_f32_32x32x16_bf16 v[32:47], a[72:75], a[48:51], v[32:47]
    ds_read_b128 a[84:87], v3 offset:14336
    v_exp_f32_e64 v53, v53
    v_cvt_pk_bf16_f32 v73, v50, v51
    v_exp_f32_e64 v54, v54
    v_mfma_f32_32x32x16_bf16 v[96:111], a[76:79], v[64:67], v[96:111]
    global_load_dwordx4 a[140:143], v6, s[68:69] offset:0 sc1
    global_load_dwordx4 a[144:147], v6, s[68:69] offset:1024 sc1
    global_load_dwordx4 a[148:151], v7, s[68:69] offset:0 sc1
    global_load_dwordx4 a[152:155], v7, s[68:69] offset:1024 sc1
    v_mfma_f32_16x16x32_bf16 a[32:35], a[40:43], v[64:67], a[32:35]
    ds_read_b128 a[88:91], v3 offset:15360
    v_exp_f32_e64 v55, v55
    v_mfma_f32_32x32x16_bf16 v[96:111], a[80:83], v[68:71], v[96:111]
    v_cvt_pk_bf16_f32 v74, v52, v53
    v_exp_f32 v56, v56
    v_exp_f32 v57, v57
    v_cvt_pk_bf16_f32 v75, v54, v55
    v_mfma_f32_16x16x32_bf16 a[32:35], a[40:43], v[68:71], a[32:35]
    v_exp_f32 v58, v58
    v_exp_f32 v59, v59
    v_cvt_pk_bf16_f32 v76, v56, v57
    v_exp_f32 v60, v60
    v_exp_f32 v61, v61
    v_cvt_pk_bf16_f32 v77, v58, v59
    v_exp_f32 v62, v62
    v_exp_f32 v63, v63
    v_cvt_pk_bf16_f32 v78, v60, v61
    v_cvt_pk_bf16_f32 v79, v62, v63
    v_exp_f32 v32, v32
    v_exp_f32 v33, v33
    v_mfma_f32_32x32x16_bf16 v[48:63], a[68:71], a[52:55], 0
    v_exp_f32 v34, v34
    v_exp_f32 v35, v35
    v_cvt_pk_bf16_f32 v64, v32, v33
    v_exp_f32_e64 v36, v36
    v_mfma_f32_32x32x16_bf16 v[48:63], a[72:75], a[56:59], v[48:63]
    ds_read_b128 a[60:63], v3 offset:16384
    v_exp_f32_e64 v37, v37
    v_cvt_pk_bf16_f32 v65, v34, v35
    v_exp_f32_e64 v38, v38
    v_mfma_f32_32x32x16_bf16 v[112:127], a[76:79], v[72:75], v[112:127]
    global_load_dwordx4 a[172:175], v1, s[60:61] offset:0 sc1
    global_load_dwordx4 a[176:179], v1, s[60:61] offset:1024 sc1
    global_load_dwordx4 a[180:183], v1, s[60:61] offset:2048 sc1
    global_load_dwordx4 a[184:187], v1, s[60:61] offset:3072 sc1
    v_mfma_f32_16x16x32_bf16 a[36:39], a[40:43], v[72:75], a[36:39]
    ds_read_b128 a[64:67], v3 offset:17408
    v_exp_f32_e64 v39, v39
    v_mfma_f32_32x32x16_bf16 v[112:127], a[80:83], v[76:79], v[112:127]
    v_cvt_pk_bf16_f32 v66, v36, v37
    v_exp_f32 v40, v40
    v_exp_f32 v41, v41
    v_cvt_pk_bf16_f32 v67, v38, v39
    v_mfma_f32_16x16x32_bf16 a[36:39], a[40:43], v[76:79], a[36:39]
    s_waitcnt lgkmcnt(0)
    v_exp_f32 v42, v42
    v_exp_f32_e64 v43, v43
    v_cvt_pk_bf16_f32 v68, v40, v41
    v_exp_f32 v44, v44
    v_exp_f32 v45, v45
    v_cvt_pk_bf16_f32 v69, v42, v43
    v_exp_f32 v46, v46
    v_exp_f32 v47, v47
    v_cvt_pk_bf16_f32 v70, v44, v45
    v_cvt_pk_bf16_f32 v71, v46, v47
    v_exp_f32 v48, v48
    v_exp_f32 v49, v49
    v_mfma_f32_32x32x16_bf16 v[32:47], a[60:63], a[44:47], 0
    v_exp_f32 v50, v50
    v_exp_f32 v51, v51
    v_cvt_pk_bf16_f32 v72, v48, v49
    v_exp_f32_e64 v52, v52
    v_mfma_f32_32x32x16_bf16 v[32:47], a[64:67], a[48:51], v[32:47]
    ds_read_b128 a[76:79], v3 offset:18432
    v_exp_f32_e64 v53, v53
    v_cvt_pk_bf16_f32 v73, v50, v51
    v_exp_f32_e64 v54, v54
    v_mfma_f32_32x32x16_bf16 v[96:111], a[84:87], v[64:67], v[96:111]
    global_load_dwordx4 a[188:191], v1, s[62:63] offset:0 sc1
    global_load_dwordx4 a[192:195], v1, s[62:63] offset:1024 sc1
    global_load_dwordx4 a[196:199], v1, s[62:63] offset:2048 sc1
    global_load_dwordx4 a[200:203], v1, s[62:63] offset:3072 sc1
    v_mfma_f32_16x16x32_bf16 a[32:35], a[40:43], v[64:67], a[32:35]
    ds_read_b128 a[80:83], v3 offset:19456
    v_exp_f32_e64 v55, v55
    v_mfma_f32_32x32x16_bf16 v[96:111], a[88:91], v[68:71], v[96:111]
    v_cvt_pk_bf16_f32 v74, v52, v53
    v_exp_f32 v56, v56
    v_exp_f32 v57, v57
    v_cvt_pk_bf16_f32 v75, v54, v55
    v_mfma_f32_16x16x32_bf16 a[32:35], a[40:43], v[68:71], a[32:35]
    v_exp_f32 v58, v58
    v_exp_f32 v59, v59
    v_cvt_pk_bf16_f32 v76, v56, v57
    v_exp_f32 v60, v60
    v_exp_f32 v61, v61
    v_cvt_pk_bf16_f32 v77, v58, v59
    v_exp_f32 v62, v62
    v_exp_f32 v63, v63
    v_cvt_pk_bf16_f32 v78, v60, v61
    v_cvt_pk_bf16_f32 v79, v62, v63
    v_exp_f32 v32, v32
    v_exp_f32 v33, v33
    v_mfma_f32_32x32x16_bf16 v[48:63], a[60:63], a[52:55], 0
    v_exp_f32 v34, v34
    v_exp_f32 v35, v35
    v_cvt_pk_bf16_f32 v64, v32, v33
    v_exp_f32_e64 v36, v36
    v_mfma_f32_32x32x16_bf16 v[48:63], a[64:67], a[56:59], v[48:63]
    ds_read_b128 a[68:71], v3 offset:20480
    s_add_u32 m0, s34, 0
    v_exp_f32 v37, v37
    v_cvt_pk_bf16_f32 v65, v34, v35
    v_exp_f32_e64 v38, v38
    v_mfma_f32_32x32x16_bf16 v[112:127], a[84:87], v[72:75], v[112:127]
    global_load_dwordx4 a[204:207], v1, s[70:71] offset:0 sc1
    global_load_dwordx4 a[208:211], v1, s[70:71] offset:1024 sc1
    global_load_dwordx4 a[212:215], v1, s[70:71] offset:2048 sc1
    global_load_dwordx4 a[216:219], v1, s[70:71] offset:3072 sc1
    v_mfma_f32_16x16x32_bf16 a[36:39], a[40:43], v[72:75], a[36:39]
    ds_read_b128 a[72:75], v3 offset:21504
    v_exp_f32_e64 v39, v39
    v_mfma_f32_32x32x16_bf16 v[112:127], a[88:91], v[76:79], v[112:127]
    global_load_lds_dwordx4 v1, s[16:17] offset:0 sc1
    v_cvt_pk_bf16_f32 v66, v36, v37
    v_exp_f32 v40, v40
    v_exp_f32 v41, v41
    v_mfma_f32_16x16x32_bf16 a[36:39], a[40:43], v[76:79], a[36:39]
    s_waitcnt lgkmcnt(0)
    v_cvt_pk_bf16_f32 v67, v38, v39
    v_exp_f32 v42, v42
    v_exp_f32_e64 v43, v43
    v_cvt_pk_bf16_f32 v68, v40, v41
    v_exp_f32 v44, v44
    v_exp_f32 v45, v45
    v_cvt_pk_bf16_f32 v69, v42, v43
    v_exp_f32 v46, v46
    v_exp_f32 v47, v47
    v_cvt_pk_bf16_f32 v70, v44, v45
    v_cvt_pk_bf16_f32 v71, v46, v47
    v_exp_f32 v48, v48
    v_exp_f32 v49, v49
    v_mfma_f32_32x32x16_bf16 v[32:47], a[68:71], a[44:47], 0
    s_waitcnt vmcnt(28)
    global_load_lds_dwordx4 v1, s[16:17] offset:1024 sc1
    v_exp_f32 v50, v50
    v_exp_f32_e64 v51, v51
    v_mfma_f32_16x16x32_bf16 v[128:131], a[92:95], a[156:159], 0
    ds_read_b128 a[84:87], v3 offset:22528
    v_cvt_pk_bf16_f32 v72, v48, v49
    v_mfma_f32_32x32x16_bf16 v[32:47], a[72:75], a[48:51], v[32:47]
    s_add_u32 s52, s32, 49152
    s_addc_u32 s53, s33, 0
    global_load_dwordx4 a[0:3], v4, s[52:53] offset:0 sc1
    global_load_dwordx4 a[4:7], v4, s[52:53] offset:1024 sc1
    global_load_dwordx4 a[8:11], v5, s[52:53] offset:0 sc1
    global_load_dwordx4 a[12:15], v5, s[52:53] offset:1024 sc1
    v_mfma_f32_16x16x32_bf16 v[132:135], a[92:95], a[160:163], 0
    ds_read_b128 a[88:91], v3 offset:23552
    global_load_lds_dwordx4 v1, s[16:17] offset:2048 sc1
    v_mfma_f32_32x32x16_bf16 v[96:111], a[76:79], v[64:67], v[96:111]
    s_add_u32 s14, s14, 0x2000
    s_addc_u32 s15, s15, 0
    v_exp_f32 v52, v52
    v_exp_f32 v53, v53
    v_cvt_pk_bf16_f32 v73, v50, v51
    v_mfma_f32_16x16x32_bf16 a[32:35], a[40:43], v[64:67], a[32:35]
    global_load_lds_dwordx4 v1, s[16:17] offset:3072 sc1
    v_exp_f32_e64 v54, v54
    v_mfma_f32_16x16x32_bf16 v[136:139], a[92:95], a[164:167], 0
    v_exp_f32_e64 v55, v55
    v_mfma_f32_32x32x16_bf16 v[96:111], a[80:83], v[68:71], v[96:111]
    v_cvt_pk_bf16_f32 v74, v52, v53
    v_exp_f32 v56, v56
    v_exp_f32 v57, v57
    v_cvt_pk_bf16_f32 v75, v54, v55
    v_mfma_f32_16x16x32_bf16 v[140:143], a[92:95], a[168:171], 0
    v_exp_f32_e64 v58, v58
    v_mfma_f32_16x16x32_bf16 a[32:35], a[40:43], v[68:71], a[32:35]
    s_waitcnt vmcnt(34)
    v_exp_f32 v59, v59
    v_mfma_f32_16x16x32_bf16 v[144:147], a[96:99], a[156:159], 0
    v_cvt_pk_bf16_f32 v76, v56, v57
    v_exp_f32 v60, v60
    v_exp_f32 v61, v61
    v_cvt_pk_bf16_f32 v77, v58, v59
    v_exp_f32 v62, v62
    v_exp_f32 v63, v63
    v_cvt_pk_bf16_f32 v78, v60, v61
    v_cvt_pk_bf16_f32 v79, v62, v63
    v_exp_f32 v32, v32
    v_exp_f32 v33, v33
    v_mfma_f32_32x32x16_bf16 v[48:63], a[68:71], a[52:55], 0
    global_load_dwordx4 a[92:95], v4, s[14:15] offset:0 sc1
    v_exp_f32 v34, v34
    v_exp_f32 v35, v35
    v_cvt_pk_bf16_f32 v64, v32, v33
    v_mfma_f32_16x16x32_bf16 v[148:151], a[96:99], a[160:163], 0
    ds_read_b128 a[60:63], v3 offset:24576
    s_add_u32 m0, s34, 4096
    v_mfma_f32_32x32x16_bf16 v[48:63], a[72:75], a[56:59], v[48:63]
    global_load_dwordx4 a[16:19], v6, s[52:53] offset:0 sc1
    global_load_dwordx4 a[20:23], v6, s[52:53] offset:1024 sc1
    global_load_dwordx4 a[24:27], v7, s[52:53] offset:0 sc1
    global_load_dwordx4 a[28:31], v7, s[52:53] offset:1024 sc1
    v_mfma_f32_32x32x16_bf16 v[112:127], a[76:79], v[72:75], v[112:127]
    ds_read_b128 a[64:67], v3 offset:25600
    v_exp_f32 v36, v36
    v_exp_f32 v37, v37
    v_cvt_pk_bf16_f32 v65, v34, v35
    v_mfma_f32_16x16x32_bf16 v[152:155], a[96:99], a[164:167], 0
    global_load_lds_dwordx4 v2, s[16:17] offset:0 sc1
    v_exp_f32_e64 v38, v38
    v_mfma_f32_16x16x32_bf16 a[36:39], a[40:43], v[72:75], a[36:39]
    v_exp_f32_e64 v39, v39
    v_mfma_f32_16x16x32_bf16 v[156:159], a[96:99], a[168:171], 0
    global_load_lds_dwordx4 v2, s[16:17] offset:1024 sc1
    v_cvt_pk_bf16_f32 v66, v36, v37
    v_mfma_f32_32x32x16_bf16 v[112:127], a[80:83], v[76:79], v[112:127]
    global_load_dwordx4 a[96:99], v4, s[14:15] offset:1024 sc1
    v_exp_f32 v40, v40
    v_exp_f32 v41, v41
    v_cvt_pk_bf16_f32 v67, v38, v39
    v_mfma_f32_16x16x32_bf16 a[36:39], a[40:43], v[76:79], a[36:39]
    s_waitcnt vmcnt(41)
    global_load_lds_dwordx4 v2, s[16:17] offset:2048 sc1
    v_mfma_f32_16x16x32_bf16 v[160:163], a[100:103], a[156:159], 0
    s_waitcnt lgkmcnt(0)
    v_exp_f32 v42, v42
    v_exp_f32 v43, v43
    v_cvt_pk_bf16_f32 v68, v40, v41
    v_exp_f32 v44, v44
    v_exp_f32 v45, v45
    v_cvt_pk_bf16_f32 v69, v42, v43
    v_exp_f32 v46, v46
    v_exp_f32 v47, v47
    v_cvt_pk_bf16_f32 v70, v44, v45
    v_cvt_pk_bf16_f32 v71, v46, v47
    v_exp_f32 v48, v48
    v_exp_f32 v49, v49
    v_mfma_f32_32x32x16_bf16 v[32:47], a[60:63], a[44:47], 0
    global_load_lds_dwordx4 v2, s[16:17] offset:3072 sc1
    v_exp_f32 v50, v50
    v_exp_f32 v51, v51
    v_cvt_pk_bf16_f32 v72, v48, v49
    v_mfma_f32_16x16x32_bf16 v[164:167], a[100:103], a[160:163], 0
    ds_read_b128 a[76:79], v3 offset:26624
    v_exp_f32_e64 v52, v52
    v_mfma_f32_32x32x16_bf16 v[32:47], a[64:67], a[48:51], v[32:47]
    s_add_u32 s52, s32, 57344
    s_addc_u32 s53, s33, 0
    global_load_dwordx4 a[220:223], v4, s[52:53] offset:0 sc1
    global_load_dwordx4 a[224:227], v4, s[52:53] offset:1024 sc1
    global_load_dwordx4 a[228:231], v5, s[52:53] offset:0 sc1
    global_load_dwordx4 a[232:235], v5, s[52:53] offset:1024 sc1
    v_mfma_f32_16x16x32_bf16 v[168:171], a[100:103], a[164:167], 0
    ds_read_b128 a[80:83], v3 offset:27648
    v_exp_f32 v53, v53
    v_mfma_f32_32x32x16_bf16 v[96:111], a[84:87], v[64:67], v[96:111]
    s_add_u32 s16, s16, 0x8000
    s_addc_u32 s17, s17, 0
    v_cvt_pk_bf16_f32 v73, v50, v51
    v_exp_f32 v54, v54
    v_exp_f32_e64 v55, v55
    v_mfma_f32_16x16x32_bf16 a[32:35], a[40:43], v[64:67], a[32:35]
    s_xor_b32 s34, s34, 0x8000
    v_cvt_pk_bf16_f32 v74, v52, v53
    v_exp_f32_e64 v56, v56
    v_mfma_f32_16x16x32_bf16 v[172:175], a[100:103], a[168:171], 0
    global_load_dwordx4 a[100:103], v5, s[14:15] offset:0 sc1
    v_exp_f32_e64 v57, v57
    v_mfma_f32_32x32x16_bf16 v[96:111], a[88:91], v[68:71], v[96:111]
    s_waitcnt vmcnt(47)
    v_cvt_pk_bf16_f32 v75, v54, v55
    v_exp_f32 v58, v58
    v_exp_f32_e64 v59, v59
    v_cvt_pk_bf16_f32 v76, v56, v57
    v_mfma_f32_16x16x32_bf16 v[176:179], a[104:107], a[156:159], 0
    v_exp_f32_e64 v60, v60
    v_mfma_f32_16x16x32_bf16 a[32:35], a[40:43], v[68:71], a[32:35]
    v_exp_f32_e64 v61, v61
    v_mfma_f32_16x16x32_bf16 v[180:183], a[104:107], a[160:163], 0
    v_cvt_pk_bf16_f32 v77, v58, v59
    v_exp_f32 v62, v62
    v_exp_f32 v63, v63
    v_cvt_pk_bf16_f32 v78, v60, v61
    v_cvt_pk_bf16_f32 v79, v62, v63
    v_exp_f32 v32, v32
    v_exp_f32 v33, v33
    v_mfma_f32_32x32x16_bf16 v[48:63], a[60:63], a[52:55], 0
    v_exp_f32 v34, v34
    v_exp_f32 v35, v35
    v_cvt_pk_bf16_f32 v64, v32, v33
    v_exp_f32_e64 v36, v36
    v_mfma_f32_16x16x32_bf16 v[184:187], a[104:107], a[164:167], 0
    ds_read_b128 a[68:71], v3 offset:28672
    v_exp_f32_e64 v37, v37
    v_mfma_f32_32x32x16_bf16 v[48:63], a[64:67], a[56:59], v[48:63]
    global_load_dwordx4 a[236:239], v6, s[52:53] offset:0 sc1
    global_load_dwordx4 a[240:243], v6, s[52:53] offset:1024 sc1
    global_load_dwordx4 a[244:247], v7, s[52:53] offset:0 sc1
    global_load_dwordx4 a[248:251], v7, s[52:53] offset:1024 sc1
    v_mfma_f32_32x32x16_bf16 v[112:127], a[84:87], v[72:75], v[112:127]
    ds_read_b128 a[72:75], v3 offset:29696
    v_cvt_pk_bf16_f32 v65, v34, v35
    v_exp_f32 v38, v38
    v_exp_f32 v39, v39
    v_mfma_f32_16x16x32_bf16 v[188:191], a[104:107], a[168:171], 0
    v_cvt_pk_bf16_f32 v66, v36, v37
    v_exp_f32_e64 v40, v40
    v_mfma_f32_16x16x32_bf16 a[36:39], a[40:43], v[72:75], a[36:39]
    s_waitcnt vmcnt(50)
    v_exp_f32 v41, v41
    v_mfma_f32_16x16x32_bf16 v[192:195], a[108:111], a[156:159], 0
    v_cvt_pk_bf16_f32 v67, v38, v39
    v_exp_f32_e64 v42, v42
    v_mfma_f32_32x32x16_bf16 v[112:127], a[88:91], v[76:79], v[112:127]
    global_load_dwordx4 a[104:107], v5, s[14:15] offset:1024 sc1
    v_exp_f32_e64 v43, v43
    v_cvt_pk_bf16_f32 v68, v40, v41
    v_exp_f32_e64 v44, v44
    v_mfma_f32_16x16x32_bf16 a[36:39], a[40:43], v[76:79], a[36:39]
    v_exp_f32_e64 v45, v45
    v_mfma_f32_16x16x32_bf16 v[196:199], a[108:111], a[160:163], 0
    s_waitcnt lgkmcnt(0)
    v_cvt_pk_bf16_f32 v69, v42, v43
    v_exp_f32 v46, v46
    v_exp_f32_e64 v47, v47
    v_cvt_pk_bf16_f32 v70, v44, v45
    v_cvt_pk_bf16_f32 v71, v46, v47
    v_exp_f32 v48, v48
    v_exp_f32 v49, v49
    v_mfma_f32_32x32x16_bf16 v[32:47], a[68:71], a[44:47], 0
    v_exp_f32 v50, v50
    v_exp_f32 v51, v51
    v_cvt_pk_bf16_f32 v72, v48, v49
    v_exp_f32_e64 v52, v52
    v_mfma_f32_16x16x32_bf16 v[200:203], a[108:111], a[164:167], 0
    ds_read_b128 a[84:87], v3 offset:30720
    v_exp_f32_e64 v53, v53
    v_mfma_f32_32x32x16_bf16 v[32:47], a[72:75], a[48:51], v[32:47]
    buffer_load_dword v22, v26, s[24:27], s41 offen offset:0 sc1
    buffer_load_dword v23, v26, s[24:27], s41 offen offset:256 sc1
    v_cvt_pk_bf16_f32 v73, v50, v51
    v_mfma_f32_16x16x32_bf16 v[204:207], a[108:111], a[168:171], 0
    ds_read_b128 a[88:91], v3 offset:31744
    v_exp_f32_e64 v54, v54
    v_mfma_f32_32x32x16_bf16 v[96:111], a[76:79], v[64:67], v[96:111]
    global_load_dwordx4 a[108:111], v6, s[14:15] offset:0 sc1
    v_exp_f32_e64 v55, v55
    v_cvt_pk_bf16_f32 v74, v52, v53
    v_exp_f32_e64 v56, v56
    v_mfma_f32_16x16x32_bf16 a[32:35], a[40:43], v[64:67], a[32:35]
    s_waitcnt vmcnt(53)
    v_exp_f32 v57, v57
    v_mfma_f32_16x16x32_bf16 v[208:211], a[112:115], a[156:159], 0
    v_cvt_pk_bf16_f32 v75, v54, v55
    v_exp_f32_e64 v58, v58
    v_mfma_f32_32x32x16_bf16 v[96:111], a[80:83], v[68:71], v[96:111]
    v_exp_f32_e64 v59, v59
    v_cvt_pk_bf16_f32 v76, v56, v57
    v_exp_f32 v60, v60
    v_exp_f32 v61, v61
    v_mfma_f32_16x16x32_bf16 v[212:215], a[112:115], a[160:163], 0
    v_cvt_pk_bf16_f32 v77, v58, v59
    v_exp_f32_e64 v62, v62
    v_mfma_f32_16x16x32_bf16 a[32:35], a[40:43], v[68:71], a[32:35]
    v_exp_f32_e64 v63, v63
    v_mfma_f32_16x16x32_bf16 v[216:219], a[112:115], a[164:167], 0
    v_cvt_pk_bf16_f32 v78, v60, v61
    v_cvt_pk_bf16_f32 v79, v62, v63
    v_exp_f32 v32, v32
    v_exp_f32 v33, v33
    v_mfma_f32_32x32x16_bf16 v[48:63], a[68:71], a[52:55], 0
    s_waitcnt vmcnt(13) lgkmcnt(0)
    s_barrier
    v_xor_b32 v3, 0x8000, v3
    v_exp_f32 v34, v34
    v_exp_f32 v35, v35
    v_mfma_f32_16x16x32_bf16 v[220:223], a[112:115], a[168:171], 0
    global_load_dwordx4 a[112:115], v6, s[14:15] offset:1024 sc1
    v_cvt_pk_bf16_f32 v64, v32, v33
    v_mfma_f32_32x32x16_bf16 v[48:63], a[72:75], a[56:59], v[48:63]
    ds_read_b128 a[60:63], v3 offset:0
    v_exp_f32 v36, v36
    v_exp_f32 v37, v37
    v_cvt_pk_bf16_f32 v65, v34, v35
    v_mfma_f32_32x32x16_bf16 v[112:127], a[76:79], v[72:75], v[112:127]
    v_exp_f32 v38, v38
    v_exp_f32 v39, v39
    v_cvt_pk_bf16_f32 v66, v36, v37
    v_exp_f32_e64 v40, v40
    v_mfma_f32_16x16x32_bf16 v[224:227], a[116:119], a[156:159], 0
    ds_read_b128 a[64:67], v3 offset:1024
    v_exp_f32_e64 v41, v41
    v_mfma_f32_16x16x32_bf16 a[36:39], a[40:43], v[72:75], a[36:39]
    v_cvt_pk_bf16_f32 v67, v38, v39
    v_exp_f32_e64 v42, v42
    v_mfma_f32_16x16x32_bf16 v[228:231], a[116:119], a[160:163], 0
    v_exp_f32_e64 v43, v43
    v_mfma_f32_32x32x16_bf16 v[112:127], a[80:83], v[76:79], v[112:127]
    buffer_load_dword v18, v27, s[24:27], s40 offen offset:4 sc1
    buffer_load_dword v19, v27, s[24:27], s40 offen offset:132 sc1
    buffer_load_dword v20, v27, s[24:27], s40 offen offset:260 sc1
    buffer_load_dword v21, v27, s[24:27], s40 offen offset:388 sc1
    v_mfma_f32_16x16x32_bf16 a[36:39], a[40:43], v[76:79], a[36:39]
    v_cvt_pk_bf16_f32 v68, v40, v41
    v_exp_f32_e64 v44, v44
    v_mfma_f32_16x16x32_bf16 v[232:235], a[116:119], a[164:167], 0
    s_waitcnt lgkmcnt(0)
    v_exp_f32 v45, v45
    v_cvt_pk_bf16_f32 v69, v42, v43
    v_exp_f32 v46, v46
    v_exp_f32 v47, v47
    v_cvt_pk_bf16_f32 v70, v44, v45
    v_cvt_pk_bf16_f32 v71, v46, v47
    v_exp_f32 v48, v48
    v_exp_f32 v49, v49
    v_mfma_f32_32x32x16_bf16 v[32:47], a[60:63], a[44:47], 0
    v_exp_f32 v50, v50
    v_exp_f32 v51, v51
    v_cvt_pk_bf16_f32 v72, v48, v49
    v_exp_f32_e64 v52, v52
    v_mfma_f32_16x16x32_bf16 v[236:239], a[116:119], a[168:171], 0
    ds_read_b128 a[76:79], v3 offset:2048
    v_exp_f32_e64 v53, v53
    v_mfma_f32_32x32x16_bf16 v[32:47], a[64:67], a[48:51], v[32:47]
    v_cvt_pk_bf16_f32 v73, v50, v51
    v_exp_f32 v54, v54
    v_exp_f32 v55, v55
    v_cvt_pk_bf16_f32 v74, v52, v53
    v_mfma_f32_16x16x32_bf16 v[240:243], a[120:123], a[156:159], 0
    ds_read_b128 a[80:83], v3 offset:3072
    v_exp_f32_e64 v56, v56
    v_mfma_f32_32x32x16_bf16 v[96:111], a[84:87], v[64:67], v[96:111]
    global_load_dwordx4 a[116:119], v7, s[14:15] offset:0 sc1
    v_exp_f32_e64 v57, v57
    v_cvt_pk_bf16_f32 v75, v54, v55
    v_exp_f32_e64 v58, v58
    v_mfma_f32_16x16x32_bf16 a[32:35], a[40:43], v[64:67], a[32:35]
    v_exp_f32_e64 v59, v59
    v_mfma_f32_16x16x32_bf16 v[244:247], a[120:123], a[160:163], 0
    v_cvt_pk_bf16_f32 v76, v56, v57
    v_exp_f32_e64 v60, v60
    v_mfma_f32_32x32x16_bf16 v[96:111], a[88:91], v[68:71], v[96:111]
    v_exp_f32_e64 v61, v61
    v_cvt_pk_bf16_f32 v77, v58, v59
    v_exp_f32 v62, v62
    v_exp_f32 v63, v63
    v_mfma_f32_16x16x32_bf16 v[248:251], a[120:123], a[164:167], 0
    v_cvt_pk_bf16_f32 v78, v60, v61
    v_cvt_pk_bf16_f32 v79, v62, v63
    v_mfma_f32_16x16x32_bf16 a[32:35], a[40:43], v[68:71], a[32:35]
    v_mfma_f32_16x16x32_bf16 v[252:255], a[120:123], a[168:171], 0
    global_load_dwordx4 a[120:123], v7, s[14:15] offset:1024 sc1
KM_LOOP:
    v_exp_f32 v32, v32
    v_exp_f32 v33, v33
    v_mfma_f32_32x32x16_bf16 v[48:63], a[60:63], a[52:55], 0
    s_waitcnt vmcnt(26)
    v_exp_f32 v34, v34
    v_exp_f32_e64 v35, v35
    v_cvt_pk_bf16_f32 v64, v32, v33
    v_exp_f32_e64 v36, v36
    v_mfma_f32_16x16x32_bf16 v[128:131], a[124:127], a[172:175], v[128:131]
    ds_read_b128 a[68:71], v3 offset:4096
    s_add_u32 s12, s12, 0x2000
    s_addc_u32 s13, s13, 0
    v_mfma_f32_32x32x16_bf16 v[48:63], a[64:67], a[56:59], v[48:63]
    s_add_u32 s14, s14, 0x2000
    s_addc_u32 s15, s15, 0
    v_exp_f32_e64 v37, v37
    v_cvt_pk_bf16_f32 v65, v34, v35
    v_exp_f32_e64 v38, v38
    v_mfma_f32_16x16x32_bf16 v[132:135], a[124:127], a[176:179], v[132:135]
    ds_read_b128 a[72:75], v3 offset:5120
    v_exp_f32_e64 v39, v39
    v_mfma_f32_16x16x32_bf16 v[136:139], a[124:127], a[180:183], v[136:139]
    v_cvt_pk_bf16_f32 v66, v36, v37
    v_exp_f32_e64 v40, v40
    v_mfma_f32_32x32x16_bf16 v[112:127], a[84:87], v[72:75], v[112:127]
    global_load_dwordx4 a[156:159], v1, s[12:13] offset:0 sc1
    v_exp_f32_e64 v41, v41
    v_cvt_pk_bf16_f32 v67, v38, v39
    v_exp_f32_e64 v42, v42
    v_mfma_f32_16x16x32_bf16 v[140:143], a[124:127], a[184:187], v[140:143]
    v_exp_f32_e64 v43, v43
    v_mfma_f32_16x16x32_bf16 a[36:39], a[40:43], v[72:75], a[36:39]
    s_waitcnt vmcnt(25)
    v_cvt_pk_bf16_f32 v68, v40, v41
    v_exp_f32 v44, v44
    v_mfma_f32_16x16x32_bf16 v[144:147], a[128:131], a[172:175], v[144:147]
    v_exp_f32_e64 v45, v45
    v_mfma_f32_32x32x16_bf16 v[112:127], a[88:91], v[76:79], v[112:127]
    global_load_dwordx4 a[124:127], v4, s[14:15] offset:0 sc1
    v_cvt_pk_bf16_f32 v69, v42, v43
    v_exp_f32 v46, v46
    v_exp_f32 v47, v47
    v_mfma_f32_16x16x32_bf16 v[148:151], a[128:131], a[176:179], v[148:151]
    v_cvt_pk_bf16_f32 v70, v44, v45
    v_cvt_pk_bf16_f32 v71, v46, v47
    v_mfma_f32_16x16x32_bf16 v[152:155], a[128:131], a[180:183], v[152:155]
    v_exp_f32_e64 v48, v48
    v_mfma_f32_16x16x32_bf16 a[36:39], a[40:43], v[76:79], a[36:39]
    global_load_dwordx4 a[160:163], v1, s[12:13] offset:1024 sc1
    v_exp_f32_e64 v49, v49
    v_mfma_f32_16x16x32_bf16 v[156:159], a[128:131], a[184:187], v[156:159]
    s_waitcnt lgkmcnt(0)
    v_exp_f32 v50, v50
    v_mfma_f32_32x32x16_bf16 v[32:47], a[68:71], a[44:47], 0
    s_waitcnt vmcnt(24)
    v_exp_f32 v51, v51
    v_cvt_pk_bf16_f32 v72, v48, v49
    v_exp_f32 v52, v52
    v_exp_f32 v53, v53
    v_mfma_f32_16x16x32_bf16 v[160:163], a[132:135], a[172:175], v[160:163]
    ds_read_b128 a[84:87], v3 offset:6144
    s_add_u32 m0, s34, 0
    v_mfma_f32_32x32x16_bf16 v[32:47], a[72:75], a[48:51], v[32:47]
    global_load_dwordx4 a[128:131], v4, s[14:15] offset:1024 sc1
    v_cvt_pk_bf16_f32 v73, v50, v51
    v_exp_f32 v54, v54
    v_exp_f32_e64 v55, v55
    v_mfma_f32_16x16x32_bf16 v[164:167], a[132:135], a[176:179], v[164:167]
    ds_read_b128 a[88:91], v3 offset:7168
    v_cvt_pk_bf16_f32 v74, v52, v53
    v_mfma_f32_16x16x32_bf16 v[168:171], a[132:135], a[180:183], v[168:171]
    global_load_lds_dwordx4 v1, s[16:17] offset:0 sc1
    v_exp_f32_e64 v56, v56
    v_mfma_f32_32x32x16_bf16 v[96:111], a[76:79], v[64:67], v[96:111]
    global_load_dwordx4 a[164:167], v1, s[12:13] offset:2048 sc1
    v_exp_f32_e64 v57, v57
    v_cvt_pk_bf16_f32 v75, v54, v55
    v_exp_f32_e64 v58, v58
    v_mfma_f32_16x16x32_bf16 v[172:175], a[132:135], a[184:187], v[172:175]
    v_exp_f32_e64 v59, v59
    v_mfma_f32_16x16x32_bf16 a[32:35], a[40:43], v[64:67], a[32:35]
    s_waitcnt vmcnt(24)
    v_cvt_pk_bf16_f32 v76, v56, v57
    v_exp_f32 v60, v60
    v_mfma_f32_16x16x32_bf16 v[176:179], a[136:139], a[172:175], v[176:179]
    v_exp_f32_e64 v61, v61
    v_mfma_f32_32x32x16_bf16 v[96:111], a[80:83], v[68:71], v[96:111]
    global_load_dwordx4 a[132:135], v5, s[14:15] offset:0 sc1
    v_cvt_pk_bf16_f32 v77, v58, v59
    v_exp_f32 v62, v62
    v_exp_f32 v63, v63
    v_mfma_f32_16x16x32_bf16 v[180:183], a[136:139], a[176:179], v[180:183]
    global_load_lds_dwordx4 v1, s[16:17] offset:1024 sc1
    v_cvt_pk_bf16_f32 v78, v60, v61
    v_mfma_f32_16x16x32_bf16 v[184:187], a[136:139], a[180:183], v[184:187]
    v_cvt_pk_bf16_f32 v79, v62, v63
    v_exp_f32_e64 v32, v32
    v_mfma_f32_16x16x32_bf16 a[32:35], a[40:43], v[68:71], a[32:35]
    global_load_dwordx4 a[168:171], v1, s[12:13] offset:3072 sc1
    v_exp_f32_e64 v33, v33
    v_mfma_f32_16x16x32_bf16 v[188:191], a[136:139], a[184:187], v[188:191]
    v_exp_f32_e64 v34, v34
    v_mfma_f32_32x32x16_bf16 v[48:63], a[68:71], a[52:55], 0
    s_waitcnt vmcnt(25)
    v_exp_f32 v35, v35
    v_cvt_pk_bf16_f32 v64, v32, v33
    v_exp_f32 v36, v36
    v_exp_f32 v37, v37
    v_mfma_f32_16x16x32_bf16 v[192:195], a[140:143], a[172:175], v[192:195]
    ds_read_b128 a[60:63], v3 offset:8192
    v_cvt_pk_bf16_f32 v65, v34, v35
    v_mfma_f32_32x32x16_bf16 v[48:63], a[72:75], a[56:59], v[48:63]
    global_load_dwordx4 a[136:139], v5, s[14:15] offset:1024 sc1
    v_exp_f32 v38, v38
    v_exp_f32 v39, v39
    v_cvt_pk_bf16_f32 v66, v36, v37
    v_mfma_f32_16x16x32_bf16 v[196:199], a[140:143], a[176:179], v[196:199]
    ds_read_b128 a[64:67], v3 offset:9216
    v_exp_f32_e64 v40, v40
    v_mfma_f32_16x16x32_bf16 v[200:203], a[140:143], a[180:183], v[200:203]
    v_exp_f32_e64 v41, v41
    v_mfma_f32_32x32x16_bf16 v[112:127], a[76:79], v[72:75], v[112:127]
    global_load_lds_dwordx4 v1, s[16:17] offset:2048 sc1
    v_cvt_pk_bf16_f32 v67, v38, v39
    v_exp_f32 v42, v42
    v_exp_f32 v43, v43
    v_mfma_f32_16x16x32_bf16 v[204:207], a[140:143], a[184:187], v[204:207]
    v_cvt_pk_bf16_f32 v68, v40, v41
    v_exp_f32_e64 v44, v44
    v_mfma_f32_16x16x32_bf16 a[36:39], a[40:43], v[72:75], a[36:39]
    s_waitcnt vmcnt(25)
    v_exp_f32 v45, v45
    v_mfma_f32_16x16x32_bf16 v[208:211], a[144:147], a[172:175], v[208:211]
    v_cvt_pk_bf16_f32 v69, v42, v43
    v_exp_f32_e64 v46, v46
    v_mfma_f32_32x32x16_bf16 v[112:127], a[80:83], v[76:79], v[112:127]
    global_load_dwordx4 a[140:143], v6, s[14:15] offset:0 sc1
    v_exp_f32_e64 v47, v47
    v_cvt_pk_bf16_f32 v70, v44, v45
    v_cvt_pk_bf16_f32 v71, v46, v47
    v_exp_f32_e64 v48, v48
    v_mfma_f32_16x16x32_bf16 v[212:215], a[144:147], a[176:179], v[212:215]
    global_load_lds_dwordx4 v1, s[16:17] offset:3072 sc1
    v_exp_f32_e64 v49, v49
    v_mfma_f32_16x16x32_bf16 v[216:219], a[144:147], a[180:183], v[216:219]
    v_exp_f32_e64 v50, v50
    v_mfma_f32_16x16x32_bf16 a[36:39], a[40:43], v[76:79], a[36:39]
    v_exp_f32_e64 v51, v51
    v_mfma_f32_16x16x32_bf16 v[220:223], a[144:147], a[184:187], v[220:223]
    s_waitcnt lgkmcnt(0)
    v_cvt_pk_bf16_f32 v72, v48, v49
    v_exp_f32 v52, v52
    v_mfma_f32_32x32x16_bf16 v[32:47], a[60:63], a[44:47], 0
    s_waitcnt vmcnt(26)
    v_exp_f32 v53, v53
    v_cvt_pk_bf16_f32 v73, v50, v51
    v_exp_f32 v54, v54
    v_exp_f32 v55, v55
    v_mfma_f32_16x16x32_bf16 v[224:227], a[148:151], a[172:175], v[224:227]
    ds_read_b128 a[76:79], v3 offset:10240
    v_cvt_pk_bf16_f32 v74, v52, v53
    v_mfma_f32_32x32x16_bf16 v[32:47], a[64:67], a[48:51], v[32:47]
    global_load_dwordx4 a[144:147], v6, s[14:15] offset:1024 sc1
    v_exp_f32 v56, v56
    v_exp_f32 v57, v57
    v_cvt_pk_bf16_f32 v75, v54, v55
    v_mfma_f32_16x16x32_bf16 v[228:231], a[148:151], a[176:179], v[228:231]
    ds_read_b128 a[80:83], v3 offset:11264
    v_exp_f32_e64 v58, v58
    v_mfma_f32_16x16x32_bf16 v[232:235], a[148:151], a[180:183], v[232:235]
    v_exp_f32_e64 v59, v59
    v_mfma_f32_32x32x16_bf16 v[96:111], a[84:87], v[64:67], v[96:111]
    v_cvt_pk_bf16_f32 v76, v56, v57
    v_exp_f32 v60, v60
    v_exp_f32 v61, v61
    v_cvt_pk_bf16_f32 v77, v58, v59
    v_mfma_f32_16x16x32_bf16 v[236:239], a[148:151], a[184:187], v[236:239]
    v_exp_f32_e64 v62, v62
    v_mfma_f32_16x16x32_bf16 a[32:35], a[40:43], v[64:67], a[32:35]
    s_waitcnt vmcnt(26)
    v_exp_f32 v63, v63
    v_mfma_f32_16x16x32_bf16 v[240:243], a[152:155], a[172:175], v[240:243]
    v_cvt_pk_bf16_f32 v78, v60, v61
    v_cvt_pk_bf16_f32 v79, v62, v63
    v_mfma_f32_32x32x16_bf16 v[96:111], a[88:91], v[68:71], v[96:111]
    global_load_dwordx4 a[148:151], v7, s[14:15] offset:0 sc1
    v_exp_f32 v32, v32
    v_exp_f32 v33, v33
    v_exp_f32_e64 v34, v34
    v_mfma_f32_16x16x32_bf16 v[244:247], a[152:155], a[176:179], v[244:247]
    v_exp_f32_e64 v35, v35
    v_mfma_f32_16x16x32_bf16 v[248:251], a[152:155], a[180:183], v[248:251]
    v_cvt_pk_bf16_f32 v64, v32, v33
    v_exp_f32_e64 v36, v36
    v_mfma_f32_16x16x32_bf16 a[32:35], a[40:43], v[68:71], a[32:35]
    v_exp_f32_e64 v37, v37
    v_mfma_f32_16x16x32_bf16 v[252:255], a[152:155], a[184:187], v[252:255]
    v_cvt_pk_bf16_f32 v65, v34, v35
    v_exp_f32_e64 v38, v38
    v_mfma_f32_32x32x16_bf16 v[48:63], a[60:63], a[52:55], 0
    s_waitcnt vmcnt(25)
    v_exp_f32 v39, v39
    v_cvt_pk_bf16_f32 v66, v36, v37
    v_exp_f32 v40, v40
    v_exp_f32 v41, v41
    v_mfma_f32_16x16x32_bf16 v[128:131], a[92:95], a[188:191], v[128:131]
    ds_read_b128 a[68:71], v3 offset:12288
    s_add_u32 s12, s12, 0x2000
    s_addc_u32 s13, s13, 0
    v_mfma_f32_32x32x16_bf16 v[48:63], a[64:67], a[56:59], v[48:63]
    global_load_dwordx4 a[152:155], v7, s[14:15] offset:1024 sc1
    v_cvt_pk_bf16_f32 v67, v38, v39
    v_exp_f32 v42, v42
    v_exp_f32_e64 v43, v43
    v_mfma_f32_16x16x32_bf16 v[132:135], a[92:95], a[192:195], v[132:135]
    ds_read_b128 a[72:75], v3 offset:13312
    s_add_u32 m0, s34, 4096
    v_mfma_f32_16x16x32_bf16 v[136:139], a[92:95], a[196:199], v[136:139]
    s_add_u32 s14, s14, 0x2000
    s_addc_u32 s15, s15, 0
    v_cvt_pk_bf16_f32 v68, v40, v41
    v_mfma_f32_32x32x16_bf16 v[112:127], a[84:87], v[72:75], v[112:127]
    global_load_dwordx4 a[172:175], v1, s[12:13] offset:0 sc1
    v_exp_f32 v44, v44
    v_exp_f32_e64 v45, v45
    v_cvt_pk_bf16_f32 v69, v42, v43
    v_mfma_f32_16x16x32_bf16 v[140:143], a[92:95], a[200:203], v[140:143]
    global_load_lds_dwordx4 v2, s[16:17] offset:0 sc1
    v_exp_f32_e64 v46, v46
    v_mfma_f32_16x16x32_bf16 a[36:39], a[40:43], v[72:75], a[36:39]
    s_waitcnt vmcnt(26)
    v_exp_f32 v47, v47
    v_mfma_f32_16x16x32_bf16 v[144:147], a[96:99], a[188:191], v[144:147]
    v_cvt_pk_bf16_f32 v70, v44, v45
    v_cvt_pk_bf16_f32 v71, v46, v47
    v_mfma_f32_32x32x16_bf16 v[112:127], a[88:91], v[76:79], v[112:127]
    global_load_dwordx4 a[92:95], v4, s[14:15] offset:0 sc1
    v_exp_f32 v48, v48
    v_exp_f32 v49, v49
    v_exp_f32_e64 v50, v50
    v_mfma_f32_16x16x32_bf16 v[148:151], a[96:99], a[192:195], v[148:151]
    v_exp_f32_e64 v51, v51
    v_mfma_f32_16x16x32_bf16 v[152:155], a[96:99], a[196:199], v[152:155]
    global_load_lds_dwordx4 v2, s[16:17] offset:1024 sc1
    v_cvt_pk_bf16_f32 v72, v48, v49
    v_mfma_f32_16x16x32_bf16 a[36:39], a[40:43], v[76:79], a[36:39]
    global_load_dwordx4 a[176:179], v1, s[12:13] offset:1024 sc1
    v_exp_f32_e64 v52, v52
    v_mfma_f32_16x16x32_bf16 v[156:159], a[96:99], a[200:203], v[156:159]
    s_waitcnt lgkmcnt(0)
    v_exp_f32 v53, v53
    v_mfma_f32_32x32x16_bf16 v[32:47], a[68:71], a[44:47], 0
    s_waitcnt vmcnt(27)
    v_cvt_pk_bf16_f32 v73, v50, v51
    v_exp_f32 v54, v54
    v_exp_f32_e64 v55, v55
    v_cvt_pk_bf16_f32 v74, v52, v53
    v_mfma_f32_16x16x32_bf16 v[160:163], a[100:103], a[188:191], v[160:163]
    ds_read_b128 a[84:87], v3 offset:14336
    v_exp_f32_e64 v56, v56
    v_mfma_f32_32x32x16_bf16 v[32:47], a[72:75], a[48:51], v[32:47]
    global_load_dwordx4 a[96:99], v4, s[14:15] offset:1024 sc1
    v_exp_f32_e64 v57, v57
    v_cvt_pk_bf16_f32 v75, v54, v55
    v_exp_f32_e64 v58, v58
    v_mfma_f32_16x16x32_bf16 v[164:167], a[100:103], a[192:195], v[164:167]
    ds_read_b128 a[88:91], v3 offset:15360
    v_exp_f32_e64 v59, v59
    v_mfma_f32_16x16x32_bf16 v[168:171], a[100:103], a[196:199], v[168:171]
    global_load_lds_dwordx4 v2, s[16:17] offset:2048 sc1
    v_cvt_pk_bf16_f32 v76, v56, v57
    v_mfma_f32_32x32x16_bf16 v[96:111], a[76:79], v[64:67], v[96:111]
    global_load_dwordx4 a[180:183], v1, s[12:13] offset:2048 sc1
    v_exp_f32 v60, v60
    v_exp_f32 v61, v61
    v_cvt_pk_bf16_f32 v77, v58, v59
    v_mfma_f32_16x16x32_bf16 v[172:175], a[100:103], a[200:203], v[172:175]
    v_exp_f32_e64 v62, v62
    v_mfma_f32_16x16x32_bf16 a[32:35], a[40:43], v[64:67], a[32:35]
    s_waitcnt vmcnt(28)
    v_exp_f32 v63, v63
    v_mfma_f32_16x16x32_bf16 v[176:179], a[104:107], a[188:191], v[176:179]
    v_cvt_pk_bf16_f32 v78, v60, v61
    v_cvt_pk_bf16_f32 v79, v62, v63
    v_mfma_f32_32x32x16_bf16 v[96:111], a[80:83], v[68:71], v[96:111]
    global_load_dwordx4 a[100:103], v5, s[14:15] offset:0 sc1
    v_exp_f32 v32, v32
    v_exp_f32 v33, v33
    v_exp_f32_e64 v34, v34
    v_mfma_f32_16x16x32_bf16 v[180:183], a[104:107], a[192:195], v[180:183]
    global_load_lds_dwordx4 v2, s[16:17] offset:3072 sc1
    v_exp_f32_e64 v35, v35
    v_mfma_f32_16x16x32_bf16 v[184:187], a[104:107], a[196:199], v[184:187]
    s_add_u32 s16, s16, 0x8000
    s_addc_u32 s17, s17, 0
    v_cvt_pk_bf16_f32 v64, v32, v33
    v_mfma_f32_16x16x32_bf16 a[32:35], a[40:43], v[68:71], a[32:35]
    global_load_dwordx4 a[184:187], v1, s[12:13] offset:3072 sc1
    v_exp_f32 v36, v36
    v_mfma_f32_16x16x32_bf16 v[188:191], a[104:107], a[200:203], v[188:191]
    s_xor_b32 s34, s34, 0x8000
    v_exp_f32_e64 v37, v37
    v_mfma_f32_32x32x16_bf16 v[48:63], a[68:71], a[52:55], 0
    s_waitcnt vmcnt(30)
    v_cvt_pk_bf16_f32 v65, v34, v35
    v_exp_f32 v38, v38
    v_exp_f32_e64 v39, v39
    v_cvt_pk_bf16_f32 v66, v36, v37
    v_mfma_f32_16x16x32_bf16 v[192:195], a[108:111], a[188:191], v[192:195]
    ds_read_b128 a[60:63], v3 offset:16384
    v_exp_f32_e64 v40, v40
    v_mfma_f32_32x32x16_bf16 v[48:63], a[72:75], a[56:59], v[48:63]
    global_load_dwordx4 a[104:107], v5, s[14:15] offset:1024 sc1
    v_exp_f32_e64 v41, v41
    v_cvt_pk_bf16_f32 v67, v38, v39
    v_exp_f32_e64 v42, v42
    v_mfma_f32_16x16x32_bf16 v[196:199], a[108:111], a[192:195], v[196:199]
    ds_read_b128 a[64:67], v3 offset:17408
    v_exp_f32_e64 v43, v43
    v_mfma_f32_16x16x32_bf16 v[200:203], a[108:111], a[196:199], v[200:203]
    v_cvt_pk_bf16_f32 v68, v40, v41
    v_exp_f32_e64 v44, v44
    v_mfma_f32_32x32x16_bf16 v[112:127], a[76:79], v[72:75], v[112:127]
    v_exp_f32_e64 v45, v45
    v_cvt_pk_bf16_f32 v69, v42, v43
    v_exp_f32 v46, v46
    v_exp_f32 v47, v47
    v_mfma_f32_16x16x32_bf16 v[204:207], a[108:111], a[200:203], v[204:207]
    v_cvt_pk_bf16_f32 v70, v44, v45
    v_cvt_pk_bf16_f32 v71, v46, v47
    v_mfma_f32_16x16x32_bf16 a[36:39], a[40:43], v[72:75], a[36:39]
    s_waitcnt vmcnt(30)
    v_exp_f32 v48, v48
    v_mfma_f32_16x16x32_bf16 v[208:211], a[112:115], a[188:191], v[208:211]
    v_exp_f32_e64 v49, v49
    v_mfma_f32_32x32x16_bf16 v[112:127], a[80:83], v[76:79], v[112:127]
    global_load_dwordx4 a[108:111], v6, s[14:15] offset:0 sc1
    v_exp_f32 v50, v50
    v_exp_f32 v51, v51
    v_cvt_pk_bf16_f32 v72, v48, v49
    v_mfma_f32_16x16x32_bf16 v[212:215], a[112:115], a[192:195], v[212:215]
    v_exp_f32_e64 v52, v52
    v_mfma_f32_16x16x32_bf16 v[216:219], a[112:115], a[196:199], v[216:219]
    v_exp_f32_e64 v53, v53
    v_mfma_f32_16x16x32_bf16 a[36:39], a[40:43], v[76:79], a[36:39]
    v_cvt_pk_bf16_f32 v73, v50, v51
    v_exp_f32_e64 v54, v54
    v_mfma_f32_16x16x32_bf16 v[220:223], a[112:115], a[200:203], v[220:223]
    s_waitcnt lgkmcnt(0)
    v_exp_f32 v55, v55
    v_mfma_f32_32x32x16_bf16 v[32:47], a[60:63], a[44:47], 0
    s_waitcnt vmcnt(30)
    v_cvt_pk_bf16_f32 v74, v52, v53
    v_exp_f32 v56, v56
    v_exp_f32_e64 v57, v57
    v_cvt_pk_bf16_f32 v75, v54, v55
    v_mfma_f32_16x16x32_bf16 v[224:227], a[116:119], a[188:191], v[224:227]
    ds_read_b128 a[76:79], v3 offset:18432
    v_exp_f32_e64 v58, v58
    v_mfma_f32_32x32x16_bf16 v[32:47], a[64:67], a[48:51], v[32:47]
    global_load_dwordx4 a[112:115], v6, s[14:15] offset:1024 sc1
    v_exp_f32_e64 v59, v59
    v_cvt_pk_bf16_f32 v76, v56, v57
    v_exp_f32_e64 v60, v60
    v_mfma_f32_16x16x32_bf16 v[228:231], a[116:119], a[192:195], v[228:231]
    ds_read_b128 a[80:83], v3 offset:19456
    v_exp_f32_e64 v61, v61
    v_mfma_f32_16x16x32_bf16 v[232:235], a[116:119], a[196:199], v[232:235]
    v_cvt_pk_bf16_f32 v77, v58, v59
    v_exp_f32_e64 v62, v62
    v_mfma_f32_32x32x16_bf16 v[96:111], a[84:87], v[64:67], v[96:111]
    v_exp_f32_e64 v63, v63
    v_cvt_pk_bf16_f32 v78, v60, v61
    v_cvt_pk_bf16_f32 v79, v62, v63
    v_exp_f32_e64 v32, v32
    v_mfma_f32_16x16x32_bf16 v[236:239], a[116:119], a[200:203], v[236:239]
    v_exp_f32_e64 v33, v33
    v_mfma_f32_16x16x32_bf16 a[32:35], a[40:43], v[64:67], a[32:35]
    s_waitcnt vmcnt(30)
    v_exp_f32 v34, v34
    v_mfma_f32_16x16x32_bf16 v[240:243], a[120:123], a[188:191], v[240:243]
    v_exp_f32_e64 v35, v35
    v_mfma_f32_32x32x16_bf16 v[96:111], a[88:91], v[68:71], v[96:111]
    global_load_dwordx4 a[116:119], v7, s[14:15] offset:0 sc1
    v_cvt_pk_bf16_f32 v64, v32, v33
    v_exp_f32 v36, v36
    v_exp_f32 v37, v37
    v_mfma_f32_16x16x32_bf16 v[244:247], a[120:123], a[192:195], v[244:247]
    v_cvt_pk_bf16_f32 v65, v34, v35
    v_exp_f32_e64 v38, v38
    v_mfma_f32_16x16x32_bf16 v[248:251], a[120:123], a[196:199], v[248:251]
    v_exp_f32_e64 v39, v39
    v_mfma_f32_16x16x32_bf16 a[32:35], a[40:43], v[68:71], a[32:35]
    v_cvt_pk_bf16_f32 v66, v36, v37
    v_exp_f32_e64 v40, v40
    v_mfma_f32_16x16x32_bf16 v[252:255], a[120:123], a[200:203], v[252:255]
    v_exp_f32_e64 v41, v41
    v_mfma_f32_32x32x16_bf16 v[48:63], a[60:63], a[52:55], 0
    s_waitcnt vmcnt(29)
    v_cvt_pk_bf16_f32 v67, v38, v39
    v_exp_f32 v42, v42
    v_exp_f32_e64 v43, v43
    v_cvt_pk_bf16_f32 v68, v40, v41
    v_mfma_f32_16x16x32_bf16 v[128:131], a[124:127], a[204:207], v[128:131]
    ds_read_b128 a[68:71], v3 offset:20480
    s_add_u32 s12, s12, 0x2000
    s_addc_u32 s13, s13, 0
    v_mfma_f32_32x32x16_bf16 v[48:63], a[64:67], a[56:59], v[48:63]
    global_load_dwordx4 a[120:123], v7, s[14:15] offset:1024 sc1
    v_exp_f32 v44, v44
    v_exp_f32_e64 v45, v45
    v_cvt_pk_bf16_f32 v69, v42, v43
    v_mfma_f32_16x16x32_bf16 v[132:135], a[124:127], a[208:211], v[132:135]
    ds_read_b128 a[72:75], v3 offset:21504
    v_exp_f32_e64 v46, v46
    v_mfma_f32_16x16x32_bf16 v[136:139], a[124:127], a[212:215], v[136:139]
    s_add_u32 s14, s14, 0x2000
    s_addc_u32 s15, s15, 0
    v_exp_f32 v47, v47
    v_mfma_f32_32x32x16_bf16 v[112:127], a[84:87], v[72:75], v[112:127]
    global_load_dwordx4 a[188:191], v1, s[12:13] offset:0 sc1
    v_cvt_pk_bf16_f32 v70, v44, v45
    v_cvt_pk_bf16_f32 v71, v46, v47
    v_exp_f32 v48, v48
    v_exp_f32 v49, v49
    v_mfma_f32_16x16x32_bf16 v[140:143], a[124:127], a[216:219], v[140:143]
    v_exp_f32_e64 v50, v50
    v_mfma_f32_16x16x32_bf16 a[36:39], a[40:43], v[72:75], a[36:39]
    s_waitcnt vmcnt(29)
    v_exp_f32 v51, v51
    v_mfma_f32_16x16x32_bf16 v[144:147], a[128:131], a[204:207], v[144:147]
    v_cvt_pk_bf16_f32 v72, v48, v49
    v_exp_f32_e64 v52, v52
    v_mfma_f32_32x32x16_bf16 v[112:127], a[88:91], v[76:79], v[112:127]
    global_load_dwordx4 a[124:127], v4, s[14:15] offset:0 sc1
    v_exp_f32_e64 v53, v53
    v_cvt_pk_bf16_f32 v73, v50, v51
    v_exp_f32_e64 v54, v54
    v_mfma_f32_16x16x32_bf16 v[148:151], a[128:131], a[208:211], v[148:151]
    v_exp_f32_e64 v55, v55
    v_mfma_f32_16x16x32_bf16 v[152:155], a[128:131], a[212:215], v[152:155]
    v_cvt_pk_bf16_f32 v74, v52, v53
    v_exp_f32_e64 v56, v56
    v_mfma_f32_16x16x32_bf16 a[36:39], a[40:43], v[76:79], a[36:39]
    global_load_dwordx4 a[192:195], v1, s[12:13] offset:1024 sc1
    v_exp_f32_e64 v57, v57
    v_mfma_f32_16x16x32_bf16 v[156:159], a[128:131], a[216:219], v[156:159]
    s_waitcnt lgkmcnt(0)
    v_cvt_pk_bf16_f32 v75, v54, v55
    v_exp_f32 v58, v58
    v_mfma_f32_32x32x16_bf16 v[32:47], a[68:71], a[44:47], 0
    s_waitcnt vmcnt(28)
    v_exp_f32 v59, v59
    v_cvt_pk_bf16_f32 v76, v56, v57
    v_exp_f32 v60, v60
    v_exp_f32 v61, v61
    v_mfma_f32_16x16x32_bf16 v[160:163], a[132:135], a[204:207], v[160:163]
    ds_read_b128 a[84:87], v3 offset:22528
    s_mov_b32 m0, s35
    v_mfma_f32_32x32x16_bf16 v[32:47], a[72:75], a[48:51], v[32:47]
    global_load_dwordx4 a[128:131], v4, s[14:15] offset:1024 sc1
    v_cvt_pk_bf16_f32 v77, v58, v59
    v_exp_f32 v62, v62
    v_exp_f32_e64 v63, v63
    v_mfma_f32_16x16x32_bf16 v[164:167], a[132:135], a[208:211], v[164:167]
    ds_read_b128 a[88:91], v3 offset:23552
    v_cvt_pk_bf16_f32 v78, v60, v61
    v_mfma_f32_16x16x32_bf16 v[168:171], a[132:135], a[212:215], v[168:171]
    global_load_lds_dwordx4 v1, s[18:19] offset:0 sc1
    v_cvt_pk_bf16_f32 v79, v62, v63
    v_mfma_f32_32x32x16_bf16 v[96:111], a[76:79], v[64:67], v[96:111]
    global_load_dwordx4 a[196:199], v1, s[12:13] offset:2048 sc1
    v_exp_f32 v32, v32
    v_exp_f32 v33, v33
    v_exp_f32_e64 v34, v34
    v_mfma_f32_16x16x32_bf16 v[172:175], a[132:135], a[216:219], v[172:175]
    v_exp_f32_e64 v35, v35
    v_mfma_f32_16x16x32_bf16 a[32:35], a[40:43], v[64:67], a[32:35]
    s_waitcnt vmcnt(28)
    v_cvt_pk_bf16_f32 v64, v32, v33
    v_exp_f32 v36, v36
    v_mfma_f32_16x16x32_bf16 v[176:179], a[136:139], a[204:207], v[176:179]
    v_exp_f32_e64 v37, v37
    v_mfma_f32_32x32x16_bf16 v[96:111], a[80:83], v[68:71], v[96:111]
    global_load_dwordx4 a[132:135], v5, s[14:15] offset:0 sc1
    v_cvt_pk_bf16_f32 v65, v34, v35
    v_exp_f32 v38, v38
    v_exp_f32 v39, v39
    v_mfma_f32_16x16x32_bf16 v[180:183], a[136:139], a[208:211], v[180:183]
    global_load_lds_dwordx4 v1, s[18:19] offset:1024 sc1
    v_cvt_pk_bf16_f32 v66, v36, v37
    v_mfma_f32_16x16x32_bf16 v[184:187], a[136:139], a[212:215], v[184:187]
    v_exp_f32_e64 v40, v40
    v_mfma_f32_16x16x32_bf16 a[32:35], a[40:43], v[68:71], a[32:35]
    global_load_dwordx4 a[200:203], v1, s[12:13] offset:3072 sc1
    v_exp_f32_e64 v41, v41
    v_mfma_f32_16x16x32_bf16 v[188:191], a[136:139], a[216:219], v[188:191]
    v_cvt_pk_bf16_f32 v67, v38, v39
    v_exp_f32_e64 v42, v42
    v_mfma_f32_32x32x16_bf16 v[48:63], a[68:71], a[52:55], 0
    s_waitcnt vmcnt(29)
    v_exp_f32 v43, v43
    v_cvt_pk_bf16_f32 v68, v40, v41
    v_exp_f32 v44, v44
    v_exp_f32 v45, v45
    v_mfma_f32_16x16x32_bf16 v[192:195], a[140:143], a[204:207], v[192:195]
    ds_read_b128 a[60:63], v3 offset:24576
    v_cvt_pk_bf16_f32 v69, v42, v43
    v_mfma_f32_32x32x16_bf16 v[48:63], a[72:75], a[56:59], v[48:63]
    global_load_dwordx4 a[136:139], v5, s[14:15] offset:1024 sc1
    v_exp_f32 v46, v46
    v_exp_f32 v47, v47
    v_cvt_pk_bf16_f32 v70, v44, v45
    v_mfma_f32_16x16x32_bf16 v[196:199], a[140:143], a[208:211], v[196:199]
    ds_read_b128 a[64:67], v3 offset:25600
    v_cvt_pk_bf16_f32 v71, v46, v47
    v_mfma_f32_16x16x32_bf16 v[200:203], a[140:143], a[212:215], v[200:203]
    v_mfma_f32_32x32x16_bf16 v[112:127], a[76:79], v[72:75], v[112:127]
    global_load_lds_dwordx4 v1, s[18:19] offset:2048 sc1
    v_mfma_f32_16x16x32_bf16 v[204:207], a[140:143], a[216:219], v[204:207]
    v_mfma_f32_16x16x32_bf16 a[36:39], a[40:43], v[72:75], a[36:39]
    s_waitcnt vmcnt(29)
    v_exp_f32 v48, v48
    v_mfma_f32_16x16x32_bf16 v[208:211], a[144:147], a[204:207], v[208:211]
    v_exp_f32_e64 v49, v49
    v_mfma_f32_32x32x16_bf16 v[112:127], a[80:83], v[76:79], v[112:127]
    global_load_dwordx4 a[140:143], v6, s[14:15] offset:0 sc1
    v_exp_f32 v50, v50
    v_exp_f32 v51, v51
    v_cvt_pk_bf16_f32 v72, v48, v49
    v_mfma_f32_16x16x32_bf16 v[212:215], a[144:147], a[208:211], v[212:215]
    global_load_lds_dwordx4 v1, s[18:19] offset:3072 sc1
    v_exp_f32_e64 v52, v52
    v_mfma_f32_16x16x32_bf16 v[216:219], a[144:147], a[212:215], v[216:219]
    s_add_u32 s18, s18, 0x1000
    s_addc_u32 s19, s19, 0
    v_exp_f32 v53, v53
    v_mfma_f32_16x16x32_bf16 a[36:39], a[40:43], v[76:79], a[36:39]
    s_add_u32 s35, s35, 4096
    v_cvt_pk_bf16_f32 v73, v50, v51
    v_exp_f32_e64 v54, v54
    v_mfma_f32_16x16x32_bf16 v[220:223], a[144:147], a[216:219], v[220:223]
    s_waitcnt lgkmcnt(0)
    v_exp_f32 v55, v55
    v_mfma_f32_32x32x16_bf16 v[32:47], a[60:63], a[44:47], 0
    s_waitcnt vmcnt(30)
    v_cvt_pk_bf16_f32 v74, v52, v53
    v_exp_f32 v56, v56
    v_exp_f32_e64 v57, v57
    v_cvt_pk_bf16_f32 v75, v54, v55
    v_mfma_f32_16x16x32_bf16 v[224:227], a[148:151], a[204:207], v[224:227]
    ds_read_b128 a[76:79], v3 offset:26624
    v_exp_f32_e64 v58, v58
    v_mfma_f32_32x32x16_bf16 v[32:47], a[64:67], a[48:51], v[32:47]
    global_load_dwordx4 a[144:147], v6, s[14:15] offset:1024 sc1
    v_exp_f32_e64 v59, v59
    v_cvt_pk_bf16_f32 v76, v56, v57
    v_exp_f32_e64 v60, v60
    v_mfma_f32_16x16x32_bf16 v[228:231], a[148:151], a[208:211], v[228:231]
    ds_read_b128 a[80:83], v3 offset:27648
    v_exp_f32_e64 v61, v61
    v_mfma_f32_16x16x32_bf16 v[232:235], a[148:151], a[212:215], v[232:235]
    s_sub_u32 s39, s39, 1
    v_cvt_pk_bf16_f32 v77, v58, v59
    v_exp_f32 v62, v62
    v_mfma_f32_32x32x16_bf16 v[96:111], a[84:87], v[64:67], v[96:111]
    s_cmp_eq_u32 s39, 4
    s_cselect_b32 s18, s32, s18
    s_cselect_b32 s19, s33, s19
    v_exp_f32 v63, v63
    v_cvt_pk_bf16_f32 v78, v60, v61
    v_cvt_pk_bf16_f32 v79, v62, v63
    v_mfma_f32_16x16x32_bf16 v[236:239], a[148:151], a[216:219], v[236:239]
    s_cmp_eq_u32 s39, 1
    s_cselect_b32 s16, s66, s16
    s_cselect_b32 s17, s67, s17
    v_mfma_f32_16x16x32_bf16 a[32:35], a[40:43], v[64:67], a[32:35]
    s_waitcnt vmcnt(30)
    v_exp_f32_e64 v32, v32
    v_mfma_f32_16x16x32_bf16 v[240:243], a[152:155], a[204:207], v[240:243]
    v_exp_f32_e64 v33, v33
    v_mfma_f32_32x32x16_bf16 v[96:111], a[88:91], v[68:71], v[96:111]
    global_load_dwordx4 a[148:151], v7, s[14:15] offset:0 sc1
    v_exp_f32 v34, v34
    v_exp_f32 v35, v35
    v_cvt_pk_bf16_f32 v64, v32, v33
    v_mfma_f32_16x16x32_bf16 v[244:247], a[152:155], a[208:211], v[244:247]
    v_exp_f32_e64 v36, v36
    v_mfma_f32_16x16x32_bf16 v[248:251], a[152:155], a[212:215], v[248:251]
    v_exp_f32_e64 v37, v37
    v_mfma_f32_16x16x32_bf16 a[32:35], a[40:43], v[68:71], a[32:35]
    v_cvt_pk_bf16_f32 v65, v34, v35
    v_exp_f32_e64 v38, v38
    v_mfma_f32_16x16x32_bf16 v[252:255], a[152:155], a[216:219], v[252:255]
    v_exp_f32_e64 v39, v39
    v_mfma_f32_32x32x16_bf16 v[48:63], a[60:63], a[52:55], 0
    s_waitcnt vmcnt(28)
    v_cvt_pk_bf16_f32 v66, v36, v37
    v_exp_f32 v40, v40
    v_exp_f32_e64 v41, v41
    v_cvt_pk_bf16_f32 v67, v38, v39
    v_mfma_f32_16x16x32_bf16 v[128:131], a[92:95], a[156:159], v[128:131]
    ds_read_b128 a[68:71], v3 offset:28672
    s_add_u32 s12, s12, 0x2000
    s_addc_u32 s13, s13, 0
    v_mfma_f32_32x32x16_bf16 v[48:63], a[64:67], a[56:59], v[48:63]
    global_load_dwordx4 a[152:155], v7, s[14:15] offset:1024 sc1
    v_exp_f32 v42, v42
    v_exp_f32_e64 v43, v43
    v_cvt_pk_bf16_f32 v68, v40, v41
    v_mfma_f32_16x16x32_bf16 v[132:135], a[92:95], a[160:163], v[132:135]
    ds_read_b128 a[72:75], v3 offset:29696
    v_exp_f32_e64 v44, v44
    v_mfma_f32_16x16x32_bf16 v[136:139], a[92:95], a[164:167], v[136:139]
    s_add_u32 s14, s14, 0x2000
    s_addc_u32 s15, s15, 0
    v_exp_f32 v45, v45
    v_mfma_f32_32x32x16_bf16 v[112:127], a[84:87], v[72:75], v[112:127]
    global_load_dwordx4 a[204:207], v1, s[12:13] offset:0 sc1
    v_cvt_pk_bf16_f32 v69, v42, v43
    v_exp_f32 v46, v46
    v_exp_f32 v47, v47
    v_mfma_f32_16x16x32_bf16 v[140:143], a[92:95], a[168:171], v[140:143]
    v_cvt_pk_bf16_f32 v70, v44, v45
    v_cvt_pk_bf16_f32 v71, v46, v47
    v_mfma_f32_16x16x32_bf16 a[36:39], a[40:43], v[72:75], a[36:39]
    s_waitcnt vmcnt(27)
    v_exp_f32 v48, v48
    v_mfma_f32_16x16x32_bf16 v[144:147], a[96:99], a[156:159], v[144:147]
    v_exp_f32_e64 v49, v49
    v_mfma_f32_32x32x16_bf16 v[112:127], a[88:91], v[76:79], v[112:127]
    global_load_dwordx4 a[92:95], v4, s[14:15] offset:0 sc1
    v_exp_f32 v50, v50
    v_exp_f32 v51, v51
    v_cvt_pk_bf16_f32 v72, v48, v49
    v_mfma_f32_16x16x32_bf16 v[148:151], a[96:99], a[160:163], v[148:151]
    v_exp_f32_e64 v52, v52
    v_mfma_f32_16x16x32_bf16 v[152:155], a[96:99], a[164:167], v[152:155]
    v_exp_f32_e64 v53, v53
    v_mfma_f32_16x16x32_bf16 a[36:39], a[40:43], v[76:79], a[36:39]
    global_load_dwordx4 a[208:211], v1, s[12:13] offset:1024 sc1
    v_cvt_pk_bf16_f32 v73, v50, v51
    v_mfma_f32_16x16x32_bf16 v[156:159], a[96:99], a[168:171], v[156:159]
    s_waitcnt lgkmcnt(0)
    v_exp_f32 v54, v54
    v_mfma_f32_32x32x16_bf16 v[32:47], a[68:71], a[44:47], 0
    s_waitcnt vmcnt(26)
    v_exp_f32 v55, v55
    v_cvt_pk_bf16_f32 v74, v52, v53
    v_exp_f32 v56, v56
    v_exp_f32 v57, v57
    v_mfma_f32_16x16x32_bf16 v[160:163], a[100:103], a[156:159], v[160:163]
    ds_read_b128 a[84:87], v3 offset:30720
    v_cvt_pk_bf16_f32 v75, v54, v55
    v_mfma_f32_32x32x16_bf16 v[32:47], a[72:75], a[48:51], v[32:47]
    global_load_dwordx4 a[96:99], v4, s[14:15] offset:1024 sc1
    v_exp_f32 v58, v58
    v_exp_f32 v59, v59
    v_cvt_pk_bf16_f32 v76, v56, v57
    v_mfma_f32_16x16x32_bf16 v[164:167], a[100:103], a[160:163], v[164:167]
    ds_read_b128 a[88:91], v3 offset:31744
    v_exp_f32_e64 v60, v60
    v_mfma_f32_16x16x32_bf16 v[168:171], a[100:103], a[164:167], v[168:171]
    v_exp_f32_e64 v61, v61
    v_mfma_f32_32x32x16_bf16 v[96:111], a[76:79], v[64:67], v[96:111]
    global_load_dwordx4 a[212:215], v1, s[12:13] offset:2048 sc1
    v_cvt_pk_bf16_f32 v77, v58, v59
    v_exp_f32 v62, v62
    v_exp_f32 v63, v63
    v_mfma_f32_16x16x32_bf16 v[172:175], a[100:103], a[168:171], v[172:175]
    v_cvt_pk_bf16_f32 v78, v60, v61
    v_cvt_pk_bf16_f32 v79, v62, v63
    v_mfma_f32_16x16x32_bf16 a[32:35], a[40:43], v[64:67], a[32:35]
    s_waitcnt vmcnt(25)
    v_exp_f32 v32, v32
    v_mfma_f32_16x16x32_bf16 v[176:179], a[104:107], a[156:159], v[176:179]
    v_exp_f32_e64 v33, v33
    v_mfma_f32_32x32x16_bf16 v[96:111], a[80:83], v[68:71], v[96:111]
    global_load_dwordx4 a[100:103], v5, s[14:15] offset:0 sc1
    v_exp_f32 v34, v34
    v_exp_f32 v35, v35
    v_cvt_pk_bf16_f32 v64, v32, v33
    v_mfma_f32_16x16x32_bf16 v[180:183], a[104:107], a[160:163], v[180:183]
    v_exp_f32_e64 v36, v36
    v_mfma_f32_16x16x32_bf16 v[184:187], a[104:107], a[164:167], v[184:187]
    v_exp_f32_e64 v37, v37
    v_mfma_f32_16x16x32_bf16 a[32:35], a[40:43], v[68:71], a[32:35]
    global_load_dwordx4 a[216:219], v1, s[12:13] offset:3072 sc1
    v_cvt_pk_bf16_f32 v65, v34, v35
    v_mfma_f32_16x16x32_bf16 v[188:191], a[104:107], a[168:171], v[188:191]
    global_load_dwordx4 a[104:107], v5, s[14:15] offset:1024 sc1
    v_exp_f32_e64 v38, v38
    v_mfma_f32_32x32x16_bf16 v[48:63], a[68:71], a[52:55], 0
    s_waitcnt lgkmcnt(0)
    s_barrier
    v_xor_b32 v3, 0x8000, v3
    s_waitcnt vmcnt(27)
    v_exp_f32 v39, v39
    v_cvt_pk_bf16_f32 v66, v36, v37
    v_mfma_f32_16x16x32_bf16 v[192:195], a[108:111], a[156:159], v[192:195]
    v_exp_f32_e64 v40, v40
    v_mfma_f32_32x32x16_bf16 v[48:63], a[72:75], a[56:59], v[48:63]
    ds_read_b128 a[60:63], v3 offset:0
    v_exp_f32_e64 v41, v41
    v_cvt_pk_bf16_f32 v67, v38, v39
    v_exp_f32_e64 v42, v42
    v_mfma_f32_16x16x32_bf16 v[196:199], a[108:111], a[160:163], v[196:199]
    v_exp_f32_e64 v43, v43
    v_mfma_f32_16x16x32_bf16 v[200:203], a[108:111], a[164:167], v[200:203]
    ds_read_b128 a[64:67], v3 offset:1024
    v_cvt_pk_bf16_f32 v68, v40, v41
    v_mfma_f32_32x32x16_bf16 v[112:127], a[76:79], v[72:75], v[112:127]
    v_exp_f32 v44, v44
    v_exp_f32 v45, v45
    v_cvt_pk_bf16_f32 v69, v42, v43
    v_exp_f32_e64 v46, v46
    v_mfma_f32_16x16x32_bf16 v[204:207], a[108:111], a[168:171], v[204:207]
    v_exp_f32_e64 v47, v47
    v_mfma_f32_16x16x32_bf16 a[36:39], a[40:43], v[72:75], a[36:39]
    s_waitcnt vmcnt(26)
    v_cvt_pk_bf16_f32 v70, v44, v45
    v_cvt_pk_bf16_f32 v71, v46, v47
    v_mfma_f32_16x16x32_bf16 v[208:211], a[112:115], a[156:159], v[208:211]
    v_exp_f32 v48, v48
    v_mfma_f32_32x32x16_bf16 v[112:127], a[80:83], v[76:79], v[112:127]
    global_load_dwordx4 a[108:111], v6, s[14:15] offset:0 sc1
    v_exp_f32 v49, v49
    v_exp_f32 v50, v50
    v_exp_f32_e64 v51, v51
    v_mfma_f32_16x16x32_bf16 v[212:215], a[112:115], a[160:163], v[212:215]
    v_cvt_pk_bf16_f32 v72, v48, v49
    v_exp_f32_e64 v52, v52
    v_mfma_f32_16x16x32_bf16 v[216:219], a[112:115], a[164:167], v[216:219]
    v_exp_f32_e64 v53, v53
    v_mfma_f32_16x16x32_bf16 a[36:39], a[40:43], v[76:79], a[36:39]
    v_cvt_pk_bf16_f32 v73, v50, v51
    v_exp_f32_e64 v54, v54
    v_mfma_f32_16x16x32_bf16 v[220:223], a[112:115], a[168:171], v[220:223]
    s_waitcnt lgkmcnt(0)
    v_exp_f32 v55, v55
    v_mfma_f32_32x32x16_bf16 v[32:47], a[60:63], a[44:47], 0
    s_waitcnt vmcnt(26)
    v_cvt_pk_bf16_f32 v74, v52, v53
    v_exp_f32 v56, v56
    v_exp_f32_e64 v57, v57
    v_cvt_pk_bf16_f32 v75, v54, v55
    v_mfma_f32_16x16x32_bf16 v[224:227], a[116:119], a[156:159], v[224:227]
    ds_read_b128 a[76:79], v3 offset:2048
    v_exp_f32_e64 v58, v58
    v_mfma_f32_32x32x16_bf16 v[32:47], a[64:67], a[48:51], v[32:47]
    global_load_dwordx4 a[112:115], v6, s[14:15] offset:1024 sc1
    v_exp_f32_e64 v59, v59
    v_cvt_pk_bf16_f32 v76, v56, v57
    v_exp_f32_e64 v60, v60
    v_mfma_f32_16x16x32_bf16 v[228:231], a[116:119], a[160:163], v[228:231]
    ds_read_b128 a[80:83], v3 offset:3072
    v_exp_f32_e64 v61, v61
    v_mfma_f32_16x16x32_bf16 v[232:235], a[116:119], a[164:167], v[232:235]
    v_cvt_pk_bf16_f32 v77, v58, v59
    v_exp_f32_e64 v62, v62
    v_mfma_f32_32x32x16_bf16 v[96:111], a[84:87], v[64:67], v[96:111]
    v_exp_f32_e64 v63, v63
    v_cvt_pk_bf16_f32 v78, v60, v61
    v_cvt_pk_bf16_f32 v79, v62, v63
    v_mfma_f32_16x16x32_bf16 v[236:239], a[116:119], a[168:171], v[236:239]
    v_mfma_f32_16x16x32_bf16 a[32:35], a[40:43], v[64:67], a[32:35]
    s_waitcnt vmcnt(26)
    v_mfma_f32_16x16x32_bf16 v[240:243], a[120:123], a[156:159], v[240:243]
    v_mfma_f32_32x32x16_bf16 v[96:111], a[88:91], v[68:71], v[96:111]
    global_load_dwordx4 a[116:119], v7, s[14:15] offset:0 sc1
    v_mfma_f32_16x16x32_bf16 v[244:247], a[120:123], a[160:163], v[244:247]
    v_mfma_f32_16x16x32_bf16 v[248:251], a[120:123], a[164:167], v[248:251]
    v_mfma_f32_16x16x32_bf16 a[32:35], a[40:43], v[68:71], a[32:35]
    v_mfma_f32_16x16x32_bf16 v[252:255], a[120:123], a[168:171], v[252:255]
    global_load_dwordx4 a[120:123], v7, s[14:15] offset:1024 sc1
    s_cmp_lg_u32 s39, 0
    s_cbranch_scc1 KM_LOOP
KM_TAIL:
    s_nop 1
    v_mfma_f32_32x32x16_bf16 v[112:127], a[84:87], v[72:75], v[112:127]
    v_mfma_f32_16x16x32_bf16 a[36:39], a[40:43], v[72:75], a[36:39]
    v_mfma_f32_32x32x16_bf16 v[112:127], a[88:91], v[76:79], v[112:127]
    v_mfma_f32_16x16x32_bf16 a[36:39], a[40:43], v[76:79], a[36:39]
    s_waitcnt vmcnt(26)
    v_mfma_f32_16x16x32_bf16 v[128:131], a[124:127], a[172:175], v[128:131]
    v_bfe_u32 v26, v16, 4, 1
    s_lshl_b32 s78, s37, 1
    v_lshlrev_b32_e64 v26, 10, v26
    v_mfma_f32_16x16x32_bf16 v[132:135], a[124:127], a[176:179], v[132:135]
    s_lshr_b32 s79, s36, 1
    v_and_b32_e64 v27, 15, v16
    s_add_u32 s78, s78, s79
    v_lshl_add_u32 v26, v27, 4, v26
    v_mfma_f32_16x16x32_bf16 v[136:139], a[124:127], a[180:183], v[136:139]
    s_lshl_b32 s78, s78, 5
    v_lshrrev_b32_e64 v27, 5, v16
    s_add_u32 s78, s78, s38
    v_lshl_add_u32 v26, v27, 8, v26
    v_mfma_f32_16x16x32_bf16 v[140:143], a[124:127], a[184:187], v[140:143]
    s_waitcnt vmcnt(24)
    s_lshl_b32 s78, s78, 13
    s_and_b32 s79, s36, 1
    v_mfma_f32_16x16x32_bf16 v[144:147], a[128:131], a[172:175], v[144:147]
    s_lshl_b32 s79, s79, 12
    s_add_u32 s78, s78, s79
    v_mfma_f32_16x16x32_bf16 v[148:151], a[128:131], a[176:179], v[148:151]
    s_add_u32 s54, s78, 0x1300000
    s_mov_b32 s78, 0x1f800000
    v_mfma_f32_16x16x32_bf16 v[152:155], a[128:131], a[180:183], v[152:155]
    s_mov_b32 s79, 0x5f800000
    s_mov_b32 s55, 0
    v_accvgpr_read_b32 v80, a32
    v_mfma_f32_16x16x32_bf16 v[156:159], a[128:131], a[184:187], v[156:159]
    s_waitcnt vmcnt(21)
    v_accvgpr_read_b32 v81, a36
    v_min_f32 v83, v80, v81
    v_mfma_f32_16x16x32_bf16 v[160:163], a[132:135], a[172:175], v[160:163]
    v_max_f32 v84, v80, v81
    v_add_f32 v85, v80, v81
    v_mfma_f32_16x16x32_bf16 v[164:167], a[132:135], a[176:179], v[164:167]
    v_cmp_nle_f32 s[82:83], s78, v83
    v_cmp_nge_f32 s[84:85], s79, v84
    v_mfma_f32_16x16x32_bf16 v[168:171], a[132:135], a[180:183], v[168:171]
    v_cmp_u_f32 vcc, v85, v85
    s_nop 1
    s_or_b64 s[82:83], s[82:83], s[84:85]
    s_or_b64 vcc, vcc, s[82:83]
    s_cbranch_vccnz KM_FALLBACK
KM_NORM:
    v_rcp_f32 v80, v80
    v_mfma_f32_16x16x32_bf16 v[172:175], a[132:135], a[184:187], v[172:175]
    s_waitcnt vmcnt(18)
    v_rcp_f32 v82, v81
    v_mul_f32_e64 v80, v80, v22
    v_mfma_f32_16x16x32_bf16 v[176:179], a[136:139], a[172:175], v[176:179]
    v_mul_f32 v82, v82, v23
    v_mul_f32 v96, v96, v80
    v_mfma_f32_16x16x32_bf16 v[180:183], a[136:139], a[176:179], v[180:183]
    v_mul_f32 v97, v97, v80
    v_mul_f32 v98, v98, v80
    v_mfma_f32_16x16x32_bf16 v[184:187], a[136:139], a[180:183], v[184:187]
    v_mul_f32 v99, v99, v80
    v_mul_f32 v100, v100, v80
    v_mfma_f32_16x16x32_bf16 v[188:191], a[136:139], a[184:187], v[188:191]
    s_waitcnt vmcnt(16)
    ds_read_b128 a[124:127], v8 offset:0
    ds_read_b128 a[128:131], v8 offset:1024
    ds_read_b128 a[132:135], v9 offset:0
    ds_read_b128 a[136:139], v9 offset:1024
    v_mul_f32 v101, v101, v80
    v_mul_f32_e64 v102, v102, v80
    v_mfma_f32_16x16x32_bf16 v[192:195], a[140:143], a[172:175], v[192:195]
    v_mul_f32_e64 v103, v103, v80
    v_cvt_pk_bf16_f32 v64, v96, v97
    v_mfma_f32_16x16x32_bf16 v[196:199], a[140:143], a[176:179], v[196:199]
    v_cvt_pk_bf16_f32 v65, v98, v99
    v_cvt_pk_bf16_f32 v66, v100, v101
    v_mfma_f32_16x16x32_bf16 v[200:203], a[140:143], a[180:183], v[200:203]
    v_cvt_pk_bf16_f32 v67, v102, v103
    buffer_store_dwordx4 v[64:67], v26, s[24:27], s54 offen offset:0 sc1
    v_mfma_f32_16x16x32_bf16 v[204:207], a[140:143], a[184:187], v[204:207]
    s_waitcnt vmcnt(15)
    v_mul_f32 v104, v104, v80
    v_mul_f32_e64 v105, v105, v80
    v_mfma_f32_16x16x32_bf16 v[208:211], a[144:147], a[172:175], v[208:211]
    v_mul_f32 v106, v106, v80
    v_mul_f32 v107, v107, v80
    v_mfma_f32_16x16x32_bf16 v[212:215], a[144:147], a[176:179], v[212:215]
    v_mul_f32 v108, v108, v80
    v_mul_f32 v109, v109, v80
    v_mfma_f32_16x16x32_bf16 v[216:219], a[144:147], a[180:183], v[216:219]
    v_mul_f32 v110, v110, v80
    v_mul_f32 v111, v111, v80
    v_mfma_f32_16x16x32_bf16 v[220:223], a[144:147], a[184:187], v[220:223]
    s_waitcnt vmcnt(14)
    v_cvt_pk_bf16_f32 v68, v104, v105
    v_cvt_pk_bf16_f32 v69, v106, v107
    v_mfma_f32_16x16x32_bf16 v[224:227], a[148:151], a[172:175], v[224:227]
    v_cvt_pk_bf16_f32 v70, v108, v109
    v_cvt_pk_bf16_f32 v71, v110, v111
    v_mfma_f32_16x16x32_bf16 v[228:231], a[148:151], a[176:179], v[228:231]
    buffer_store_dwordx4 v[68:71], v26, s[24:27], s54 offen offset:512 sc1
    v_mul_f32 v112, v112, v82
    v_mfma_f32_16x16x32_bf16 v[232:235], a[148:151], a[180:183], v[232:235]
    v_mul_f32 v113, v113, v82
    v_mul_f32 v114, v114, v82
    v_mfma_f32_16x16x32_bf16 v[236:239], a[148:151], a[184:187], v[236:239]
    s_waitcnt vmcnt(14)
    v_mul_f32 v115, v115, v82
    v_mul_f32_e64 v116, v116, v82
    v_mfma_f32_16x16x32_bf16 v[240:243], a[152:155], a[172:175], v[240:243]
    v_mul_f32 v117, v117, v82
    v_mul_f32 v118, v118, v82
    v_mfma_f32_16x16x32_bf16 v[244:247], a[152:155], a[176:179], v[244:247]
    v_mul_f32_e64 v119, v119, v82
    v_cvt_pk_bf16_f32 v72, v112, v113
    v_mfma_f32_16x16x32_bf16 v[248:251], a[152:155], a[180:183], v[248:251]
    v_cvt_pk_bf16_f32 v73, v114, v115
    v_cvt_pk_bf16_f32 v74, v116, v117
    v_mfma_f32_16x16x32_bf16 v[252:255], a[152:155], a[184:187], v[252:255]
    ds_read_b128 a[140:143], v10 offset:0
    ds_read_b128 a[144:147], v10 offset:1024
    ds_read_b128 a[148:151], v11 offset:0
    ds_read_b128 a[152:155], v11 offset:1024
    v_cvt_pk_bf16_f32 v75, v118, v119
    buffer_store_dwordx4 v[72:75], v26, s[24:27], s54 offen offset:2048 sc1
    v_mul_f32 v120, v120, v82
    v_mul_f32 v121, v121, v82
    v_mul_f32 v122, v122, v82
    v_mul_f32 v123, v123, v82
    v_mul_f32 v124, v124, v82
    v_mul_f32 v125, v125, v82
    v_mul_f32 v126, v126, v82
    v_mul_f32 v127, v127, v82
    v_cvt_pk_bf16_f32 v76, v120, v121
    v_cvt_pk_bf16_f32 v77, v122, v123
    v_cvt_pk_bf16_f32 v78, v124, v125
    v_cvt_pk_bf16_f32 v79, v126, v127
    buffer_store_dwordx4 v[76:79], v26, s[24:27], s54 offen offset:2560 sc1
    s_nop 1
    v_mfma_f32_16x16x32_bf16 v[84:87], a[40:43], v[64:67], 0
    v_mfma_f32_16x16x32_bf16 v[84:87], a[40:43], v[68:71], v[84:87]
    v_mfma_f32_16x16x32_bf16 v[84:87], a[40:43], v[72:75], v[84:87]
    v_mfma_f32_16x16x32_bf16 v[84:87], a[40:43], v[76:79], v[84:87]
    v_and_b32 v25, 31, v16
    v_lshlrev_b32 v25, 7, v25
    s_lshr_b32 s78, s28, 1
    s_lshl_b32 s78, s78, 18
    s_add_u32 s78, s78, s42
    s_lshl_b32 s79, s36, 16
    s_add_u32 s78, s78, s79
    s_add_u32 s78, s78, 0x1300000
    s_add_u32 s56, s86, s78
    s_addc_u32 s57, s87, 0
    v_sub_f32_e64 v84, v84, v84
    s_cmp_lg_u32 s55, 0
    v_cmp_u_f32 vcc, v84, v84
    s_cbranch_scc1 KM_CHECKED
    s_cbranch_vccnz KM_FALLBACK2
KM_CHECKED:
    s_waitcnt vmcnt(0)
    s_mov_b64 exec, 1
    buffer_store_dword v24, off, s[24:27], s10 sc1
    s_mov_b64 exec, -1
    v_mfma_f32_16x16x32_bf16 v[128:131], a[92:95], a[188:191], v[128:131]
    v_mfma_f32_16x16x32_bf16 v[132:135], a[92:95], a[192:195], v[132:135]
    v_mfma_f32_16x16x32_bf16 v[136:139], a[92:95], a[196:199], v[136:139]
    v_mfma_f32_16x16x32_bf16 v[140:143], a[92:95], a[200:203], v[140:143]
    s_add_u32 s52, s32, 40960
    s_addc_u32 s53, s33, 0
    global_load_dwordx4 v[32:35], v4, s[52:53] offset:0 sc1
    v_mfma_f32_16x16x32_bf16 v[144:147], a[96:99], a[188:191], v[144:147]
    v_mfma_f32_16x16x32_bf16 v[148:151], a[96:99], a[192:195], v[148:151]
    global_load_dwordx4 v[36:39], v4, s[52:53] offset:1024 sc1
    v_mfma_f32_16x16x32_bf16 v[152:155], a[96:99], a[196:199], v[152:155]
    v_mfma_f32_16x16x32_bf16 v[156:159], a[96:99], a[200:203], v[156:159]
    global_load_dwordx4 v[40:43], v5, s[52:53] offset:0 sc1
    v_mfma_f32_16x16x32_bf16 v[160:163], a[100:103], a[188:191], v[160:163]
    v_mfma_f32_16x16x32_bf16 v[164:167], a[100:103], a[192:195], v[164:167]
    global_load_dwordx4 v[44:47], v5, s[52:53] offset:1024 sc1
    v_mfma_f32_16x16x32_bf16 v[168:171], a[100:103], a[196:199], v[168:171]
    v_mfma_f32_16x16x32_bf16 v[172:175], a[100:103], a[200:203], v[172:175]
    s_add_u32 s18, s32, 24576
    s_addc_u32 s19, s33, 0
    s_add_u32 m0, s31, 0
    s_waitcnt lgkmcnt(0)
    s_nop 0
    global_load_lds_dwordx4 v1, s[18:19] offset:0 sc1
    v_mfma_f32_16x16x32_bf16 v[176:179], a[104:107], a[188:191], v[176:179]
    v_mfma_f32_16x16x32_bf16 v[180:183], a[104:107], a[192:195], v[180:183]
    global_load_lds_dwordx4 v1, s[18:19] offset:1024 sc1
    v_mfma_f32_16x16x32_bf16 v[184:187], a[104:107], a[196:199], v[184:187]
    v_mfma_f32_16x16x32_bf16 v[188:191], a[104:107], a[200:203], v[188:191]
    ds_read_b128 a[92:95], v8 offset:8192
    ds_read_b128 a[96:99], v8 offset:9216
    ds_read_b128 a[100:103], v9 offset:8192
    ds_read_b128 a[104:107], v9 offset:9216
    global_load_lds_dwordx4 v1, s[18:19] offset:2048 sc1
    v_mfma_f32_16x16x32_bf16 v[192:195], a[108:111], a[188:191], v[192:195]
    v_mfma_f32_16x16x32_bf16 v[196:199], a[108:111], a[192:195], v[196:199]
    global_load_lds_dwordx4 v1, s[18:19] offset:3072 sc1
    v_mfma_f32_16x16x32_bf16 v[200:203], a[108:111], a[196:199], v[200:203]
    v_mfma_f32_16x16x32_bf16 v[204:207], a[108:111], a[200:203], v[204:207]
    s_add_u32 m0, s31, 4096
    s_nop 0
    global_load_lds_dwordx4 v2, s[18:19] offset:0 sc1
    v_mfma_f32_16x16x32_bf16 v[208:211], a[112:115], a[188:191], v[208:211]
    v_mfma_f32_16x16x32_bf16 v[212:215], a[112:115], a[192:195], v[212:215]
    global_load_lds_dwordx4 v2, s[18:19] offset:1024 sc1
    v_mfma_f32_16x16x32_bf16 v[216:219], a[112:115], a[196:199], v[216:219]
    v_mfma_f32_16x16x32_bf16 v[220:223], a[112:115], a[200:203], v[220:223]
    global_load_lds_dwordx4 v2, s[18:19] offset:2048 sc1
    v_mfma_f32_16x16x32_bf16 v[224:227], a[116:119], a[188:191], v[224:227]
    v_mfma_f32_16x16x32_bf16 v[228:231], a[116:119], a[192:195], v[228:231]
    global_load_lds_dwordx4 v2, s[18:19] offset:3072 sc1
    v_mfma_f32_16x16x32_bf16 v[232:235], a[116:119], a[196:199], v[232:235]
    v_mfma_f32_16x16x32_bf16 v[236:239], a[116:119], a[200:203], v[236:239]
    global_load_dwordx4 v[48:51], v6, s[52:53] offset:0 sc1
    v_mfma_f32_16x16x32_bf16 v[240:243], a[120:123], a[188:191], v[240:243]
    v_mfma_f32_16x16x32_bf16 v[244:247], a[120:123], a[192:195], v[244:247]
    global_load_dwordx4 v[52:55], v6, s[52:53] offset:1024 sc1
    v_mfma_f32_16x16x32_bf16 v[248:251], a[120:123], a[196:199], v[248:251]
    global_load_dwordx4 v[56:59], v7, s[52:53] offset:0 sc1
    v_mfma_f32_16x16x32_bf16 v[252:255], a[120:123], a[200:203], v[252:255]
    ds_read_b128 a[108:111], v10 offset:8192
    ds_read_b128 a[112:115], v10 offset:9216
    ds_read_b128 a[116:119], v11 offset:8192
    ds_read_b128 a[120:123], v11 offset:9216
    global_load_dwordx4 v[60:63], v7, s[52:53] offset:1024 sc1
    v_mfma_f32_16x16x32_bf16 v[128:131], a[124:127], a[204:207], v[128:131]
    v_mfma_f32_16x16x32_bf16 v[132:135], a[124:127], a[208:211], v[132:135]
    v_mfma_f32_16x16x32_bf16 v[136:139], a[124:127], a[212:215], v[136:139]
    v_mfma_f32_16x16x32_bf16 v[140:143], a[124:127], a[216:219], v[140:143]
    v_mfma_f32_16x16x32_bf16 v[144:147], a[128:131], a[204:207], v[144:147]
    s_add_u32 s18, s32, 32768
    s_addc_u32 s19, s33, 0
    s_add_u32 m0, s31, 8192
    s_waitcnt lgkmcnt(0)
    s_nop 0
    global_load_lds_dwordx4 v1, s[18:19] offset:0 sc1
    v_mfma_f32_16x16x32_bf16 v[148:151], a[128:131], a[208:211], v[148:151]
    v_mfma_f32_16x16x32_bf16 v[152:155], a[128:131], a[212:215], v[152:155]
    global_load_lds_dwordx4 v1, s[18:19] offset:1024 sc1
    v_mfma_f32_16x16x32_bf16 v[156:159], a[128:131], a[216:219], v[156:159]
    v_mfma_f32_16x16x32_bf16 v[160:163], a[132:135], a[204:207], v[160:163]
    global_load_lds_dwordx4 v1, s[18:19] offset:2048 sc1
    v_mfma_f32_16x16x32_bf16 v[164:167], a[132:135], a[208:211], v[164:167]
    v_mfma_f32_16x16x32_bf16 v[168:171], a[132:135], a[212:215], v[168:171]
    global_load_lds_dwordx4 v1, s[18:19] offset:3072 sc1
    v_mfma_f32_16x16x32_bf16 v[172:175], a[132:135], a[216:219], v[172:175]
    v_mfma_f32_16x16x32_bf16 v[176:179], a[136:139], a[204:207], v[176:179]
    v_mfma_f32_16x16x32_bf16 v[180:183], a[136:139], a[208:211], v[180:183]
    buffer_load_dword v28, v25, s[24:27], s11 offen sc1
    v_mfma_f32_16x16x32_bf16 v[184:187], a[136:139], a[212:215], v[184:187]
    v_mfma_f32_16x16x32_bf16 v[188:191], a[136:139], a[216:219], v[188:191]
    ds_read_b128 a[124:127], v8 offset:16384
    ds_read_b128 a[128:131], v8 offset:17408
    ds_read_b128 a[132:135], v9 offset:16384
    ds_read_b128 a[136:139], v9 offset:17408
    s_add_u32 m0, s31, 12288
    s_nop 0
    global_load_lds_dwordx4 v2, s[18:19] offset:0 sc1
    v_mfma_f32_16x16x32_bf16 v[192:195], a[140:143], a[204:207], v[192:195]
    v_mfma_f32_16x16x32_bf16 v[196:199], a[140:143], a[208:211], v[196:199]
    global_load_lds_dwordx4 v2, s[18:19] offset:1024 sc1
    v_mfma_f32_16x16x32_bf16 v[200:203], a[140:143], a[212:215], v[200:203]
    v_mfma_f32_16x16x32_bf16 v[204:207], a[140:143], a[216:219], v[204:207]
    global_load_lds_dwordx4 v2, s[18:19] offset:2048 sc1
    v_mfma_f32_16x16x32_bf16 v[208:211], a[144:147], a[204:207], v[208:211]
    v_mfma_f32_16x16x32_bf16 v[212:215], a[144:147], a[208:211], v[212:215]
    global_load_lds_dwordx4 v2, s[18:19] offset:3072 sc1
    v_mfma_f32_16x16x32_bf16 v[216:219], a[144:147], a[212:215], v[216:219]
    v_mfma_f32_16x16x32_bf16 v[220:223], a[144:147], a[216:219], v[220:223]
    v_mfma_f32_16x16x32_bf16 v[224:227], a[148:151], a[204:207], v[224:227]
    v_mfma_f32_16x16x32_bf16 v[228:231], a[148:151], a[208:211], v[228:231]
    v_mfma_f32_16x16x32_bf16 v[232:235], a[148:151], a[212:215], v[232:235]
    v_mfma_f32_16x16x32_bf16 v[236:239], a[148:151], a[216:219], v[236:239]
    v_mfma_f32_16x16x32_bf16 v[240:243], a[152:155], a[204:207], v[240:243]
    v_mfma_f32_16x16x32_bf16 v[244:247], a[152:155], a[208:211], v[244:247]
    v_mfma_f32_16x16x32_bf16 v[248:251], a[152:155], a[212:215], v[248:251]
    v_mfma_f32_16x16x32_bf16 v[252:255], a[152:155], a[216:219], v[252:255]
    ds_read_b128 a[140:143], v10 offset:16384
    ds_read_b128 a[144:147], v10 offset:17408
    ds_read_b128 a[148:151], v11 offset:16384
    ds_read_b128 a[152:155], v11 offset:17408
    s_waitcnt vmcnt(4)
    v_cmp_ne_u32 vcc, s89, v28
    s_nop 0
    s_cbranch_vccnz KM_OSPIN
KM_OBACK:
    global_load_dwordx4 a[44:47], v1, s[56:57] offset:0 sc1
    global_load_dwordx4 a[48:51], v1, s[56:57] offset:1024 sc1
    global_load_dwordx4 a[52:55], v1, s[56:57] offset:2048 sc1
    global_load_dwordx4 a[56:59], v1, s[56:57] offset:3072 sc1
    s_add_u32 s56, s56, 0x2000
    s_addc_u32 s57, s57, 0
    s_waitcnt vmcnt(3)
    v_mfma_f32_16x16x32_bf16 v[128:131], a[92:95], a[44:47], v[128:131]
    s_waitcnt vmcnt(2)
    v_mfma_f32_16x16x32_bf16 v[132:135], a[92:95], a[48:51], v[132:135]
    s_waitcnt vmcnt(1)
    v_mfma_f32_16x16x32_bf16 v[136:139], a[92:95], a[52:55], v[136:139]
    s_waitcnt vmcnt(0)
    v_mfma_f32_16x16x32_bf16 v[140:143], a[92:95], a[56:59], v[140:143]
    global_load_dwordx4 a[60:63], v1, s[56:57] offset:0 sc1
    v_mfma_f32_16x16x32_bf16 v[144:147], a[96:99], a[44:47], v[144:147]
    v_mfma_f32_16x16x32_bf16 v[148:151], a[96:99], a[48:51], v[148:151]
    global_load_dwordx4 a[64:67], v1, s[56:57] offset:1024 sc1
    v_mfma_f32_16x16x32_bf16 v[152:155], a[96:99], a[52:55], v[152:155]
    v_mfma_f32_16x16x32_bf16 v[156:159], a[96:99], a[56:59], v[156:159]
    global_load_dwordx4 a[68:71], v1, s[56:57] offset:2048 sc1
    v_mfma_f32_16x16x32_bf16 v[160:163], a[100:103], a[44:47], v[160:163]
    v_mfma_f32_16x16x32_bf16 v[164:167], a[100:103], a[48:51], v[164:167]
    global_load_dwordx4 a[72:75], v1, s[56:57] offset:3072 sc1
    s_add_u32 s56, s56, 0x2000
    s_addc_u32 s57, s57, 0
    v_mfma_f32_16x16x32_bf16 v[168:171], a[100:103], a[52:55], v[168:171]
    v_mfma_f32_16x16x32_bf16 v[172:175], a[100:103], a[56:59], v[172:175]
    v_mfma_f32_16x16x32_bf16 v[176:179], a[104:107], a[44:47], v[176:179]
    v_mfma_f32_16x16x32_bf16 v[180:183], a[104:107], a[48:51], v[180:183]
    v_mfma_f32_16x16x32_bf16 v[184:187], a[104:107], a[52:55], v[184:187]
    global_load_dwordx4 a[76:79], v1, s[56:57] offset:0 sc1
    v_mfma_f32_16x16x32_bf16 v[188:191], a[104:107], a[56:59], v[188:191]
    ds_read_b128 a[92:95], v12 offset:0
    ds_read_b128 a[96:99], v12 offset:1024
    ds_read_b128 a[100:103], v13 offset:0
    ds_read_b128 a[104:107], v13 offset:1024
    v_mfma_f32_16x16x32_bf16 v[192:195], a[108:111], a[44:47], v[192:195]
    global_load_dwordx4 a[80:83], v1, s[56:57] offset:1024 sc1
    v_mfma_f32_16x16x32_bf16 v[196:199], a[108:111], a[48:51], v[196:199]
    v_mfma_f32_16x16x32_bf16 v[200:203], a[108:111], a[52:55], v[200:203]
    global_load_dwordx4 a[84:87], v1, s[56:57] offset:2048 sc1
    v_mfma_f32_16x16x32_bf16 v[204:207], a[108:111], a[56:59], v[204:207]
    v_mfma_f32_16x16x32_bf16 v[208:211], a[112:115], a[44:47], v[208:211]
    global_load_dwordx4 a[88:91], v1, s[56:57] offset:3072 sc1
    s_add_u32 s56, s56, 0x2000
    s_addc_u32 s57, s57, 0
    v_mfma_f32_16x16x32_bf16 v[212:215], a[112:115], a[48:51], v[212:215]
    v_mfma_f32_16x16x32_bf16 v[216:219], a[112:115], a[52:55], v[216:219]
    v_mfma_f32_16x16x32_bf16 v[220:223], a[112:115], a[56:59], v[220:223]
    v_mfma_f32_16x16x32_bf16 v[224:227], a[116:119], a[44:47], v[224:227]
    v_mfma_f32_16x16x32_bf16 v[228:231], a[116:119], a[48:51], v[228:231]
    v_mfma_f32_16x16x32_bf16 v[232:235], a[116:119], a[52:55], v[232:235]
    v_mfma_f32_16x16x32_bf16 v[236:239], a[116:119], a[56:59], v[236:239]
    v_mfma_f32_16x16x32_bf16 v[240:243], a[120:123], a[44:47], v[240:243]
    v_mfma_f32_16x16x32_bf16 v[244:247], a[120:123], a[48:51], v[244:247]
    v_mfma_f32_16x16x32_bf16 v[248:251], a[120:123], a[52:55], v[248:251]
    v_mfma_f32_16x16x32_bf16 v[252:255], a[120:123], a[56:59], v[252:255]
    ds_read_b128 a[108:111], v14 offset:0
    ds_read_b128 a[112:115], v14 offset:1024
    ds_read_b128 a[116:119], v15 offset:0
    ds_read_b128 a[120:123], v15 offset:1024
    s_waitcnt vmcnt(7) lgkmcnt(15)
    v_mfma_f32_16x16x32_bf16 v[128:131], a[124:127], a[60:63], v[128:131]
    s_waitcnt vmcnt(6)
    v_mfma_f32_16x16x32_bf16 v[132:135], a[124:127], a[64:67], v[132:135]
    s_waitcnt vmcnt(5)
    v_mfma_f32_16x16x32_bf16 v[136:139], a[124:127], a[68:71], v[136:139]
    s_waitcnt vmcnt(4)
    v_mfma_f32_16x16x32_bf16 v[140:143], a[124:127], a[72:75], v[140:143]
    s_waitcnt lgkmcnt(14)
    global_load_dwordx4 v[96:99], v1, s[56:57] offset:0 sc1
    v_mfma_f32_16x16x32_bf16 v[144:147], a[128:131], a[60:63], v[144:147]
    v_mfma_f32_16x16x32_bf16 v[148:151], a[128:131], a[64:67], v[148:151]
    global_load_dwordx4 v[100:103], v1, s[56:57] offset:1024 sc1
    v_mfma_f32_16x16x32_bf16 v[152:155], a[128:131], a[68:71], v[152:155]
    v_mfma_f32_16x16x32_bf16 v[156:159], a[128:131], a[72:75], v[156:159]
    s_waitcnt lgkmcnt(13)
    global_load_dwordx4 v[104:107], v1, s[56:57] offset:2048 sc1
    v_mfma_f32_16x16x32_bf16 v[160:163], a[132:135], a[60:63], v[160:163]
    v_mfma_f32_16x16x32_bf16 v[164:167], a[132:135], a[64:67], v[164:167]
    global_load_dwordx4 v[108:111], v1, s[56:57] offset:3072 sc1
    s_add_u32 s56, s56, 0x2000
    s_addc_u32 s57, s57, 0
    v_mfma_f32_16x16x32_bf16 v[168:171], a[132:135], a[68:71], v[168:171]
    v_mfma_f32_16x16x32_bf16 v[172:175], a[132:135], a[72:75], v[172:175]
    s_waitcnt lgkmcnt(12)
    v_mfma_f32_16x16x32_bf16 v[176:179], a[136:139], a[60:63], v[176:179]
    v_mfma_f32_16x16x32_bf16 v[180:183], a[136:139], a[64:67], v[180:183]
    v_mfma_f32_16x16x32_bf16 v[184:187], a[136:139], a[68:71], v[184:187]
    global_load_dwordx4 v[112:115], v1, s[56:57] offset:0 sc1
    v_mfma_f32_16x16x32_bf16 v[188:191], a[136:139], a[72:75], v[188:191]
    s_waitcnt lgkmcnt(11)
    ds_read_b128 a[124:127], v8 offset:0
    ds_read_b128 a[128:131], v8 offset:1024
    ds_read_b128 a[132:135], v9 offset:0
    ds_read_b128 a[136:139], v9 offset:1024
    v_mfma_f32_16x16x32_bf16 v[192:195], a[140:143], a[60:63], v[192:195]
    global_load_dwordx4 v[116:119], v1, s[56:57] offset:1024 sc1
    v_mfma_f32_16x16x32_bf16 v[196:199], a[140:143], a[64:67], v[196:199]
    v_mfma_f32_16x16x32_bf16 v[200:203], a[140:143], a[68:71], v[200:203]
    global_load_dwordx4 v[120:123], v1, s[56:57] offset:2048 sc1
    v_mfma_f32_16x16x32_bf16 v[204:207], a[140:143], a[72:75], v[204:207]
    s_waitcnt lgkmcnt(14)
    v_mfma_f32_16x16x32_bf16 v[208:211], a[144:147], a[60:63], v[208:211]
    global_load_dwordx4 v[124:127], v1, s[56:57] offset:3072 sc1
    s_add_u32 s56, s56, 0x2000
    s_addc_u32 s57, s57, 0
    v_mfma_f32_16x16x32_bf16 v[212:215], a[144:147], a[64:67], v[212:215]
    v_mfma_f32_16x16x32_bf16 v[216:219], a[144:147], a[68:71], v[216:219]
    v_mfma_f32_16x16x32_bf16 v[220:223], a[144:147], a[72:75], v[220:223]
    s_waitcnt lgkmcnt(13)
    v_mfma_f32_16x16x32_bf16 v[224:227], a[148:151], a[60:63], v[224:227]
    v_mfma_f32_16x16x32_bf16 v[228:231], a[148:151], a[64:67], v[228:231]
    v_mfma_f32_16x16x32_bf16 v[232:235], a[148:151], a[68:71], v[232:235]
    v_mfma_f32_16x16x32_bf16 v[236:239], a[148:151], a[72:75], v[236:239]
    s_waitcnt lgkmcnt(12)
    v_mfma_f32_16x16x32_bf16 v[240:243], a[152:155], a[60:63], v[240:243]
    v_mfma_f32_16x16x32_bf16 v[244:247], a[152:155], a[64:67], v[244:247]
    v_mfma_f32_16x16x32_bf16 v[248:251], a[152:155], a[68:71], v[248:251]
    v_mfma_f32_16x16x32_bf16 v[252:255], a[152:155], a[72:75], v[252:255]
    ds_read_b128 a[140:143], v10 offset:0
    ds_read_b128 a[144:147], v10 offset:1024
    ds_read_b128 a[148:151], v11 offset:0
    ds_read_b128 a[152:155], v11 offset:1024
    s_waitcnt vmcnt(11) lgkmcnt(15)
    v_mfma_f32_16x16x32_bf16 v[128:131], a[92:95], a[76:79], v[128:131]
    s_waitcnt vmcnt(10)
    v_mfma_f32_16x16x32_bf16 v[132:135], a[92:95], a[80:83], v[132:135]
    s_waitcnt vmcnt(9)
    v_mfma_f32_16x16x32_bf16 v[136:139], a[92:95], a[84:87], v[136:139]
    s_waitcnt vmcnt(8)
    v_mfma_f32_16x16x32_bf16 v[140:143], a[92:95], a[88:91], v[140:143]
    s_waitcnt lgkmcnt(14)
    global_load_dwordx4 a[156:159], v1, s[56:57] offset:0 sc1
    v_mfma_f32_16x16x32_bf16 v[144:147], a[96:99], a[76:79], v[144:147]
    v_mfma_f32_16x16x32_bf16 v[148:151], a[96:99], a[80:83], v[148:151]
    global_load_dwordx4 a[160:163], v1, s[56:57] offset:1024 sc1
    v_mfma_f32_16x16x32_bf16 v[152:155], a[96:99], a[84:87], v[152:155]
    v_mfma_f32_16x16x32_bf16 v[156:159], a[96:99], a[88:91], v[156:159]
    s_waitcnt lgkmcnt(13)
    global_load_dwordx4 a[164:167], v1, s[56:57] offset:2048 sc1
    v_mfma_f32_16x16x32_bf16 v[160:163], a[100:103], a[76:79], v[160:163]
    v_mfma_f32_16x16x32_bf16 v[164:167], a[100:103], a[80:83], v[164:167]
    global_load_dwordx4 a[168:171], v1, s[56:57] offset:3072 sc1
    s_add_u32 s56, s56, 0x2000
    s_addc_u32 s57, s57, 0
    v_mfma_f32_16x16x32_bf16 v[168:171], a[100:103], a[84:87], v[168:171]
    v_mfma_f32_16x16x32_bf16 v[172:175], a[100:103], a[88:91], v[172:175]
    s_waitcnt lgkmcnt(12)
    v_mfma_f32_16x16x32_bf16 v[176:179], a[104:107], a[76:79], v[176:179]
    v_mfma_f32_16x16x32_bf16 v[180:183], a[104:107], a[80:83], v[180:183]
    v_mfma_f32_16x16x32_bf16 v[184:187], a[104:107], a[84:87], v[184:187]
    global_load_dwordx4 a[172:175], v1, s[56:57] offset:0 sc1
    v_mfma_f32_16x16x32_bf16 v[188:191], a[104:107], a[88:91], v[188:191]
    s_waitcnt lgkmcnt(11)
    ds_read_b128 a[92:95], v8 offset:8192
    ds_read_b128 a[96:99], v8 offset:9216
    ds_read_b128 a[100:103], v9 offset:8192
    ds_read_b128 a[104:107], v9 offset:9216
    v_mfma_f32_16x16x32_bf16 v[192:195], a[108:111], a[76:79], v[192:195]
    global_load_dwordx4 a[176:179], v1, s[56:57] offset:1024 sc1
    v_mfma_f32_16x16x32_bf16 v[196:199], a[108:111], a[80:83], v[196:199]
    v_mfma_f32_16x16x32_bf16 v[200:203], a[108:111], a[84:87], v[200:203]
    global_load_dwordx4 a[180:183], v1, s[56:57] offset:2048 sc1
    v_mfma_f32_16x16x32_bf16 v[204:207], a[108:111], a[88:91], v[204:207]
    s_waitcnt lgkmcnt(14)
    v_mfma_f32_16x16x32_bf16 v[208:211], a[112:115], a[76:79], v[208:211]
    global_load_dwordx4 a[184:187], v1, s[56:57] offset:3072 sc1
    s_add_u32 s56, s56, 0x2000
    s_addc_u32 s57, s57, 0
    v_mfma_f32_16x16x32_bf16 v[212:215], a[112:115], a[80:83], v[212:215]
    v_mfma_f32_16x16x32_bf16 v[216:219], a[112:115], a[84:87], v[216:219]
    v_mfma_f32_16x16x32_bf16 v[220:223], a[112:115], a[88:91], v[220:223]
    s_waitcnt lgkmcnt(13)
    v_mfma_f32_16x16x32_bf16 v[224:227], a[116:119], a[76:79], v[224:227]
    v_mfma_f32_16x16x32_bf16 v[228:231], a[116:119], a[80:83], v[228:231]
    v_mfma_f32_16x16x32_bf16 v[232:235], a[116:119], a[84:87], v[232:235]
    v_mfma_f32_16x16x32_bf16 v[236:239], a[116:119], a[88:91], v[236:239]
    s_waitcnt lgkmcnt(12)
    v_mfma_f32_16x16x32_bf16 v[240:243], a[120:123], a[76:79], v[240:243]
    v_mfma_f32_16x16x32_bf16 v[244:247], a[120:123], a[80:83], v[244:247]
    v_mfma_f32_16x16x32_bf16 v[248:251], a[120:123], a[84:87], v[248:251]
    v_mfma_f32_16x16x32_bf16 v[252:255], a[120:123], a[88:91], v[252:255]
    ds_read_b128 a[108:111], v10 offset:8192
    ds_read_b128 a[112:115], v10 offset:9216
    ds_read_b128 a[116:119], v11 offset:8192
    ds_read_b128 a[120:123], v11 offset:9216
    s_waitcnt vmcnt(15) lgkmcnt(15)
    v_mfma_f32_16x16x32_bf16 v[128:131], a[124:127], v[96:99], v[128:131]
    s_waitcnt vmcnt(14)
    v_mfma_f32_16x16x32_bf16 v[132:135], a[124:127], v[100:103], v[132:135]
    s_waitcnt vmcnt(13)
    v_mfma_f32_16x16x32_bf16 v[136:139], a[124:127], v[104:107], v[136:139]
    s_waitcnt vmcnt(12)
    v_mfma_f32_16x16x32_bf16 v[140:143], a[124:127], v[108:111], v[140:143]
    s_waitcnt lgkmcnt(14)
    global_load_dwordx4 a[188:191], v1, s[56:57] offset:0 sc1
    v_mfma_f32_16x16x32_bf16 v[144:147], a[128:131], v[96:99], v[144:147]
    v_mfma_f32_16x16x32_bf16 v[148:151], a[128:131], v[100:103], v[148:151]
    global_load_dwordx4 a[192:195], v1, s[56:57] offset:1024 sc1
    v_mfma_f32_16x16x32_bf16 v[152:155], a[128:131], v[104:107], v[152:155]
    v_mfma_f32_16x16x32_bf16 v[156:159], a[128:131], v[108:111], v[156:159]
    s_waitcnt lgkmcnt(13)
    global_load_dwordx4 a[196:199], v1, s[56:57] offset:2048 sc1
    v_mfma_f32_16x16x32_bf16 v[160:163], a[132:135], v[96:99], v[160:163]
    v_mfma_f32_16x16x32_bf16 v[164:167], a[132:135], v[100:103], v[164:167]
    global_load_dwordx4 a[200:203], v1, s[56:57] offset:3072 sc1
    v_mfma_f32_16x16x32_bf16 v[168:171], a[132:135], v[104:107], v[168:171]
    v_mfma_f32_16x16x32_bf16 v[172:175], a[132:135], v[108:111], v[172:175]
    s_waitcnt lgkmcnt(12)
    v_mfma_f32_16x16x32_bf16 v[176:179], a[136:139], v[96:99], v[176:179]
    v_mfma_f32_16x16x32_bf16 v[180:183], a[136:139], v[100:103], v[180:183]
    v_mfma_f32_16x16x32_bf16 v[184:187], a[136:139], v[104:107], v[184:187]
    v_mfma_f32_16x16x32_bf16 v[188:191], a[136:139], v[108:111], v[188:191]
    s_waitcnt lgkmcnt(11)
    v_mfma_f32_16x16x32_bf16 v[192:195], a[140:143], v[96:99], v[192:195]
    v_mfma_f32_16x16x32_bf16 v[196:199], a[140:143], v[100:103], v[196:199]
    v_mfma_f32_16x16x32_bf16 v[200:203], a[140:143], v[104:107], v[200:203]
    v_mfma_f32_16x16x32_bf16 v[204:207], a[140:143], v[108:111], v[204:207]
    s_waitcnt lgkmcnt(10)
    v_mfma_f32_16x16x32_bf16 v[208:211], a[144:147], v[96:99], v[208:211]
    v_mfma_f32_16x16x32_bf16 v[212:215], a[144:147], v[100:103], v[212:215]
    v_mfma_f32_16x16x32_bf16 v[216:219], a[144:147], v[104:107], v[216:219]
    v_mfma_f32_16x16x32_bf16 v[220:223], a[144:147], v[108:111], v[220:223]
    s_waitcnt lgkmcnt(9)
    v_mfma_f32_16x16x32_bf16 v[224:227], a[148:151], v[96:99], v[224:227]
    v_mfma_f32_16x16x32_bf16 v[228:231], a[148:151], v[100:103], v[228:231]
    v_mfma_f32_16x16x32_bf16 v[232:235], a[148:151], v[104:107], v[232:235]
    v_mfma_f32_16x16x32_bf16 v[236:239], a[148:151], v[108:111], v[236:239]
    s_waitcnt lgkmcnt(8)
    v_mfma_f32_16x16x32_bf16 v[240:243], a[152:155], v[96:99], v[240:243]
    v_mfma_f32_16x16x32_bf16 v[244:247], a[152:155], v[100:103], v[244:247]
    v_mfma_f32_16x16x32_bf16 v[248:251], a[152:155], v[104:107], v[248:251]
    v_mfma_f32_16x16x32_bf16 v[252:255], a[152:155], v[108:111], v[252:255]
    s_waitcnt lgkmcnt(0)
    s_barrier
    s_waitcnt vmcnt(12)
    v_mfma_f32_16x16x32_bf16 v[160:163], a[100:103], v[112:115], v[160:163]
    s_add_u32 s78, s36, 1
    v_mfma_f32_16x16x32_bf16 v[164:167], a[100:103], v[116:119], v[164:167]
    s_and_b32 s78, s78, 3
    v_mfma_f32_16x16x32_bf16 v[168:171], a[100:103], v[120:123], v[168:171]
    s_mul_i32 s78, s78, 24576
    v_mfma_f32_16x16x32_bf16 v[172:175], a[100:103], v[124:127], v[172:175]
    s_add_u32 s78, s78, 0
    v_mfma_f32_16x16x32_bf16 v[176:179], a[104:107], v[112:115], v[176:179]
    v_add_u32 v27, s78, v1
    v_mfma_f32_16x16x32_bf16 v[180:183], a[104:107], v[116:119], v[180:183]
    s_add_u32 s78, s36, 2
    v_mfma_f32_16x16x32_bf16 v[184:187], a[104:107], v[120:123], v[184:187]
    s_and_b32 s78, s78, 3
    v_mfma_f32_16x16x32_bf16 v[188:191], a[104:107], v[124:127], v[188:191]
    s_mul_i32 s78, s78, 24576
    s_waitcnt vmcnt(8)
    v_mfma_f32_16x16x32_bf16 v[160:163], v[40:43], a[156:159], v[160:163]
    s_add_u32 s78, s78, 8192
    v_mfma_f32_16x16x32_bf16 v[164:167], v[40:43], a[160:163], v[164:167]
    v_add_u32 v28, s78, v1
    v_mfma_f32_16x16x32_bf16 v[168:171], v[40:43], a[164:167], v[168:171]
    s_add_u32 s78, s36, 3
    v_mfma_f32_16x16x32_bf16 v[172:175], v[40:43], a[168:171], v[172:175]
    s_and_b32 s78, s78, 3
    v_mfma_f32_16x16x32_bf16 v[176:179], v[44:47], a[156:159], v[176:179]
    s_mul_i32 s78, s78, 24576
    v_mfma_f32_16x16x32_bf16 v[180:183], v[44:47], a[160:163], v[180:183]
    s_add_u32 s78, s78, 16384
    v_mfma_f32_16x16x32_bf16 v[184:187], v[44:47], a[164:167], v[184:187]
    v_add_u32_e64 v29, s78, v1
    v_mfma_f32_16x16x32_bf16 v[188:191], v[44:47], a[168:171], v[188:191]
    s_mul_i32 s78, s36, 24576
    s_waitcnt vmcnt(4)
    v_mfma_f32_16x16x32_bf16 v[160:163], a[8:11], a[172:175], v[160:163]
    v_add_u32 v26, s78, v1
    v_mfma_f32_16x16x32_bf16 v[164:167], a[8:11], a[176:179], v[164:167]
    s_lshl_b32 s78, s28, 17
    v_mfma_f32_16x16x32_bf16 v[168:171], a[8:11], a[180:183], v[168:171]
    s_lshl_b32 s79, s29, 8
    v_mfma_f32_16x16x32_bf16 v[172:175], a[8:11], a[184:187], v[172:175]
    s_add_u32 s78, s78, s79
    v_mfma_f32_16x16x32_bf16 v[176:179], a[12:15], a[172:175], v[176:179]
    s_lshl_b32 s79, s36, 6
    v_mfma_f32_16x16x32_bf16 v[180:183], a[12:15], a[176:179], v[180:183]
    s_add_u32 s78, s78, s79
    v_mfma_f32_16x16x32_bf16 v[184:187], a[12:15], a[180:183], v[184:187]
    s_add_u32 s79, s78, 0x8000
    v_mfma_f32_16x16x32_bf16 v[188:191], a[12:15], a[184:187], v[188:191]
    s_add_u32 s80, s78, 0x10000
    s_waitcnt vmcnt(0)
    v_mfma_f32_16x16x32_bf16 v[160:163], a[228:231], a[188:191], v[160:163]
    s_add_u32 s81, s78, 0x18000
    v_mfma_f32_16x16x32_bf16 v[164:167], a[228:231], a[192:195], v[164:167]
    v_and_b32_e64 v30, 15, v16
    v_mfma_f32_16x16x32_bf16 v[168:171], a[228:231], a[196:199], v[168:171]
    v_lshlrev_b32_e64 v30, 11, v30
    v_mfma_f32_16x16x32_bf16 v[172:175], a[228:231], a[200:203], v[172:175]
    v_bfe_u32 v25, v16, 4, 1
    v_mfma_f32_16x16x32_bf16 v[176:179], a[232:235], a[188:191], v[176:179]
    v_lshl_add_u32 v30, v25, 5, v30
    v_mfma_f32_16x16x32_bf16 v[180:183], a[232:235], a[192:195], v[180:183]
    v_lshrrev_b32_e64 v25, 5, v16
    v_mfma_f32_16x16x32_bf16 v[184:187], a[232:235], a[196:199], v[184:187]
    v_lshl_add_u32 v30, v25, 4, v30
    v_mfma_f32_16x16x32_bf16 v[188:191], a[232:235], a[200:203], v[188:191]
    v_mfma_f32_16x16x32_bf16 v[192:195], a[108:111], v[112:115], v[192:195]
    v_mfma_f32_16x16x32_bf16 v[196:199], a[108:111], v[116:119], v[196:199]
    v_mfma_f32_16x16x32_bf16 v[200:203], a[108:111], v[120:123], v[200:203]
    v_mfma_f32_16x16x32_bf16 v[204:207], a[108:111], v[124:127], v[204:207]
    v_mfma_f32_16x16x32_bf16 v[208:211], a[112:115], v[112:115], v[208:211]
    ds_write_b128 v27, v[160:163] offset:0
    v_mfma_f32_16x16x32_bf16 v[212:215], a[112:115], v[116:119], v[212:215]
    v_mfma_f32_16x16x32_bf16 v[216:219], a[112:115], v[120:123], v[216:219]
    v_mfma_f32_16x16x32_bf16 v[220:223], a[112:115], v[124:127], v[220:223]
    ds_write_b128 v27, v[164:167] offset:1024
    v_mfma_f32_16x16x32_bf16 v[192:195], v[48:51], a[156:159], v[192:195]
    v_mfma_f32_16x16x32_bf16 v[196:199], v[48:51], a[160:163], v[196:199]
    v_mfma_f32_16x16x32_bf16 v[200:203], v[48:51], a[164:167], v[200:203]
    ds_write_b128 v27, v[168:171] offset:2048
    v_mfma_f32_16x16x32_bf16 v[204:207], v[48:51], a[168:171], v[204:207]
    v_mfma_f32_16x16x32_bf16 v[208:211], v[52:55], a[156:159], v[208:211]
    v_mfma_f32_16x16x32_bf16 v[212:215], v[52:55], a[160:163], v[212:215]
    ds_write_b128 v27, v[172:175] offset:3072
    v_mfma_f32_16x16x32_bf16 v[216:219], v[52:55], a[164:167], v[216:219]
    v_mfma_f32_16x16x32_bf16 v[220:223], v[52:55], a[168:171], v[220:223]
    v_mfma_f32_16x16x32_bf16 v[192:195], a[16:19], a[172:175], v[192:195]
    ds_write_b128 v27, v[176:179] offset:4096
    v_mfma_f32_16x16x32_bf16 v[196:199], a[16:19], a[176:179], v[196:199]
    v_mfma_f32_16x16x32_bf16 v[200:203], a[16:19], a[180:183], v[200:203]
    v_mfma_f32_16x16x32_bf16 v[204:207], a[16:19], a[184:187], v[204:207]
    ds_write_b128 v27, v[180:183] offset:5120
    v_mfma_f32_16x16x32_bf16 v[208:211], a[20:23], a[172:175], v[208:211]
    v_mfma_f32_16x16x32_bf16 v[212:215], a[20:23], a[176:179], v[212:215]
    v_mfma_f32_16x16x32_bf16 v[216:219], a[20:23], a[180:183], v[216:219]
    ds_write_b128 v27, v[184:187] offset:6144
    v_mfma_f32_16x16x32_bf16 v[220:223], a[20:23], a[184:187], v[220:223]
    v_mfma_f32_16x16x32_bf16 v[192:195], a[236:239], a[188:191], v[192:195]
    v_mfma_f32_16x16x32_bf16 v[196:199], a[236:239], a[192:195], v[196:199]
    ds_write_b128 v27, v[188:191] offset:7168
    v_mfma_f32_16x16x32_bf16 v[200:203], a[236:239], a[196:199], v[200:203]
    v_mfma_f32_16x16x32_bf16 v[204:207], a[236:239], a[200:203], v[204:207]
    v_mfma_f32_16x16x32_bf16 v[208:211], a[240:243], a[188:191], v[208:211]
    v_mfma_f32_16x16x32_bf16 v[212:215], a[240:243], a[192:195], v[212:215]
    v_mfma_f32_16x16x32_bf16 v[216:219], a[240:243], a[196:199], v[216:219]
    v_mfma_f32_16x16x32_bf16 v[220:223], a[240:243], a[200:203], v[220:223]
    v_mfma_f32_16x16x32_bf16 v[224:227], a[116:119], v[112:115], v[224:227]
    v_mfma_f32_16x16x32_bf16 v[228:231], a[116:119], v[116:119], v[228:231]
    v_mfma_f32_16x16x32_bf16 v[232:235], a[116:119], v[120:123], v[232:235]
    v_mfma_f32_16x16x32_bf16 v[236:239], a[116:119], v[124:127], v[236:239]
    v_mfma_f32_16x16x32_bf16 v[240:243], a[120:123], v[112:115], v[240:243]
    ds_write_b128 v28, v[192:195] offset:0
    v_mfma_f32_16x16x32_bf16 v[244:247], a[120:123], v[116:119], v[244:247]
    v_mfma_f32_16x16x32_bf16 v[248:251], a[120:123], v[120:123], v[248:251]
    v_mfma_f32_16x16x32_bf16 v[252:255], a[120:123], v[124:127], v[252:255]
    ds_write_b128 v28, v[196:199] offset:1024
    v_mfma_f32_16x16x32_bf16 v[224:227], v[56:59], a[156:159], v[224:227]
    v_mfma_f32_16x16x32_bf16 v[228:231], v[56:59], a[160:163], v[228:231]
    v_mfma_f32_16x16x32_bf16 v[232:235], v[56:59], a[164:167], v[232:235]
    ds_write_b128 v28, v[200:203] offset:2048
    v_mfma_f32_16x16x32_bf16 v[236:239], v[56:59], a[168:171], v[236:239]
    v_mfma_f32_16x16x32_bf16 v[240:243], v[60:63], a[156:159], v[240:243]
    v_mfma_f32_16x16x32_bf16 v[244:247], v[60:63], a[160:163], v[244:247]
    ds_write_b128 v28, v[204:207] offset:3072
    v_mfma_f32_16x16x32_bf16 v[248:251], v[60:63], a[164:167], v[248:251]
    v_mfma_f32_16x16x32_bf16 v[252:255], v[60:63], a[168:171], v[252:255]
    v_mfma_f32_16x16x32_bf16 v[224:227], a[24:27], a[172:175], v[224:227]
    ds_write_b128 v28, v[208:211] offset:4096
    v_mfma_f32_16x16x32_bf16 v[228:231], a[24:27], a[176:179], v[228:231]
    v_mfma_f32_16x16x32_bf16 v[232:235], a[24:27], a[180:183], v[232:235]
    v_mfma_f32_16x16x32_bf16 v[236:239], a[24:27], a[184:187], v[236:239]
    ds_write_b128 v28, v[212:215] offset:5120
    v_mfma_f32_16x16x32_bf16 v[240:243], a[28:31], a[172:175], v[240:243]
    v_mfma_f32_16x16x32_bf16 v[244:247], a[28:31], a[176:179], v[244:247]
    v_mfma_f32_16x16x32_bf16 v[248:251], a[28:31], a[180:183], v[248:251]
    ds_write_b128 v28, v[216:219] offset:6144
    v_mfma_f32_16x16x32_bf16 v[252:255], a[28:31], a[184:187], v[252:255]
    v_mfma_f32_16x16x32_bf16 v[224:227], a[244:247], a[188:191], v[224:227]
    v_mfma_f32_16x16x32_bf16 v[228:231], a[244:247], a[192:195], v[228:231]
    ds_write_b128 v28, v[220:223] offset:7168
    v_mfma_f32_16x16x32_bf16 v[232:235], a[244:247], a[196:199], v[232:235]
    v_mfma_f32_16x16x32_bf16 v[236:239], a[244:247], a[200:203], v[236:239]
    v_mfma_f32_16x16x32_bf16 v[240:243], a[248:251], a[188:191], v[240:243]
    v_mfma_f32_16x16x32_bf16 v[244:247], a[248:251], a[192:195], v[244:247]
    v_mfma_f32_16x16x32_bf16 v[248:251], a[248:251], a[196:199], v[248:251]
    v_mfma_f32_16x16x32_bf16 v[252:255], a[248:251], a[200:203], v[252:255]
    s_waitcnt lgkmcnt(0)
    s_barrier
    v_mfma_f32_16x16x32_bf16 v[128:131], a[92:95], v[112:115], v[128:131]
    v_mfma_f32_16x16x32_bf16 v[132:135], a[92:95], v[116:119], v[132:135]
    ds_write_b128 v29, v[224:227] offset:0
    v_mfma_f32_16x16x32_bf16 v[136:139], a[92:95], v[120:123], v[136:139]
    ds_write_b128 v29, v[228:231] offset:1024
    v_mfma_f32_16x16x32_bf16 v[140:143], a[92:95], v[124:127], v[140:143]
    ds_write_b128 v29, v[232:235] offset:2048
    v_mfma_f32_16x16x32_bf16 v[144:147], a[96:99], v[112:115], v[144:147]
    ds_write_b128 v29, v[236:239] offset:3072
    v_mfma_f32_16x16x32_bf16 v[148:151], a[96:99], v[116:119], v[148:151]
    v_mfma_f32_16x16x32_bf16 v[152:155], a[96:99], v[120:123], v[152:155]
    v_mfma_f32_16x16x32_bf16 v[156:159], a[96:99], v[124:127], v[156:159]
    v_mfma_f32_16x16x32_bf16 v[128:131], v[32:35], a[156:159], v[128:131]
    ds_write_b128 v29, v[240:243] offset:4096
    v_mfma_f32_16x16x32_bf16 v[132:135], v[32:35], a[160:163], v[132:135]
    ds_write_b128 v29, v[244:247] offset:5120
    v_mfma_f32_16x16x32_bf16 v[136:139], v[32:35], a[164:167], v[136:139]
    ds_write_b128 v29, v[248:251] offset:6144
    v_mfma_f32_16x16x32_bf16 v[140:143], v[32:35], a[168:171], v[140:143]
    ds_write_b128 v29, v[252:255] offset:7168
    v_mfma_f32_16x16x32_bf16 v[144:147], v[36:39], a[156:159], v[144:147]
    ds_read_b128 v[160:163], v26 offset:0
    ds_read_b128 v[164:167], v26 offset:1024
    v_mfma_f32_16x16x32_bf16 v[148:151], v[36:39], a[160:163], v[148:151]
    ds_read_b128 v[168:171], v26 offset:2048
    ds_read_b128 v[172:175], v26 offset:3072
    v_mfma_f32_16x16x32_bf16 v[152:155], v[36:39], a[164:167], v[152:155]
    ds_read_b128 v[176:179], v26 offset:4096
    ds_read_b128 v[180:183], v26 offset:5120
    v_mfma_f32_16x16x32_bf16 v[156:159], v[36:39], a[168:171], v[156:159]
    ds_read_b128 v[184:187], v26 offset:6144
    ds_read_b128 v[188:191], v26 offset:7168
    v_mfma_f32_16x16x32_bf16 v[128:131], a[0:3], a[172:175], v[128:131]
    ds_read_b128 v[192:195], v26 offset:8192
    ds_read_b128 v[196:199], v26 offset:9216
    v_mfma_f32_16x16x32_bf16 v[132:135], a[0:3], a[176:179], v[132:135]
    ds_read_b128 v[200:203], v26 offset:10240
    ds_read_b128 v[204:207], v26 offset:11264
    v_mfma_f32_16x16x32_bf16 v[136:139], a[0:3], a[180:183], v[136:139]
    ds_read_b128 v[208:211], v26 offset:12288
    ds_read_b128 v[212:215], v26 offset:13312
    v_mfma_f32_16x16x32_bf16 v[140:143], a[0:3], a[184:187], v[140:143]
    ds_read_b128 v[216:219], v26 offset:14336
    ds_read_b128 v[220:223], v26 offset:15360
    v_mfma_f32_16x16x32_bf16 v[144:147], a[4:7], a[172:175], v[144:147]
    v_mfma_f32_16x16x32_bf16 v[148:151], a[4:7], a[176:179], v[148:151]
    s_waitcnt lgkmcnt(15)
    s_barrier
    v_mfma_f32_16x16x32_bf16 v[152:155], a[4:7], a[180:183], v[152:155]
    ds_read_b128 v[224:227], v26 offset:16384
    ds_read_b128 v[228:231], v26 offset:17408
    v_mfma_f32_16x16x32_bf16 v[156:159], a[4:7], a[184:187], v[156:159]
    ds_read_b128 v[232:235], v26 offset:18432
    ds_read_b128 v[236:239], v26 offset:19456
    v_mfma_f32_16x16x32_bf16 v[128:131], a[220:223], a[188:191], v[128:131]
    ds_read_b128 v[240:243], v26 offset:20480
    ds_read_b128 v[244:247], v26 offset:21504
    v_mfma_f32_16x16x32_bf16 v[132:135], a[220:223], a[192:195], v[132:135]
    ds_read_b128 v[248:251], v26 offset:22528
    ds_read_b128 v[252:255], v26 offset:23552
    v_mfma_f32_16x16x32_bf16 v[136:139], a[220:223], a[196:199], v[136:139]
    s_waitcnt lgkmcnt(8)
    v_add_f32 v160, v160, v192
    v_add_f32_e64 v161, v161, v193
    v_mfma_f32_16x16x32_bf16 v[140:143], a[220:223], a[200:203], v[140:143]
    v_add_f32 v162, v162, v194
    v_add_f32 v163, v163, v195
    v_mfma_f32_16x16x32_bf16 v[144:147], a[224:227], a[188:191], v[144:147]
    v_add_f32 v164, v164, v196
    v_add_f32 v165, v165, v197
    v_mfma_f32_16x16x32_bf16 v[148:151], a[224:227], a[192:195], v[148:151]
    v_add_f32 v166, v166, v198
    v_add_f32 v167, v167, v199
    v_mfma_f32_16x16x32_bf16 v[152:155], a[224:227], a[196:199], v[152:155]
    v_add_f32 v168, v168, v200
    v_add_f32 v169, v169, v201
    v_mfma_f32_16x16x32_bf16 v[156:159], a[224:227], a[200:203], v[156:159]
    v_pk_add_f32 v[170:171], v[170:171], v[202:203]
    v_pk_add_f32 v[172:173], v[172:173], v[204:205]
    v_pk_add_f32 v[174:175], v[174:175], v[206:207]
    v_pk_add_f32 v[176:177], v[176:177], v[208:209]
    v_pk_add_f32 v[178:179], v[178:179], v[210:211]
    v_pk_add_f32 v[180:181], v[180:181], v[212:213]
    v_pk_add_f32 v[182:183], v[182:183], v[214:215]
    v_pk_add_f32 v[184:185], v[184:185], v[216:217]
    v_pk_add_f32 v[186:187], v[186:187], v[218:219]
    v_pk_add_f32 v[188:189], v[188:189], v[220:221]
    v_pk_add_f32 v[190:191], v[190:191], v[222:223]
    s_waitcnt lgkmcnt(0)
    v_pk_add_f32 v[160:161], v[160:161], v[224:225]
    v_pk_add_f32 v[162:163], v[162:163], v[226:227]
    v_pk_add_f32 v[164:165], v[164:165], v[228:229]
    v_pk_add_f32 v[166:167], v[166:167], v[230:231]
    v_pk_add_f32 v[168:169], v[168:169], v[232:233]
    v_pk_add_f32 v[170:171], v[170:171], v[234:235]
    v_pk_add_f32 v[172:173], v[172:173], v[236:237]
    v_pk_add_f32 v[174:175], v[174:175], v[238:239]
    v_pk_add_f32 v[176:177], v[176:177], v[240:241]
    v_pk_add_f32 v[178:179], v[178:179], v[242:243]
    v_pk_add_f32 v[180:181], v[180:181], v[244:245]
    v_pk_add_f32 v[182:183], v[182:183], v[246:247]
    v_pk_add_f32 v[184:185], v[184:185], v[248:249]
    v_pk_add_f32 v[186:187], v[186:187], v[250:251]
    v_pk_add_f32 v[188:189], v[188:189], v[252:253]
    v_pk_add_f32 v[190:191], v[190:191], v[254:255]
    v_pk_add_f32 v[128:129], v[128:129], v[160:161]
    v_pk_add_f32 v[130:131], v[130:131], v[162:163]
    v_pk_add_f32 v[144:145], v[144:145], v[176:177]
    v_pk_add_f32 v[146:147], v[146:147], v[178:179]
    v_pk_mul_f32 v[128:129], v[128:129], v[18:19] op_sel_hi:[1,0]
    v_pk_mul_f32 v[130:131], v[130:131], v[18:19] op_sel_hi:[1,0]
    v_pk_mul_f32 v[144:145], v[144:145], v[18:19] op_sel_hi:[1,0]
    v_pk_mul_f32 v[146:147], v[146:147], v[18:19] op_sel_hi:[1,0]
    v_cvt_pk_bf16_f32 v64, v128, v129
    v_cvt_pk_bf16_f32 v65, v130, v131
    v_cvt_pk_bf16_f32 v66, v144, v145
    v_cvt_pk_bf16_f32 v67, v146, v147
    s_nop 1
    v_permlane16_swap_b32 v64, v66
    v_permlane16_swap_b32 v65, v67
    buffer_store_dwordx4 v[64:67], v30, s[20:23], s78 offen sc1 nt
    v_pk_add_f32 v[132:133], v[132:133], v[164:165]
    v_pk_add_f32 v[134:135], v[134:135], v[166:167]
    v_pk_add_f32 v[148:149], v[148:149], v[180:181]
    v_pk_add_f32 v[150:151], v[150:151], v[182:183]
    v_pk_mul_f32 v[132:133], v[132:133], v[18:19] op_sel:[0,1] op_sel_hi:[1,1]
    v_pk_mul_f32 v[134:135], v[134:135], v[18:19] op_sel:[0,1] op_sel_hi:[1,1]
    v_pk_mul_f32 v[148:149], v[148:149], v[18:19] op_sel:[0,1] op_sel_hi:[1,1]
    v_pk_mul_f32 v[150:151], v[150:151], v[18:19] op_sel:[0,1] op_sel_hi:[1,1]
    v_cvt_pk_bf16_f32 v68, v132, v133
    v_cvt_pk_bf16_f32 v69, v134, v135
    v_cvt_pk_bf16_f32 v70, v148, v149
    v_cvt_pk_bf16_f32 v71, v150, v151
    s_nop 1
    v_permlane16_swap_b32 v68, v70
    v_permlane16_swap_b32 v69, v71
    buffer_store_dwordx4 v[68:71], v30, s[20:23], s79 offen sc1 nt
    v_pk_add_f32 v[136:137], v[136:137], v[168:169]
    v_pk_add_f32 v[138:139], v[138:139], v[170:171]
    v_pk_add_f32 v[152:153], v[152:153], v[184:185]
    v_pk_add_f32 v[154:155], v[154:155], v[186:187]
    v_pk_mul_f32 v[136:137], v[136:137], v[20:21] op_sel_hi:[1,0]
    v_pk_mul_f32 v[138:139], v[138:139], v[20:21] op_sel_hi:[1,0]
    v_pk_mul_f32 v[152:153], v[152:153], v[20:21] op_sel_hi:[1,0]
    v_pk_mul_f32 v[154:155], v[154:155], v[20:21] op_sel_hi:[1,0]
    v_cvt_pk_bf16_f32 v72, v136, v137
    v_cvt_pk_bf16_f32 v73, v138, v139
    v_cvt_pk_bf16_f32 v74, v152, v153
    v_cvt_pk_bf16_f32 v75, v154, v155
    s_nop 1
    v_permlane16_swap_b32 v72, v74
    v_permlane16_swap_b32 v73, v75
    buffer_store_dwordx4 v[72:75], v30, s[20:23], s80 offen sc1 nt
    v_pk_add_f32 v[140:141], v[140:141], v[172:173]
    v_pk_add_f32 v[142:143], v[142:143], v[174:175]
    v_pk_add_f32 v[156:157], v[156:157], v[188:189]
    v_pk_add_f32 v[158:159], v[158:159], v[190:191]
    v_pk_mul_f32 v[140:141], v[140:141], v[20:21] op_sel:[0,1] op_sel_hi:[1,1]
    v_pk_mul_f32 v[142:143], v[142:143], v[20:21] op_sel:[0,1] op_sel_hi:[1,1]
    v_pk_mul_f32 v[156:157], v[156:157], v[20:21] op_sel:[0,1] op_sel_hi:[1,1]
    v_pk_mul_f32 v[158:159], v[158:159], v[20:21] op_sel:[0,1] op_sel_hi:[1,1]
    v_cvt_pk_bf16_f32 v76, v140, v141
    v_cvt_pk_bf16_f32 v77, v142, v143
    v_cvt_pk_bf16_f32 v78, v156, v157
    v_cvt_pk_bf16_f32 v79, v158, v159
    s_nop 1
    v_permlane16_swap_b32 v76, v78
    v_permlane16_swap_b32 v77, v79
    buffer_store_dwordx4 v[76:79], v30, s[20:23], s81 offen sc1 nt
    s_endpgm
KM_ZSPIN:
    s_mov_b32 s91, 0x40000
KM_ZSPIN1:
    buffer_load_dword v1, off, s[72:75], 0 sc1
    s_waitcnt vmcnt(0)
    v_cmp_eq_u32 vcc, 0, v1
    s_sub_u32 s91, s91, 1
    s_cbranch_vccz KM_ZBACK
    s_cmp_eq_u32 s91, 0
    s_cbranch_scc1 KM_ZBACK
    s_sleep 1
    s_branch KM_ZSPIN1
KM_ESPIN:
    s_mov_b32 s91, 0x40000
KM_ESPIN1:
    buffer_load_dword v19, v18, s[24:27], s88 offen sc1
    s_waitcnt vmcnt(0)
    v_cmp_ne_u32 vcc, s89, v19
    s_sub_u32 s91, s91, 1
    s_cbranch_vccz KM_EBACK
    s_cmp_eq_u32 s91, 0
    s_cbranch_scc1 KM_EBACK
    s_sleep 1
    s_branch KM_ESPIN1
KM_HSPIN:
    s_mov_b32 s91, 0x40000
KM_HSPIN1:
    buffer_load_dword v28, v25, s[24:27], s9 offen sc1
    s_waitcnt vmcnt(0)
    v_cmp_ne_u32 vcc, s89, v28
    s_sub_u32 s91, s91, 1
    s_cbranch_vccz KM_HBACK
    s_cmp_eq_u32 s91, 0
    s_cbranch_scc1 KM_HBACK
    s_sleep 1
    s_branch KM_HSPIN1
KM_OSPIN:
    s_mov_b32 s91, 0x40000
KM_OSPIN1:
    buffer_load_dword v28, v25, s[24:27], s11 offen sc1
    s_waitcnt vmcnt(0)
    v_cmp_ne_u32 vcc, s89, v28
    s_sub_u32 s91, s91, 1
    s_cbranch_vccz KM_OBACK
    s_cmp_eq_u32 s91, 0
    s_cbranch_scc1 KM_OBACK
    s_sleep 1
    s_branch KM_OSPIN1
KM_FALLBACK2:
    s_mov_b32 s55, 2
KM_FALLBACK:
    s_or_b32 s55, s55, 1
    s_waitcnt vmcnt(0) lgkmcnt(0)
    s_nop 15
    v_mov_b32 v82, 0xff7fffff
    v_mov_b32 v83, 0xff7fffff
    v_mov_b32 v80, 0
    v_mov_b32 v81, 0
    s_mov_b32 s78, 0x1200000
    v_mov_b32 v96, 0
    v_mov_b32 v97, 0
    v_mov_b32 v98, 0
    v_mov_b32 v99, 0
    v_mov_b32 v100, 0
    v_mov_b32 v101, 0
    v_mov_b32 v102, 0
    v_mov_b32 v103, 0
    v_mov_b32 v104, 0
    v_mov_b32 v105, 0
    v_mov_b32 v106, 0
    v_mov_b32 v107, 0
    v_mov_b32 v108, 0
    v_mov_b32 v109, 0
    v_mov_b32 v110, 0
    v_mov_b32 v111, 0
    v_mov_b32 v112, 0
    v_mov_b32 v113, 0
    v_mov_b32 v114, 0
    v_mov_b32 v115, 0
    v_mov_b32 v116, 0
    v_mov_b32 v117, 0
    v_mov_b32 v118, 0
    v_mov_b32 v119, 0
    v_mov_b32 v120, 0
    v_mov_b32 v121, 0
    v_mov_b32 v122, 0
    v_mov_b32 v123, 0
    v_mov_b32 v124, 0
    v_mov_b32 v125, 0
    v_mov_b32 v126, 0
    v_mov_b32 v127, 0
KM_FB_LOOP:
    buffer_load_dwordx4 a[60:63], v1, s[24:27], s78 offen offset:0 sc1
    buffer_load_dwordx4 a[64:67], v1, s[24:27], s78 offen offset:1024 sc1
    buffer_load_dwordx4 a[68:71], v1, s[24:27], s78 offen offset:2048 sc1
    buffer_load_dwordx4 a[72:75], v1, s[24:27], s78 offen offset:3072 sc1
    s_waitcnt vmcnt(0)
    v_mfma_f32_32x32x16_bf16 v[64:79], a[60:63], a[44:47], 0
    v_mfma_f32_32x32x16_bf16 v[64:79], a[64:67], a[48:51], v[64:79]
    s_nop 15
    v_max_f32 v84, v64, v65
    v_max3_f32 v84, v66, v67, v84
    v_max3_f32 v84, v68, v69, v84
    v_max3_f32 v84, v70, v71, v84
    v_max3_f32 v84, v72, v73, v84
    v_max3_f32 v84, v74, v75, v84
    v_max3_f32 v84, v76, v77, v84
    v_max3_f32 v84, v78, v79, v84
    v_mov_b32 v85, v84
    s_nop 1
    v_permlane32_swap_b32 v84, v85
    s_nop 1
    v_max3_f32 v84, v84, v85, v82
    v_sub_f32 v85, v82, v84
    v_exp_f32 v85, v85
    v_mov_b32 v82, v84
    v_mul_f32 v80, v80, v85
    v_sub_f32 v64, v64, v84
    v_exp_f32 v64, v64
    v_mul_f32 v96, v96, v85
    v_sub_f32 v65, v65, v84
    v_exp_f32 v65, v65
    v_mul_f32 v97, v97, v85
    v_sub_f32 v66, v66, v84
    v_exp_f32 v66, v66
    v_mul_f32 v98, v98, v85
    v_sub_f32 v67, v67, v84
    v_exp_f32 v67, v67
    v_mul_f32 v99, v99, v85
    v_sub_f32 v68, v68, v84
    v_exp_f32 v68, v68
    v_mul_f32 v100, v100, v85
    v_sub_f32 v69, v69, v84
    v_exp_f32 v69, v69
    v_mul_f32 v101, v101, v85
    v_sub_f32 v70, v70, v84
    v_exp_f32 v70, v70
    v_mul_f32 v102, v102, v85
    v_sub_f32 v71, v71, v84
    v_exp_f32 v71, v71
    v_mul_f32 v103, v103, v85
    v_sub_f32 v72, v72, v84
    v_exp_f32 v72, v72
    v_mul_f32 v104, v104, v85
    v_sub_f32 v73, v73, v84
    v_exp_f32 v73, v73
    v_mul_f32 v105, v105, v85
    v_sub_f32 v74, v74, v84
    v_exp_f32 v74, v74
    v_mul_f32 v106, v106, v85
    v_sub_f32 v75, v75, v84
    v_exp_f32 v75, v75
    v_mul_f32 v107, v107, v85
    v_sub_f32 v76, v76, v84
    v_exp_f32 v76, v76
    v_mul_f32 v108, v108, v85
    v_sub_f32 v77, v77, v84
    v_exp_f32 v77, v77
    v_mul_f32 v109, v109, v85
    v_sub_f32 v78, v78, v84
    v_exp_f32 v78, v78
    v_mul_f32 v110, v110, v85
    v_sub_f32 v79, v79, v84
    v_exp_f32 v79, v79
    v_mul_f32 v111, v111, v85
    v_cvt_pk_bf16_f32 v64, v64, v65
    v_cvt_pk_bf16_f32 v65, v66, v67
    v_cvt_pk_bf16_f32 v66, v68, v69
    v_cvt_pk_bf16_f32 v67, v70, v71
    v_cvt_pk_bf16_f32 v68, v72, v73
    v_cvt_pk_bf16_f32 v69, v74, v75
    v_cvt_pk_bf16_f32 v70, v76, v77
    v_cvt_pk_bf16_f32 v71, v78, v79
    v_lshlrev_b32 v86, 16, v64
    v_and_b32 v87, 0xffff0000, v64
    v_add_f32 v80, v80, v86
    v_add_f32 v80, v80, v87
    v_lshlrev_b32 v86, 16, v65
    v_and_b32 v87, 0xffff0000, v65
    v_add_f32 v80, v80, v86
    v_add_f32 v80, v80, v87
    v_lshlrev_b32 v86, 16, v66
    v_and_b32 v87, 0xffff0000, v66
    v_add_f32 v80, v80, v86
    v_add_f32 v80, v80, v87
    v_lshlrev_b32 v86, 16, v67
    v_and_b32 v87, 0xffff0000, v67
    v_add_f32 v80, v80, v86
    v_add_f32 v80, v80, v87
    v_lshlrev_b32 v86, 16, v68
    v_and_b32 v87, 0xffff0000, v68
    v_add_f32 v80, v80, v86
    v_add_f32 v80, v80, v87
    v_lshlrev_b32 v86, 16, v69
    v_and_b32 v87, 0xffff0000, v69
    v_add_f32 v80, v80, v86
    v_add_f32 v80, v80, v87
    v_lshlrev_b32 v86, 16, v70
    v_and_b32 v87, 0xffff0000, v70
    v_add_f32 v80, v80, v86
    v_add_f32 v80, v80, v87
    v_lshlrev_b32 v86, 16, v71
    v_and_b32 v87, 0xffff0000, v71
    v_add_f32 v80, v80, v86
    v_add_f32 v80, v80, v87
    v_mfma_f32_32x32x16_bf16 v[96:111], a[68:71], v[64:67], v[96:111]
    v_mfma_f32_32x32x16_bf16 v[96:111], a[72:75], v[68:71], v[96:111]
    s_nop 15
    v_mfma_f32_32x32x16_bf16 v[64:79], a[60:63], a[52:55], 0
    v_mfma_f32_32x32x16_bf16 v[64:79], a[64:67], a[56:59], v[64:79]
    s_nop 15
    v_max_f32 v84, v64, v65
    v_max3_f32 v84, v66, v67, v84
    v_max3_f32 v84, v68, v69, v84
    v_max3_f32 v84, v70, v71, v84
    v_max3_f32 v84, v72, v73, v84
    v_max3_f32 v84, v74, v75, v84
    v_max3_f32 v84, v76, v77, v84
    v_max3_f32 v84, v78, v79, v84
    v_mov_b32 v85, v84
    s_nop 1
    v_permlane32_swap_b32 v84, v85
    s_nop 1
    v_max3_f32 v84, v84, v85, v83
    v_sub_f32 v85, v83, v84
    v_exp_f32 v85, v85
    v_mov_b32 v83, v84
    v_mul_f32 v81, v81, v85
    v_sub_f32 v64, v64, v84
    v_exp_f32 v64, v64
    v_mul_f32 v112, v112, v85
    v_sub_f32 v65, v65, v84
    v_exp_f32 v65, v65
    v_mul_f32 v113, v113, v85
    v_sub_f32 v66, v66, v84
    v_exp_f32 v66, v66
    v_mul_f32 v114, v114, v85
    v_sub_f32 v67, v67, v84
    v_exp_f32 v67, v67
    v_mul_f32 v115, v115, v85
    v_sub_f32 v68, v68, v84
    v_exp_f32 v68, v68
    v_mul_f32 v116, v116, v85
    v_sub_f32 v69, v69, v84
    v_exp_f32 v69, v69
    v_mul_f32 v117, v117, v85
    v_sub_f32 v70, v70, v84
    v_exp_f32 v70, v70
    v_mul_f32 v118, v118, v85
    v_sub_f32 v71, v71, v84
    v_exp_f32 v71, v71
    v_mul_f32 v119, v119, v85
    v_sub_f32 v72, v72, v84
    v_exp_f32 v72, v72
    v_mul_f32 v120, v120, v85
    v_sub_f32 v73, v73, v84
    v_exp_f32 v73, v73
    v_mul_f32 v121, v121, v85
    v_sub_f32 v74, v74, v84
    v_exp_f32 v74, v74
    v_mul_f32 v122, v122, v85
    v_sub_f32 v75, v75, v84
    v_exp_f32 v75, v75
    v_mul_f32 v123, v123, v85
    v_sub_f32 v76, v76, v84
    v_exp_f32 v76, v76
    v_mul_f32 v124, v124, v85
    v_sub_f32 v77, v77, v84
    v_exp_f32 v77, v77
    v_mul_f32 v125, v125, v85
    v_sub_f32 v78, v78, v84
    v_exp_f32 v78, v78
    v_mul_f32 v126, v126, v85
    v_sub_f32 v79, v79, v84
    v_exp_f32 v79, v79
    v_mul_f32 v127, v127, v85
    v_cvt_pk_bf16_f32 v64, v64, v65
    v_cvt_pk_bf16_f32 v65, v66, v67
    v_cvt_pk_bf16_f32 v66, v68, v69
    v_cvt_pk_bf16_f32 v67, v70, v71
    v_cvt_pk_bf16_f32 v68, v72, v73
    v_cvt_pk_bf16_f32 v69, v74, v75
    v_cvt_pk_bf16_f32 v70, v76, v77
    v_cvt_pk_bf16_f32 v71, v78, v79
    v_lshlrev_b32 v86, 16, v64
    v_and_b32 v87, 0xffff0000, v64
    v_add_f32 v81, v81, v86
    v_add_f32 v81, v81, v87
    v_lshlrev_b32 v86, 16, v65
    v_and_b32 v87, 0xffff0000, v65
    v_add_f32 v81, v81, v86
    v_add_f32 v81, v81, v87
    v_lshlrev_b32 v86, 16, v66
    v_and_b32 v87, 0xffff0000, v66
    v_add_f32 v81, v81, v86
    v_add_f32 v81, v81, v87
    v_lshlrev_b32 v86, 16, v67
    v_and_b32 v87, 0xffff0000, v67
    v_add_f32 v81, v81, v86
    v_add_f32 v81, v81, v87
    v_lshlrev_b32 v86, 16, v68
    v_and_b32 v87, 0xffff0000, v68
    v_add_f32 v81, v81, v86
    v_add_f32 v81, v81, v87
    v_lshlrev_b32 v86, 16, v69
    v_and_b32 v87, 0xffff0000, v69
    v_add_f32 v81, v81, v86
    v_add_f32 v81, v81, v87
    v_lshlrev_b32 v86, 16, v70
    v_and_b32 v87, 0xffff0000, v70
    v_add_f32 v81, v81, v86
    v_add_f32 v81, v81, v87
    v_lshlrev_b32 v86, 16, v71
    v_and_b32 v87, 0xffff0000, v71
    v_add_f32 v81, v81, v86
    v_add_f32 v81, v81, v87
    v_mfma_f32_32x32x16_bf16 v[112:127], a[68:71], v[64:67], v[112:127]
    v_mfma_f32_32x32x16_bf16 v[112:127], a[72:75], v[68:71], v[112:127]
    s_nop 15
    s_add_u32 s78, s78, 4096
    s_cmp_lt_u32 s78, 0x1240000
    s_cbranch_scc1 KM_FB_LOOP
    v_mov_b32 v84, v80
    v_mov_b32 v85, v81
    s_nop 1
    v_permlane32_swap_b32 v80, v84
    v_permlane32_swap_b32 v81, v85
    s_nop 1
    v_add_f32 v80, v80, v84
    v_add_f32 v81, v81, v85
    s_cmp_eq_u32 s55, 1
    s_cbranch_scc1 KM_NORM
    v_rcp_f32 v80, v80
    v_rcp_f32 v82, v81
    s_nop 0
    v_mul_f32 v80, v80, v22
    v_mul_f32 v82, v82, v23
    v_mul_f32 v96, v96, v80
    v_mul_f32 v97, v97, v80
    v_mul_f32 v98, v98, v80
    v_mul_f32 v99, v99, v80
    v_mul_f32 v100, v100, v80
    v_mul_f32 v101, v101, v80
    v_mul_f32 v102, v102, v80
    v_mul_f32 v103, v103, v80
    v_cvt_pk_bf16_f32 v64, v96, v97
    v_cvt_pk_bf16_f32 v65, v98, v99
    v_cvt_pk_bf16_f32 v66, v100, v101
    v_cvt_pk_bf16_f32 v67, v102, v103
    buffer_store_dwordx4 v[64:67], v26, s[24:27], s54 offen offset:0 sc1
    v_mul_f32 v104, v104, v80
    v_mul_f32 v105, v105, v80
    v_mul_f32 v106, v106, v80
    v_mul_f32 v107, v107, v80
    v_mul_f32 v108, v108, v80
    v_mul_f32 v109, v109, v80
    v_mul_f32 v110, v110, v80
    v_mul_f32 v111, v111, v80
    v_cvt_pk_bf16_f32 v68, v104, v105
    v_cvt_pk_bf16_f32 v69, v106, v107
    v_cvt_pk_bf16_f32 v70, v108, v109
    v_cvt_pk_bf16_f32 v71, v110, v111
    buffer_store_dwordx4 v[68:71], v26, s[24:27], s54 offen offset:512 sc1
    v_mul_f32 v112, v112, v82
    v_mul_f32 v113, v113, v82
    v_mul_f32 v114, v114, v82
    v_mul_f32 v115, v115, v82
    v_mul_f32 v116, v116, v82
    v_mul_f32 v117, v117, v82
    v_mul_f32 v118, v118, v82
    v_mul_f32 v119, v119, v82
    v_cvt_pk_bf16_f32 v72, v112, v113
    v_cvt_pk_bf16_f32 v73, v114, v115
    v_cvt_pk_bf16_f32 v74, v116, v117
    v_cvt_pk_bf16_f32 v75, v118, v119
    buffer_store_dwordx4 v[72:75], v26, s[24:27], s54 offen offset:2048 sc1
    v_mul_f32 v120, v120, v82
    v_mul_f32 v121, v121, v82
    v_mul_f32 v122, v122, v82
    v_mul_f32 v123, v123, v82
    v_mul_f32 v124, v124, v82
    v_mul_f32 v125, v125, v82
    v_mul_f32 v126, v126, v82
    v_mul_f32 v127, v127, v82
    v_cvt_pk_bf16_f32 v76, v120, v121
    v_cvt_pk_bf16_f32 v77, v122, v123
    v_cvt_pk_bf16_f32 v78, v124, v125
    v_cvt_pk_bf16_f32 v79, v126, v127
    buffer_store_dwordx4 v[76:79], v26, s[24:27], s54 offen offset:2560 sc1
    s_waitcnt vmcnt(0)
    s_branch KM_CHECKED
KM_END:
    s_endpgm
.section .rodata,"a"
.p2align 6
.amdhsa_kernel gated_mix__grouped_kv_mqa__glu_gated_reglu__prompt_kernel
  .amdhsa_next_free_vgpr 512
  .amdhsa_next_free_sgpr 102
  .amdhsa_accum_offset 256
  .amdhsa_group_segment_fixed_size 0
  .amdhsa_kernarg_size 104
  .amdhsa_user_sgpr_count 2
  .amdhsa_user_sgpr_kernarg_segment_ptr 1
  .amdhsa_system_sgpr_workgroup_id_x 1
  .amdhsa_float_denorm_mode_32 3
.end_amdhsa_kernel
```
